```python
import torch

def _softmax(x, axis=-1):
    return torch.softmax(x, dim=axis)

def _gelu(x):
    return torch.nn.functional.gelu(x, approximate='tanh')

def _silu(x):
    return torch.nn.functional.silu(x)

def _sigmoid(x):
    return torch.sigmoid(x)

def _layernorm(x, axis=-1, eps=1e-05):
    m = x.mean(dim=axis, keepdim=True)
    v = x.var(dim=axis, keepdim=True, unbiased=False)
    return (x - m) / torch.sqrt(v + eps)

def _scatter_add(tgt, idx, src, axis=0):
    return tgt.clone().index_add_(axis, idx, src)

def _segment_sum(src, seg, n):
    out = torch.zeros((n,) + src.shape[1:], dtype=src.dtype)
    return out.index_add_(0, seg, src)

def _pad(x, pw):
    flat = tuple((v for pair in reversed(pw) for v in pair))
    return torch.nn.functional.pad(x, flat)
kernel_name = 'interleave_layers__ssm_conv_h3__memory_aug_recurrent_mem_tr__prompt'

def setup_inputs():

    _w = lambda a: (lambda t: t.to(torch.bfloat16) if t.is_floating_point() else t)(torch.as_tensor(a))

    def _A_setup():
        B, S, D = (1, 2048, 448)
        ks = 4
        return {'q': _w((lambda *s: torch.randn(*s, dtype=torch.bfloat16) * 0.05)(B, S, D)), 'k': _w((lambda *s: torch.randn(*s, dtype=torch.bfloat16) * 0.2)(B, S, D)), 'v': _w((lambda *s: torch.randn(*s, dtype=torch.bfloat16) * 0.2)(B, S, D)), 'shift_k': _w((lambda *s: torch.randn(*s, dtype=torch.bfloat16) * 0.2)(D, ks) * 0.5), 'ssm_k': _w((lambda *s: torch.randn(*s, dtype=torch.bfloat16) * 0.2)(D, S) * (1.0 / S ** 0.5)), 'ssm_D': _w((lambda *s: torch.randn(*s, dtype=torch.bfloat16) * 0.2)(D))}
    _A_in = _A_setup()

    def _B_setup():
        B, S, Dm = (1, 2048, 448)
        H, Dh = (16, 256)
        M, seg = (8, 32)
        seg = min(seg, S)
        S = S // seg * seg
        return {'x': _w((lambda *s: torch.randn(*s, dtype=torch.bfloat16) * 0.05)(B, S, Dm)), 'mem0': _w((lambda *s: torch.randn(*s, dtype=torch.bfloat16) * 0.2)(B, M, Dm)), 'Wq': _w((lambda *s: torch.randn(*s, dtype=torch.bfloat16) * 1.6)(Dm, H, Dh) * Dm ** (-0.5)), 'Wk': _w((lambda *s: torch.randn(*s, dtype=torch.bfloat16) * 1.6)(Dm, H, Dh) * Dm ** (-0.5)), 'Wv': _w((lambda *s: torch.randn(*s, dtype=torch.bfloat16) * 0.2)(Dm, H, Dh) * Dm ** (-0.5)), 'Wo': _w((lambda *s: torch.randn(*s, dtype=torch.bfloat16) * 0.2)(H, Dh, Dm) * (H * Dh) ** (-0.5)), 'seg_len': seg}
    _B_in = _B_setup()
    return {'A_q': _A_in['q'], 'A_k': _A_in['k'], 'A_v': _A_in['v'], 'A_shift_k': _A_in['shift_k'], 'A_ssm_k': _A_in['ssm_k'], 'A_ssm_D': _A_in['ssm_D'], 'B_x': _B_in['x'], 'B_mem0': _B_in['mem0'], 'B_Wq': _B_in['Wq'], 'B_Wk': _B_in['Wk'], 'B_Wv': _B_in['Wv'], 'B_Wo': _B_in['Wo'], 'B_seg_len': _B_in['seg_len']}

def reference(A_q, A_k, A_v, A_shift_k, A_ssm_k, A_ssm_D, B_x, B_mem0, B_Wq, B_Wk, B_Wv, B_Wo, B_seg_len):

    def _A_ref(q, k, v, shift_k, ssm_k, ssm_D):
        B, S, D = q.shape
        ks = shift_k.shape[-1]
        k_pad = _pad(k, ((0, 0), (ks - 1, 0), (0, 0)))
        k_shift = torch.zeros_like(k)
        for t in range(ks):
            k_shift = k_shift + k_pad[:, t:t + S, :] * shift_k[:, ks - 1 - t][None, None, :]
        kv = k_shift * v
        L = 2 * S
        kv_pad = _pad(kv, ((0, 0), (0, S), (0, 0)))
        kf_pad = _pad(ssm_k, ((0, 0), (0, S)))
        kv_f = (lambda x, axes=(-2, -1): torch.fft.rfft2(x.float(), dim=axes))(kv_pad[:, None, :, :], axes=(1, 2))
        kf_f = (lambda x, axes=(-2, -1): torch.fft.rfft2(x.float(), dim=axes))(kf_pad[:, None, :], axes=(1, 2))
        kf_f = (lambda x, *d: x.permute(*d))(kf_f, 1, 2, 0)
        y_f = kv_f * kf_f[None, :, :, :]
        y = (lambda x, s, axes=(-2, -1): torch.fft.irfft2(x, s=s, dim=axes).to(torch.bfloat16))(y_f, (1, L), axes=(1, 2))[:, 0, :S, :]
        y = y + kv * ssm_D[None, None, :]
        return q * y

    def _B_ref(x, mem0, Wq, Wk, Wv, Wo, seg_len):
        B, S, Dm = x.shape
        H, Dh = (Wq.shape[1], Wq.shape[2])
        M = mem0.shape[1]
        scale = Dh ** (-0.5)
        n_seg = S // seg_len
        L = M + seg_len
        idx = torch.arange(L)
        mask = (idx[:, None] < M) | (idx[:, None] >= idx[None, :])
        mem = mem0
        outs = []
        for s in range(n_seg):
            xs = x[:, s * seg_len:(s + 1) * seg_len, :].clone()
            h = torch.concatenate([mem, xs], axis=1)
            q = torch.einsum('btd,dhe->bhte', h, Wq)
            k = torch.einsum('btd,dhe->bhte', h, Wk)
            v = torch.einsum('btd,dhe->bhte', h, Wv)
            scores = torch.einsum('bhqe,bhke->bhqk', q, k) * scale
            scores = torch.where(mask[None, None], scores, -1000000000.0)
            p = _softmax(scores, axis=-1)
            o = torch.einsum('bhqk,bhke->bhqe', p, v)
            o = torch.einsum('bhte,hed->btd', o, Wo)
            mem = o[:, :M, :].clone()
            outs.append(o[:, M:, :])
        return torch.concatenate(outs, axis=1)
    x = A_q
    x = x + _A_ref(_layernorm(x, axis=-1), A_k, A_v, A_shift_k, A_ssm_k, A_ssm_D)
    x = x + _B_ref(_layernorm(x, axis=-1), B_mem0, B_Wq, B_Wk, B_Wv, B_Wo, B_seg_len)
    x = x + _A_ref(_layernorm(x, axis=-1), A_k, A_v, A_shift_k, A_ssm_k, A_ssm_D)
    x = x + _B_ref(_layernorm(x, axis=-1), B_mem0, B_Wq, B_Wk, B_Wv, B_Wo, B_seg_len)
    return x
```

```asm
; @launch kernel=prep_kernel grid=(7360,1,1) block=(256,1,1) lds=0
; @launch kernel=kv_kernel grid=(3584,1,1) block=(256,1,1) lds=0
; @launch kernel=conv_kernel grid=(224,1,1) block=(256,1,1) lds=0
; @launch kernel=rowa_kernel grid=(512,1,1) block=(256,1,1) lds=0
; @launch kernel=qkv_kernel grid=(3072,1,1) block=(256,1,1) lds=0
; @launch kernel=cha_kernel grid=(64,1,1) block=(256,1,1) lds=16384
; @launch kernel=att_kernel grid=(256,1,1) block=(256,1,1) lds=0
; @launch kernel=woa_kernel grid=(448,1,1) block=(256,1,1) lds=0
; @launch kernel=rowb_kernel grid=(512,1,1) block=(256,1,1) lds=0
; @launch kernel=qkv_kernel grid=(3072,1,1) block=(256,1,1) lds=0
; @launch kernel=chb_kernel grid=(64,1,1) block=(256,1,1) lds=16384
; @launch kernel=att_kernel grid=(256,1,1) block=(256,1,1) lds=0
; @launch kernel=wob_kernel grid=(448,1,1) block=(256,1,1) lds=0
.amdgcn_target "amdgcn-amd-amdhsa--gfx950"
.text
.globl prep_kernel
.p2align 8
.type prep_kernel,@function
prep_kernel:
    s_load_dwordx4 s[8:11], s[0:1], 64
    s_load_dwordx4 s[12:15], s[0:1], 80
    s_load_dwordx2 s[20:21], s[0:1], 120
    s_waitcnt lgkmcnt(0)
    s_mov_b32 s22, 111149056
    s_mov_b32 s23, 0x00020000
    s_cmp_ge_u32 s2, 2688
    s_cbranch_scc1 P_wo
    s_mul_hi_u32 s3, s2, 0x5555556
    s_mul_i32 s4, s3, 48
    s_sub_u32 s4, s2, s4
    s_lshr_b32 s5, s4, 4
    s_mov_b32 s16, s8
    s_mov_b32 s17, s9
    s_cmp_eq_u32 s5, 1
    s_cselect_b32 s16, s10, s16
    s_cselect_b32 s17, s11, s17
    s_cmp_eq_u32 s5, 2
    s_cselect_b32 s16, s12, s16
    s_cselect_b32 s17, s13, s17
    s_mov_b32 s18, 3670016
    s_mov_b32 s19, 0x00020000
    s_and_b32 s6, s4, 15
    s_lshl_b32 s6, s6, 8
    v_add_u32 v1, s6, v0
    v_lshlrev_b32 v1, 1, v1
    s_lshl_b32 s7, s3, 16
    v_add_u32 v1, s7, v1
    buffer_load_ushort v10, v1, s[16:19], 0 offen offset:0
    v_add_u32 v1, 0x2000, v1
    buffer_load_ushort v11, v1, s[16:19], 0 offen
    v_add_u32 v1, 0x2000, v1
    buffer_load_ushort v12, v1, s[16:19], 0 offen
    v_add_u32 v1, 0x2000, v1
    buffer_load_ushort v13, v1, s[16:19], 0 offen
    v_add_u32 v1, 0x2000, v1
    buffer_load_ushort v14, v1, s[16:19], 0 offen
    v_add_u32 v1, 0x2000, v1
    buffer_load_ushort v15, v1, s[16:19], 0 offen
    v_add_u32 v1, 0x2000, v1
    buffer_load_ushort v16, v1, s[16:19], 0 offen
    v_add_u32 v1, 0x2000, v1
    buffer_load_ushort v17, v1, s[16:19], 0 offen
    s_lshl_b32 s6, s4, 8
    v_add_u32 v2, s6, v0
    v_mul_u32_u24 v2, 896, v2
    s_lshl_b32 s7, s3, 4
    v_add_u32 v2, s7, v2
    s_branch P_pack
P_wo:
    s_cmp_ge_u32 s2, 3584
    s_cbranch_scc1 P_poison
    s_sub_u32 s3, s2, 2688
    s_lshl_b32 s3, s3, 8
    v_add_u32 v3, s3, v0
    v_cvt_f32_u32 v4, v3
    v_mul_f32 v4, 0x3b124925, v4
    v_cvt_u32_f32 v4, v4
    v_mul_u32_u24 v5, 448, v4
    v_sub_u32 v5, v3, v5
    v_cmp_gt_i32 vcc, 0, v5
    s_nop 1
    v_subbrev_co_u32 v4, vcc, 0, v4, vcc
    v_mul_u32_u24 v5, 448, v4
    v_sub_u32 v5, v3, v5
    v_cmp_le_u32 vcc, 448, v5
    s_nop 1
    v_addc_co_u32 v4, vcc, 0, v4, vcc
    v_mul_u32_u24 v5, 448, v4
    v_sub_u32 v5, v3, v5
    s_mov_b32 s16, s14
    s_mov_b32 s17, s15
    s_mov_b32 s18, 3670016
    s_mov_b32 s19, 0x00020000
    v_mul_u32_u24 v1, 7168, v4
    v_lshl_add_u32 v1, v5, 1, v1
    v_add_u32 v6, 0, v1
    buffer_load_ushort v10, v6, s[16:19], 0 offen
    v_add_u32 v6, 896, v1
    buffer_load_ushort v11, v6, s[16:19], 0 offen
    v_add_u32 v6, 1792, v1
    buffer_load_ushort v12, v6, s[16:19], 0 offen
    v_add_u32 v6, 2688, v1
    buffer_load_ushort v13, v6, s[16:19], 0 offen
    v_add_u32 v6, 3584, v1
    buffer_load_ushort v14, v6, s[16:19], 0 offen
    v_add_u32 v6, 4480, v1
    buffer_load_ushort v15, v6, s[16:19], 0 offen
    v_add_u32 v6, 5376, v1
    buffer_load_ushort v16, v6, s[16:19], 0 offen
    v_add_u32 v6, 6272, v1
    buffer_load_ushort v17, v6, s[16:19], 0 offen
    v_lshlrev_b32 v2, 13, v5
    v_lshl_add_u32 v2, v4, 4, v2
    v_add_u32 v2, 11010048, v2
P_pack:
    s_waitcnt vmcnt(0)
    v_lshl_or_b32 v20, v11, 16, v10
    v_lshl_or_b32 v21, v13, 16, v12
    v_lshl_or_b32 v22, v15, 16, v14
    v_lshl_or_b32 v23, v17, 16, v16
    buffer_store_dwordx4 v[20:23], v2, s[20:23], 0 offen
    s_endpgm
P_poison:
    s_cmp_ge_u32 s2, 7360
    s_cbranch_scc1 P_end
    s_sub_u32 s3, s2, 3584
    s_lshl_b32 s3, s3, 12
    s_add_u32 s3, s3, 95682560
    v_lshl_add_u32 v2, v0, 4, s3
    v_mov_b32 v20, -1
    v_mov_b32 v21, -1
    v_mov_b32 v22, -1
    v_mov_b32 v23, -1
    buffer_store_dwordx4 v[20:23], v2, s[20:23], 0 offen
P_end:
    s_endpgm
.globl kv_kernel
.p2align 8
.type kv_kernel,@function
kv_kernel:
    s_cmp_ge_u32 s2, 3584
    s_cbranch_scc1 KV_end
    s_load_dwordx2 s[4:5], s[0:1], 8
    s_waitcnt lgkmcnt(0)
    s_mov_b32 s6, 1835008
    s_mov_b32 s7, 0x00020000
    s_load_dwordx2 s[8:9], s[0:1], 16
    s_waitcnt lgkmcnt(0)
    s_mov_b32 s10, 1835008
    s_mov_b32 s11, 0x00020000
    s_load_dwordx2 s[12:13], s[0:1], 24
    s_waitcnt lgkmcnt(0)
    s_mov_b32 s14, 3584
    s_mov_b32 s15, 0x00020000
    s_load_dwordx2 s[16:17], s[0:1], 120
    s_waitcnt lgkmcnt(0)
    s_mov_b32 s18, 111149056
    s_mov_b32 s19, 0x00020000
    s_lshl_b32 s3, s2, 8
    v_add_u32 v1, s3, v0
    v_cvt_f32_u32 v4, v1
    v_mul_f32 v4, 0x3b124925, v4
    v_cvt_u32_f32 v4, v4
    v_mul_u32_u24 v5, 448, v4
    v_sub_u32 v5, v1, v5
    v_cmp_gt_i32 vcc, 0, v5
    s_nop 1
    v_subbrev_co_u32 v4, vcc, 0, v4, vcc
    v_mul_u32_u24 v5, 448, v4
    v_sub_u32 v5, v1, v5
    v_cmp_le_u32 vcc, 448, v5
    s_nop 1
    v_addc_co_u32 v4, vcc, 0, v4, vcc
    v_mul_u32_u24 v5, 448, v4
    v_sub_u32 v5, v1, v5
    v_lshlrev_b32 v2, 1, v1
    v_lshlrev_b32 v6, 3, v5
    buffer_load_dwordx2 v[20:21], v6, s[12:15], 0 offen
    buffer_load_ushort v30, v2, s[8:11], 0 offen
    v_subrev_u32 v7, 2688, v2
    buffer_load_ushort v10, v7, s[4:7], 0 offen
    v_subrev_u32 v7, 1792, v2
    buffer_load_ushort v11, v7, s[4:7], 0 offen
    v_subrev_u32 v7, 896, v2
    buffer_load_ushort v12, v7, s[4:7], 0 offen
    v_subrev_u32 v7, 0, v2
    buffer_load_ushort v13, v7, s[4:7], 0 offen
    s_waitcnt vmcnt(0)
    v_lshlrev_b32 v22, 16, v20
    v_and_b32 v23, 0xffff0000, v20
    v_lshlrev_b32 v24, 16, v21
    v_and_b32 v25, 0xffff0000, v21
    v_mov_b32 v40, 0
    v_lshlrev_b32 v10, 16, v10
    v_mul_f32 v41, v10, v25
    v_cvt_pk_bf16_f32 v41, v41, v41
    v_lshlrev_b32 v41, 16, v41
    v_add_f32 v40, v40, v41
    v_cvt_pk_bf16_f32 v40, v40, v40
    v_lshlrev_b32 v40, 16, v40
    v_lshlrev_b32 v11, 16, v11
    v_mul_f32 v41, v11, v24
    v_cvt_pk_bf16_f32 v41, v41, v41
    v_lshlrev_b32 v41, 16, v41
    v_add_f32 v40, v40, v41
    v_cvt_pk_bf16_f32 v40, v40, v40
    v_lshlrev_b32 v40, 16, v40
    v_lshlrev_b32 v12, 16, v12
    v_mul_f32 v41, v12, v23
    v_cvt_pk_bf16_f32 v41, v41, v41
    v_lshlrev_b32 v41, 16, v41
    v_add_f32 v40, v40, v41
    v_cvt_pk_bf16_f32 v40, v40, v40
    v_lshlrev_b32 v40, 16, v40
    v_lshlrev_b32 v13, 16, v13
    v_mul_f32 v41, v13, v22
    v_cvt_pk_bf16_f32 v41, v41, v41
    v_lshlrev_b32 v41, 16, v41
    v_add_f32 v40, v40, v41
    v_cvt_pk_bf16_f32 v40, v40, v40
    v_lshlrev_b32 v40, 16, v40
    v_lshlrev_b32 v30, 16, v30
    v_mul_f32 v40, v40, v30
    v_cvt_pk_bf16_f32 v40, v40, v40
    v_add_u32 v2, 18350080, v2
    buffer_store_short v40, v2, s[16:19], 0 offen
KV_end:
    s_endpgm
.globl conv_kernel
.p2align 8
.type conv_kernel,@function
conv_kernel:
    s_cmp_ge_u32 s2, 224
    s_cbranch_scc1 CV_end
    s_load_dwordx2 s[4:5], s[0:1], 32
    s_waitcnt lgkmcnt(0)
    s_mov_b32 s6, 1835008
    s_mov_b32 s7, 0x00020000
    s_load_dwordx2 s[8:9], s[0:1], 120
    s_waitcnt lgkmcnt(0)
    s_mov_b32 s10, 111149056
    s_mov_b32 s11, 0x00020000
    s_load_dwordx2 s[12:13], s[0:1], 40
    s_waitcnt lgkmcnt(0)
    s_mov_b32 s14, 896
    s_mov_b32 s15, 0x00020000
    v_lshrrev_b32 v1, 6, v0
    s_nop 0
    v_readfirstlane_b32 s3, v1
    s_lshl_b32 s20, s2, 2
    s_add_u32 s3, s3, s20
    s_mul_hi_u32 s21, s3, 0x24924925
    s_mul_i32 s22, s21, 7
    s_sub_u32 s22, s3, s22
    v_and_b32 v1, 63, v0
    s_lshl_b32 s22, s22, 6
    v_add_u32 v1, s22, v1
    v_lshlrev_b32 v2, 1, v1
    v_lshlrev_b32 v3, 12, v1
    buffer_load_ushort v90, v2, s[12:15], 0 offen
    s_mov_b32 s24, 0
CV_blk:
    s_mov_b32 s25, s21
    s_cmp_eq_u32 s24, 0
    s_cbranch_scc1 CV_a
    s_sub_u32 s25, 255, s21
CV_a:
    v_mov_b32 v50, 0
    v_mov_b32 v51, 0
    v_mov_b32 v52, 0
    v_mov_b32 v53, 0
    v_mov_b32 v54, 0
    v_mov_b32 v55, 0
    v_mov_b32 v56, 0
    v_mov_b32 v57, 0
    s_mov_b32 s26, 0
CV_u:
    s_mul_i32 s27, s26, 7168
    s_add_u32 s27, s27, 18350080
    v_add_u32 v5, 0, v2
    buffer_load_ushort v10, v5, s[8:11], s27 offen
    v_add_u32 v5, 896, v2
    buffer_load_ushort v11, v5, s[8:11], s27 offen
    v_add_u32 v5, 1792, v2
    buffer_load_ushort v12, v5, s[8:11], s27 offen
    v_add_u32 v5, 2688, v2
    buffer_load_ushort v13, v5, s[8:11], s27 offen
    v_add_u32 v5, 3584, v2
    buffer_load_ushort v14, v5, s[8:11], s27 offen
    v_add_u32 v5, 4480, v2
    buffer_load_ushort v15, v5, s[8:11], s27 offen
    v_add_u32 v5, 5376, v2
    buffer_load_ushort v16, v5, s[8:11], s27 offen
    v_add_u32 v5, 6272, v2
    buffer_load_ushort v17, v5, s[8:11], s27 offen
    s_sub_u32 s28, s25, s26
    s_lshl_b32 s28, s28, 4
    s_sub_u32 s28, s28, 16
    v_add_u32 v4, s28, v3
    s_cmp_eq_u32 s25, s26
    s_cbranch_scc1 CV_z
    buffer_load_dwordx4 v[20:23], v4, s[4:7], 0 offen
    s_branch CV_z2
CV_z:
    v_mov_b32 v20, 0
    v_mov_b32 v21, 0
    v_mov_b32 v22, 0
    v_mov_b32 v23, 0
CV_z2:
    buffer_load_dwordx4 v[24:27], v4, s[4:7], 0 offen offset:16
    s_waitcnt vmcnt(0)
    v_lshlrev_b32 v30, 16, v20
    v_and_b32 v31, 0xffff0000, v20
    v_lshlrev_b32 v10, 16, v10
    v_lshlrev_b32 v32, 16, v21
    v_and_b32 v33, 0xffff0000, v21
    v_lshlrev_b32 v11, 16, v11
    v_lshlrev_b32 v34, 16, v22
    v_and_b32 v35, 0xffff0000, v22
    v_lshlrev_b32 v12, 16, v12
    v_lshlrev_b32 v36, 16, v23
    v_and_b32 v37, 0xffff0000, v23
    v_lshlrev_b32 v13, 16, v13
    v_lshlrev_b32 v38, 16, v24
    v_and_b32 v39, 0xffff0000, v24
    v_lshlrev_b32 v14, 16, v14
    v_lshlrev_b32 v40, 16, v25
    v_and_b32 v41, 0xffff0000, v25
    v_lshlrev_b32 v15, 16, v15
    v_lshlrev_b32 v42, 16, v26
    v_and_b32 v43, 0xffff0000, v26
    v_lshlrev_b32 v16, 16, v16
    v_lshlrev_b32 v44, 16, v27
    v_and_b32 v45, 0xffff0000, v27
    v_lshlrev_b32 v17, 16, v17
    v_fmac_f32 v50, v10, v38
    v_fmac_f32 v50, v11, v37
    v_fmac_f32 v50, v12, v36
    v_fmac_f32 v50, v13, v35
    v_fmac_f32 v50, v14, v34
    v_fmac_f32 v50, v15, v33
    v_fmac_f32 v50, v16, v32
    v_fmac_f32 v50, v17, v31
    v_fmac_f32 v51, v10, v39
    v_fmac_f32 v51, v11, v38
    v_fmac_f32 v51, v12, v37
    v_fmac_f32 v51, v13, v36
    v_fmac_f32 v51, v14, v35
    v_fmac_f32 v51, v15, v34
    v_fmac_f32 v51, v16, v33
    v_fmac_f32 v51, v17, v32
    v_fmac_f32 v52, v10, v40
    v_fmac_f32 v52, v11, v39
    v_fmac_f32 v52, v12, v38
    v_fmac_f32 v52, v13, v37
    v_fmac_f32 v52, v14, v36
    v_fmac_f32 v52, v15, v35
    v_fmac_f32 v52, v16, v34
    v_fmac_f32 v52, v17, v33
    v_fmac_f32 v53, v10, v41
    v_fmac_f32 v53, v11, v40
    v_fmac_f32 v53, v12, v39
    v_fmac_f32 v53, v13, v38
    v_fmac_f32 v53, v14, v37
    v_fmac_f32 v53, v15, v36
    v_fmac_f32 v53, v16, v35
    v_fmac_f32 v53, v17, v34
    v_fmac_f32 v54, v10, v42
    v_fmac_f32 v54, v11, v41
    v_fmac_f32 v54, v12, v40
    v_fmac_f32 v54, v13, v39
    v_fmac_f32 v54, v14, v38
    v_fmac_f32 v54, v15, v37
    v_fmac_f32 v54, v16, v36
    v_fmac_f32 v54, v17, v35
    v_fmac_f32 v55, v10, v43
    v_fmac_f32 v55, v11, v42
    v_fmac_f32 v55, v12, v41
    v_fmac_f32 v55, v13, v40
    v_fmac_f32 v55, v14, v39
    v_fmac_f32 v55, v15, v38
    v_fmac_f32 v55, v16, v37
    v_fmac_f32 v55, v17, v36
    v_fmac_f32 v56, v10, v44
    v_fmac_f32 v56, v11, v43
    v_fmac_f32 v56, v12, v42
    v_fmac_f32 v56, v13, v41
    v_fmac_f32 v56, v14, v40
    v_fmac_f32 v56, v15, v39
    v_fmac_f32 v56, v16, v38
    v_fmac_f32 v56, v17, v37
    v_fmac_f32 v57, v10, v45
    v_fmac_f32 v57, v11, v44
    v_fmac_f32 v57, v12, v43
    v_fmac_f32 v57, v13, v42
    v_fmac_f32 v57, v14, v41
    v_fmac_f32 v57, v15, v40
    v_fmac_f32 v57, v16, v39
    v_fmac_f32 v57, v17, v38
    s_add_u32 s26, s26, 1
    s_cmp_le_u32 s26, s25
    s_cbranch_scc1 CV_u
    v_lshlrev_b32 v91, 16, v90
    s_mul_i32 s27, s25, 7168
    s_add_u32 s27, s27, 14680064
    v_cvt_pk_bf16_f32 v50, v50, v50
    v_lshlrev_b32 v50, 16, v50
    v_mul_f32 v92, v10, v91
    v_cvt_pk_bf16_f32 v92, v92, v92
    v_lshlrev_b32 v92, 16, v92
    v_add_f32 v92, v92, v50
    v_cvt_pk_bf16_f32 v92, v92, v92
    v_add_u32 v5, 0, v2
    buffer_store_short v92, v5, s[8:11], s27 offen
    v_cvt_pk_bf16_f32 v51, v51, v51
    v_lshlrev_b32 v51, 16, v51
    v_mul_f32 v92, v11, v91
    v_cvt_pk_bf16_f32 v92, v92, v92
    v_lshlrev_b32 v92, 16, v92
    v_add_f32 v92, v92, v51
    v_cvt_pk_bf16_f32 v92, v92, v92
    v_add_u32 v5, 896, v2
    buffer_store_short v92, v5, s[8:11], s27 offen
    v_cvt_pk_bf16_f32 v52, v52, v52
    v_lshlrev_b32 v52, 16, v52
    v_mul_f32 v92, v12, v91
    v_cvt_pk_bf16_f32 v92, v92, v92
    v_lshlrev_b32 v92, 16, v92
    v_add_f32 v92, v92, v52
    v_cvt_pk_bf16_f32 v92, v92, v92
    v_add_u32 v5, 1792, v2
    buffer_store_short v92, v5, s[8:11], s27 offen
    v_cvt_pk_bf16_f32 v53, v53, v53
    v_lshlrev_b32 v53, 16, v53
    v_mul_f32 v92, v13, v91
    v_cvt_pk_bf16_f32 v92, v92, v92
    v_lshlrev_b32 v92, 16, v92
    v_add_f32 v92, v92, v53
    v_cvt_pk_bf16_f32 v92, v92, v92
    v_add_u32 v5, 2688, v2
    buffer_store_short v92, v5, s[8:11], s27 offen
    v_cvt_pk_bf16_f32 v54, v54, v54
    v_lshlrev_b32 v54, 16, v54
    v_mul_f32 v92, v14, v91
    v_cvt_pk_bf16_f32 v92, v92, v92
    v_lshlrev_b32 v92, 16, v92
    v_add_f32 v92, v92, v54
    v_cvt_pk_bf16_f32 v92, v92, v92
    v_add_u32 v5, 3584, v2
    buffer_store_short v92, v5, s[8:11], s27 offen
    v_cvt_pk_bf16_f32 v55, v55, v55
    v_lshlrev_b32 v55, 16, v55
    v_mul_f32 v92, v15, v91
    v_cvt_pk_bf16_f32 v92, v92, v92
    v_lshlrev_b32 v92, 16, v92
    v_add_f32 v92, v92, v55
    v_cvt_pk_bf16_f32 v92, v92, v92
    v_add_u32 v5, 4480, v2
    buffer_store_short v92, v5, s[8:11], s27 offen
    v_cvt_pk_bf16_f32 v56, v56, v56
    v_lshlrev_b32 v56, 16, v56
    v_mul_f32 v92, v16, v91
    v_cvt_pk_bf16_f32 v92, v92, v92
    v_lshlrev_b32 v92, 16, v92
    v_add_f32 v92, v92, v56
    v_cvt_pk_bf16_f32 v92, v92, v92
    v_add_u32 v5, 5376, v2
    buffer_store_short v92, v5, s[8:11], s27 offen
    v_cvt_pk_bf16_f32 v57, v57, v57
    v_lshlrev_b32 v57, 16, v57
    v_mul_f32 v92, v17, v91
    v_cvt_pk_bf16_f32 v92, v92, v92
    v_lshlrev_b32 v92, 16, v92
    v_add_f32 v92, v92, v57
    v_cvt_pk_bf16_f32 v92, v92, v92
    v_add_u32 v5, 6272, v2
    buffer_store_short v92, v5, s[8:11], s27 offen
    s_add_u32 s24, s24, 1
    s_cmp_lt_u32 s24, 2
    s_cbranch_scc1 CV_blk
CV_end:
    s_endpgm
.globl rowa_kernel
.p2align 8
.type rowa_kernel,@function
rowa_kernel:
    s_cmp_ge_u32 s2, 512
    s_cbranch_scc1 rowa_kernel_end
    s_load_dwordx2 s[8:9], s[0:1], 120
    s_waitcnt lgkmcnt(0)
    s_mov_b32 s10, 111149056
    s_mov_b32 s11, 0x00020000
    s_load_dwordx2 s[4:5], s[0:1], 0
    s_waitcnt lgkmcnt(0)
    s_mov_b32 s6, 1835008
    s_mov_b32 s7, 0x00020000
    v_lshrrev_b32 v1, 6, v0
    v_lshl_add_u32 v1, s2, 2, v1
    v_mul_u32_u24 v1, 896, v1
    v_and_b32 v2, 63, v0
    v_lshl_add_u32 v1, v2, 1, v1
    v_add_u32 v3, 14680064, v1
    buffer_load_ushort v10, v1, s[4:7], 0 offen offset:0
    buffer_load_ushort v20, v3, s[8:11], 0 offen offset:0
    buffer_load_ushort v11, v1, s[4:7], 0 offen offset:128
    buffer_load_ushort v21, v3, s[8:11], 0 offen offset:128
    buffer_load_ushort v12, v1, s[4:7], 0 offen offset:256
    buffer_load_ushort v22, v3, s[8:11], 0 offen offset:256
    buffer_load_ushort v13, v1, s[4:7], 0 offen offset:384
    buffer_load_ushort v23, v3, s[8:11], 0 offen offset:384
    buffer_load_ushort v14, v1, s[4:7], 0 offen offset:512
    buffer_load_ushort v24, v3, s[8:11], 0 offen offset:512
    buffer_load_ushort v15, v1, s[4:7], 0 offen offset:640
    buffer_load_ushort v25, v3, s[8:11], 0 offen offset:640
    buffer_load_ushort v16, v1, s[4:7], 0 offen offset:768
    buffer_load_ushort v26, v3, s[8:11], 0 offen offset:768
    s_waitcnt vmcnt(0)
    v_lshlrev_b32 v10, 16, v10
    v_lshlrev_b32 v20, 16, v20
    v_lshlrev_b32 v11, 16, v11
    v_lshlrev_b32 v21, 16, v21
    v_lshlrev_b32 v12, 16, v12
    v_lshlrev_b32 v22, 16, v22
    v_lshlrev_b32 v13, 16, v13
    v_lshlrev_b32 v23, 16, v23
    v_lshlrev_b32 v14, 16, v14
    v_lshlrev_b32 v24, 16, v24
    v_lshlrev_b32 v15, 16, v15
    v_lshlrev_b32 v25, 16, v25
    v_lshlrev_b32 v16, 16, v16
    v_lshlrev_b32 v26, 16, v26
    v_mov_b32 v60, v10
    v_add_f32 v60, v60, v11
    v_add_f32 v60, v60, v12
    v_add_f32 v60, v60, v13
    v_add_f32 v60, v60, v14
    v_add_f32 v60, v60, v15
    v_add_f32 v60, v60, v16
    ds_swizzle_b32 v61, v60 offset:1055
    s_waitcnt lgkmcnt(0)
    v_add_f32 v60, v60, v61
    ds_swizzle_b32 v61, v60 offset:2079
    s_waitcnt lgkmcnt(0)
    v_add_f32 v60, v60, v61
    ds_swizzle_b32 v61, v60 offset:4127
    s_waitcnt lgkmcnt(0)
    v_add_f32 v60, v60, v61
    ds_swizzle_b32 v61, v60 offset:8223
    s_waitcnt lgkmcnt(0)
    v_add_f32 v60, v60, v61
    ds_swizzle_b32 v61, v60 offset:16415
    s_waitcnt lgkmcnt(0)
    v_add_f32 v60, v60, v61
    s_nop 0
    v_readlane_b32 s30, v60, 0
    v_readlane_b32 s31, v60, 32
    s_nop 1
    v_mov_b32 v60, s30
    v_add_f32 v60, s31, v60
    v_mul_f32 v60, 0x3b124925, v60
    v_mov_b32 v62, 0
    v_sub_f32 v63, v10, v60
    v_fmac_f32 v62, v63, v63
    v_sub_f32 v63, v11, v60
    v_fmac_f32 v62, v63, v63
    v_sub_f32 v63, v12, v60
    v_fmac_f32 v62, v63, v63
    v_sub_f32 v63, v13, v60
    v_fmac_f32 v62, v63, v63
    v_sub_f32 v63, v14, v60
    v_fmac_f32 v62, v63, v63
    v_sub_f32 v63, v15, v60
    v_fmac_f32 v62, v63, v63
    v_sub_f32 v63, v16, v60
    v_fmac_f32 v62, v63, v63
    ds_swizzle_b32 v63, v62 offset:1055
    s_waitcnt lgkmcnt(0)
    v_add_f32 v62, v62, v63
    ds_swizzle_b32 v63, v62 offset:2079
    s_waitcnt lgkmcnt(0)
    v_add_f32 v62, v62, v63
    ds_swizzle_b32 v63, v62 offset:4127
    s_waitcnt lgkmcnt(0)
    v_add_f32 v62, v62, v63
    ds_swizzle_b32 v63, v62 offset:8223
    s_waitcnt lgkmcnt(0)
    v_add_f32 v62, v62, v63
    ds_swizzle_b32 v63, v62 offset:16415
    s_waitcnt lgkmcnt(0)
    v_add_f32 v62, v62, v63
    s_nop 0
    v_readlane_b32 s30, v62, 0
    v_readlane_b32 s31, v62, 32
    s_nop 1
    v_mov_b32 v62, s30
    v_add_f32 v62, s31, v62
    v_mul_f32 v62, 0x3b124925, v62
    v_cvt_pk_bf16_f32 v62, v62, v62
    v_lshlrev_b32 v62, 16, v62
    v_cvt_pk_bf16_f32 v60, v60, v60
    v_lshlrev_b32 v60, 16, v60
    v_add_f32 v62, 0x3727c5ac, v62
    v_cvt_pk_bf16_f32 v62, v62, v62
    v_lshlrev_b32 v62, 16, v62
    v_sqrt_f32 v62, v62
    s_nop 0
    v_cvt_pk_bf16_f32 v62, v62, v62
    v_lshlrev_b32 v62, 16, v62
    v_rcp_f32 v62, v62
    s_nop 0
    v_sub_f32 v63, v10, v60
    v_cvt_pk_bf16_f32 v63, v63, v63
    v_lshlrev_b32 v63, 16, v63
    v_mul_f32 v63, v63, v62
    v_cvt_pk_bf16_f32 v30, v63, v63
    v_lshlrev_b32 v30, 16, v30
    v_sub_f32 v63, v11, v60
    v_cvt_pk_bf16_f32 v63, v63, v63
    v_lshlrev_b32 v63, 16, v63
    v_mul_f32 v63, v63, v62
    v_cvt_pk_bf16_f32 v31, v63, v63
    v_lshlrev_b32 v31, 16, v31
    v_sub_f32 v63, v12, v60
    v_cvt_pk_bf16_f32 v63, v63, v63
    v_lshlrev_b32 v63, 16, v63
    v_mul_f32 v63, v63, v62
    v_cvt_pk_bf16_f32 v32, v63, v63
    v_lshlrev_b32 v32, 16, v32
    v_sub_f32 v63, v13, v60
    v_cvt_pk_bf16_f32 v63, v63, v63
    v_lshlrev_b32 v63, 16, v63
    v_mul_f32 v63, v63, v62
    v_cvt_pk_bf16_f32 v33, v63, v63
    v_lshlrev_b32 v33, 16, v33
    v_sub_f32 v63, v14, v60
    v_cvt_pk_bf16_f32 v63, v63, v63
    v_lshlrev_b32 v63, 16, v63
    v_mul_f32 v63, v63, v62
    v_cvt_pk_bf16_f32 v34, v63, v63
    v_lshlrev_b32 v34, 16, v34
    v_sub_f32 v63, v15, v60
    v_cvt_pk_bf16_f32 v63, v63, v63
    v_lshlrev_b32 v63, 16, v63
    v_mul_f32 v63, v63, v62
    v_cvt_pk_bf16_f32 v35, v63, v63
    v_lshlrev_b32 v35, 16, v35
    v_sub_f32 v63, v16, v60
    v_cvt_pk_bf16_f32 v63, v63, v63
    v_lshlrev_b32 v63, 16, v63
    v_mul_f32 v63, v63, v62
    v_cvt_pk_bf16_f32 v36, v63, v63
    v_lshlrev_b32 v36, 16, v36
    v_mul_f32 v30, v30, v20
    v_cvt_pk_bf16_f32 v30, v30, v30
    v_lshlrev_b32 v30, 16, v30
    v_add_f32 v10, v10, v30
    v_cvt_pk_bf16_f32 v10, v10, v10
    v_lshlrev_b32 v10, 16, v10
    v_mul_f32 v31, v31, v21
    v_cvt_pk_bf16_f32 v31, v31, v31
    v_lshlrev_b32 v31, 16, v31
    v_add_f32 v11, v11, v31
    v_cvt_pk_bf16_f32 v11, v11, v11
    v_lshlrev_b32 v11, 16, v11
    v_mul_f32 v32, v32, v22
    v_cvt_pk_bf16_f32 v32, v32, v32
    v_lshlrev_b32 v32, 16, v32
    v_add_f32 v12, v12, v32
    v_cvt_pk_bf16_f32 v12, v12, v12
    v_lshlrev_b32 v12, 16, v12
    v_mul_f32 v33, v33, v23
    v_cvt_pk_bf16_f32 v33, v33, v33
    v_lshlrev_b32 v33, 16, v33
    v_add_f32 v13, v13, v33
    v_cvt_pk_bf16_f32 v13, v13, v13
    v_lshlrev_b32 v13, 16, v13
    v_mul_f32 v34, v34, v24
    v_cvt_pk_bf16_f32 v34, v34, v34
    v_lshlrev_b32 v34, 16, v34
    v_add_f32 v14, v14, v34
    v_cvt_pk_bf16_f32 v14, v14, v14
    v_lshlrev_b32 v14, 16, v14
    v_mul_f32 v35, v35, v25
    v_cvt_pk_bf16_f32 v35, v35, v35
    v_lshlrev_b32 v35, 16, v35
    v_add_f32 v15, v15, v35
    v_cvt_pk_bf16_f32 v15, v15, v15
    v_lshlrev_b32 v15, 16, v15
    v_mul_f32 v36, v36, v26
    v_cvt_pk_bf16_f32 v36, v36, v36
    v_lshlrev_b32 v36, 16, v36
    v_add_f32 v16, v16, v36
    v_cvt_pk_bf16_f32 v16, v16, v16
    v_lshlrev_b32 v16, 16, v16
    v_mov_b32 v60, v10
    v_add_f32 v60, v60, v11
    v_add_f32 v60, v60, v12
    v_add_f32 v60, v60, v13
    v_add_f32 v60, v60, v14
    v_add_f32 v60, v60, v15
    v_add_f32 v60, v60, v16
    ds_swizzle_b32 v61, v60 offset:1055
    s_waitcnt lgkmcnt(0)
    v_add_f32 v60, v60, v61
    ds_swizzle_b32 v61, v60 offset:2079
    s_waitcnt lgkmcnt(0)
    v_add_f32 v60, v60, v61
    ds_swizzle_b32 v61, v60 offset:4127
    s_waitcnt lgkmcnt(0)
    v_add_f32 v60, v60, v61
    ds_swizzle_b32 v61, v60 offset:8223
    s_waitcnt lgkmcnt(0)
    v_add_f32 v60, v60, v61
    ds_swizzle_b32 v61, v60 offset:16415
    s_waitcnt lgkmcnt(0)
    v_add_f32 v60, v60, v61
    s_nop 0
    v_readlane_b32 s30, v60, 0
    v_readlane_b32 s31, v60, 32
    s_nop 1
    v_mov_b32 v60, s30
    v_add_f32 v60, s31, v60
    v_mul_f32 v60, 0x3b124925, v60
    v_mov_b32 v62, 0
    v_sub_f32 v63, v10, v60
    v_fmac_f32 v62, v63, v63
    v_sub_f32 v63, v11, v60
    v_fmac_f32 v62, v63, v63
    v_sub_f32 v63, v12, v60
    v_fmac_f32 v62, v63, v63
    v_sub_f32 v63, v13, v60
    v_fmac_f32 v62, v63, v63
    v_sub_f32 v63, v14, v60
    v_fmac_f32 v62, v63, v63
    v_sub_f32 v63, v15, v60
    v_fmac_f32 v62, v63, v63
    v_sub_f32 v63, v16, v60
    v_fmac_f32 v62, v63, v63
    ds_swizzle_b32 v63, v62 offset:1055
    s_waitcnt lgkmcnt(0)
    v_add_f32 v62, v62, v63
    ds_swizzle_b32 v63, v62 offset:2079
    s_waitcnt lgkmcnt(0)
    v_add_f32 v62, v62, v63
    ds_swizzle_b32 v63, v62 offset:4127
    s_waitcnt lgkmcnt(0)
    v_add_f32 v62, v62, v63
    ds_swizzle_b32 v63, v62 offset:8223
    s_waitcnt lgkmcnt(0)
    v_add_f32 v62, v62, v63
    ds_swizzle_b32 v63, v62 offset:16415
    s_waitcnt lgkmcnt(0)
    v_add_f32 v62, v62, v63
    s_nop 0
    v_readlane_b32 s30, v62, 0
    v_readlane_b32 s31, v62, 32
    s_nop 1
    v_mov_b32 v62, s30
    v_add_f32 v62, s31, v62
    v_mul_f32 v62, 0x3b124925, v62
    v_cvt_pk_bf16_f32 v62, v62, v62
    v_lshlrev_b32 v62, 16, v62
    v_cvt_pk_bf16_f32 v60, v60, v60
    v_lshlrev_b32 v60, 16, v60
    v_add_f32 v62, 0x3727c5ac, v62
    v_cvt_pk_bf16_f32 v62, v62, v62
    v_lshlrev_b32 v62, 16, v62
    v_sqrt_f32 v62, v62
    s_nop 0
    v_cvt_pk_bf16_f32 v62, v62, v62
    v_lshlrev_b32 v62, 16, v62
    v_rcp_f32 v62, v62
    s_nop 0
    v_sub_f32 v63, v10, v60
    v_cvt_pk_bf16_f32 v63, v63, v63
    v_lshlrev_b32 v63, 16, v63
    v_mul_f32 v63, v63, v62
    v_cvt_pk_bf16_f32 v30, v63, v63
    v_lshlrev_b32 v30, 16, v30
    v_sub_f32 v63, v11, v60
    v_cvt_pk_bf16_f32 v63, v63, v63
    v_lshlrev_b32 v63, 16, v63
    v_mul_f32 v63, v63, v62
    v_cvt_pk_bf16_f32 v31, v63, v63
    v_lshlrev_b32 v31, 16, v31
    v_sub_f32 v63, v12, v60
    v_cvt_pk_bf16_f32 v63, v63, v63
    v_lshlrev_b32 v63, 16, v63
    v_mul_f32 v63, v63, v62
    v_cvt_pk_bf16_f32 v32, v63, v63
    v_lshlrev_b32 v32, 16, v32
    v_sub_f32 v63, v13, v60
    v_cvt_pk_bf16_f32 v63, v63, v63
    v_lshlrev_b32 v63, 16, v63
    v_mul_f32 v63, v63, v62
    v_cvt_pk_bf16_f32 v33, v63, v63
    v_lshlrev_b32 v33, 16, v33
    v_sub_f32 v63, v14, v60
    v_cvt_pk_bf16_f32 v63, v63, v63
    v_lshlrev_b32 v63, 16, v63
    v_mul_f32 v63, v63, v62
    v_cvt_pk_bf16_f32 v34, v63, v63
    v_lshlrev_b32 v34, 16, v34
    v_sub_f32 v63, v15, v60
    v_cvt_pk_bf16_f32 v63, v63, v63
    v_lshlrev_b32 v63, 16, v63
    v_mul_f32 v63, v63, v62
    v_cvt_pk_bf16_f32 v35, v63, v63
    v_lshlrev_b32 v35, 16, v35
    v_sub_f32 v63, v16, v60
    v_cvt_pk_bf16_f32 v63, v63, v63
    v_lshlrev_b32 v63, 16, v63
    v_mul_f32 v63, v63, v62
    v_cvt_pk_bf16_f32 v36, v63, v63
    v_lshlrev_b32 v36, 16, v36
    v_add_u32 v3, 16515072, v1
    v_add_u32 v4, 18350080, v1
    v_lshrrev_b32 v10, 16, v10
    v_lshrrev_b32 v30, 16, v30
    buffer_store_short v10, v3, s[8:11], 0 offen offset:0
    buffer_store_short v30, v4, s[8:11], 0 offen offset:0
    v_lshrrev_b32 v11, 16, v11
    v_lshrrev_b32 v31, 16, v31
    buffer_store_short v11, v3, s[8:11], 0 offen offset:128
    buffer_store_short v31, v4, s[8:11], 0 offen offset:128
    v_lshrrev_b32 v12, 16, v12
    v_lshrrev_b32 v32, 16, v32
    buffer_store_short v12, v3, s[8:11], 0 offen offset:256
    buffer_store_short v32, v4, s[8:11], 0 offen offset:256
    v_lshrrev_b32 v13, 16, v13
    v_lshrrev_b32 v33, 16, v33
    buffer_store_short v13, v3, s[8:11], 0 offen offset:384
    buffer_store_short v33, v4, s[8:11], 0 offen offset:384
    v_lshrrev_b32 v14, 16, v14
    v_lshrrev_b32 v34, 16, v34
    buffer_store_short v14, v3, s[8:11], 0 offen offset:512
    buffer_store_short v34, v4, s[8:11], 0 offen offset:512
    v_lshrrev_b32 v15, 16, v15
    v_lshrrev_b32 v35, 16, v35
    buffer_store_short v15, v3, s[8:11], 0 offen offset:640
    buffer_store_short v35, v4, s[8:11], 0 offen offset:640
    v_lshrrev_b32 v16, 16, v16
    v_lshrrev_b32 v36, 16, v36
    buffer_store_short v16, v3, s[8:11], 0 offen offset:768
    buffer_store_short v36, v4, s[8:11], 0 offen offset:768
rowa_kernel_end:
    s_endpgm
.globl rowb_kernel
.p2align 8
.type rowb_kernel,@function
rowb_kernel:
    s_cmp_ge_u32 s2, 512
    s_cbranch_scc1 rowb_kernel_end
    s_load_dwordx2 s[8:9], s[0:1], 120
    s_waitcnt lgkmcnt(0)
    s_mov_b32 s10, 111149056
    s_mov_b32 s11, 0x00020000
    s_load_dwordx2 s[4:5], s[0:1], 120
    s_waitcnt lgkmcnt(0)
    s_add_u32 s4, s4, 16515072
    s_addc_u32 s5, s5, 0
    s_mov_b32 s6, 111149056
    s_mov_b32 s7, 0x00020000
    v_lshrrev_b32 v1, 6, v0
    v_lshl_add_u32 v1, s2, 2, v1
    v_mul_u32_u24 v1, 896, v1
    v_and_b32 v2, 63, v0
    v_lshl_add_u32 v1, v2, 1, v1
    v_add_u32 v3, 14680064, v1
    buffer_load_ushort v10, v1, s[4:7], 0 offen offset:0
    buffer_load_ushort v20, v3, s[8:11], 0 offen offset:0
    buffer_load_ushort v11, v1, s[4:7], 0 offen offset:128
    buffer_load_ushort v21, v3, s[8:11], 0 offen offset:128
    buffer_load_ushort v12, v1, s[4:7], 0 offen offset:256
    buffer_load_ushort v22, v3, s[8:11], 0 offen offset:256
    buffer_load_ushort v13, v1, s[4:7], 0 offen offset:384
    buffer_load_ushort v23, v3, s[8:11], 0 offen offset:384
    buffer_load_ushort v14, v1, s[4:7], 0 offen offset:512
    buffer_load_ushort v24, v3, s[8:11], 0 offen offset:512
    buffer_load_ushort v15, v1, s[4:7], 0 offen offset:640
    buffer_load_ushort v25, v3, s[8:11], 0 offen offset:640
    buffer_load_ushort v16, v1, s[4:7], 0 offen offset:768
    buffer_load_ushort v26, v3, s[8:11], 0 offen offset:768
    s_waitcnt vmcnt(0)
    v_lshlrev_b32 v10, 16, v10
    v_lshlrev_b32 v20, 16, v20
    v_lshlrev_b32 v11, 16, v11
    v_lshlrev_b32 v21, 16, v21
    v_lshlrev_b32 v12, 16, v12
    v_lshlrev_b32 v22, 16, v22
    v_lshlrev_b32 v13, 16, v13
    v_lshlrev_b32 v23, 16, v23
    v_lshlrev_b32 v14, 16, v14
    v_lshlrev_b32 v24, 16, v24
    v_lshlrev_b32 v15, 16, v15
    v_lshlrev_b32 v25, 16, v25
    v_lshlrev_b32 v16, 16, v16
    v_lshlrev_b32 v26, 16, v26
    v_mov_b32 v60, v10
    v_add_f32 v60, v60, v11
    v_add_f32 v60, v60, v12
    v_add_f32 v60, v60, v13
    v_add_f32 v60, v60, v14
    v_add_f32 v60, v60, v15
    v_add_f32 v60, v60, v16
    ds_swizzle_b32 v61, v60 offset:1055
    s_waitcnt lgkmcnt(0)
    v_add_f32 v60, v60, v61
    ds_swizzle_b32 v61, v60 offset:2079
    s_waitcnt lgkmcnt(0)
    v_add_f32 v60, v60, v61
    ds_swizzle_b32 v61, v60 offset:4127
    s_waitcnt lgkmcnt(0)
    v_add_f32 v60, v60, v61
    ds_swizzle_b32 v61, v60 offset:8223
    s_waitcnt lgkmcnt(0)
    v_add_f32 v60, v60, v61
    ds_swizzle_b32 v61, v60 offset:16415
    s_waitcnt lgkmcnt(0)
    v_add_f32 v60, v60, v61
    s_nop 0
    v_readlane_b32 s30, v60, 0
    v_readlane_b32 s31, v60, 32
    s_nop 1
    v_mov_b32 v60, s30
    v_add_f32 v60, s31, v60
    v_mul_f32 v60, 0x3b124925, v60
    v_mov_b32 v62, 0
    v_sub_f32 v63, v10, v60
    v_fmac_f32 v62, v63, v63
    v_sub_f32 v63, v11, v60
    v_fmac_f32 v62, v63, v63
    v_sub_f32 v63, v12, v60
    v_fmac_f32 v62, v63, v63
    v_sub_f32 v63, v13, v60
    v_fmac_f32 v62, v63, v63
    v_sub_f32 v63, v14, v60
    v_fmac_f32 v62, v63, v63
    v_sub_f32 v63, v15, v60
    v_fmac_f32 v62, v63, v63
    v_sub_f32 v63, v16, v60
    v_fmac_f32 v62, v63, v63
    ds_swizzle_b32 v63, v62 offset:1055
    s_waitcnt lgkmcnt(0)
    v_add_f32 v62, v62, v63
    ds_swizzle_b32 v63, v62 offset:2079
    s_waitcnt lgkmcnt(0)
    v_add_f32 v62, v62, v63
    ds_swizzle_b32 v63, v62 offset:4127
    s_waitcnt lgkmcnt(0)
    v_add_f32 v62, v62, v63
    ds_swizzle_b32 v63, v62 offset:8223
    s_waitcnt lgkmcnt(0)
    v_add_f32 v62, v62, v63
    ds_swizzle_b32 v63, v62 offset:16415
    s_waitcnt lgkmcnt(0)
    v_add_f32 v62, v62, v63
    s_nop 0
    v_readlane_b32 s30, v62, 0
    v_readlane_b32 s31, v62, 32
    s_nop 1
    v_mov_b32 v62, s30
    v_add_f32 v62, s31, v62
    v_mul_f32 v62, 0x3b124925, v62
    v_cvt_pk_bf16_f32 v62, v62, v62
    v_lshlrev_b32 v62, 16, v62
    v_cvt_pk_bf16_f32 v60, v60, v60
    v_lshlrev_b32 v60, 16, v60
    v_add_f32 v62, 0x3727c5ac, v62
    v_cvt_pk_bf16_f32 v62, v62, v62
    v_lshlrev_b32 v62, 16, v62
    v_sqrt_f32 v62, v62
    s_nop 0
    v_cvt_pk_bf16_f32 v62, v62, v62
    v_lshlrev_b32 v62, 16, v62
    v_rcp_f32 v62, v62
    s_nop 0
    v_sub_f32 v63, v10, v60
    v_cvt_pk_bf16_f32 v63, v63, v63
    v_lshlrev_b32 v63, 16, v63
    v_mul_f32 v63, v63, v62
    v_cvt_pk_bf16_f32 v30, v63, v63
    v_lshlrev_b32 v30, 16, v30
    v_sub_f32 v63, v11, v60
    v_cvt_pk_bf16_f32 v63, v63, v63
    v_lshlrev_b32 v63, 16, v63
    v_mul_f32 v63, v63, v62
    v_cvt_pk_bf16_f32 v31, v63, v63
    v_lshlrev_b32 v31, 16, v31
    v_sub_f32 v63, v12, v60
    v_cvt_pk_bf16_f32 v63, v63, v63
    v_lshlrev_b32 v63, 16, v63
    v_mul_f32 v63, v63, v62
    v_cvt_pk_bf16_f32 v32, v63, v63
    v_lshlrev_b32 v32, 16, v32
    v_sub_f32 v63, v13, v60
    v_cvt_pk_bf16_f32 v63, v63, v63
    v_lshlrev_b32 v63, 16, v63
    v_mul_f32 v63, v63, v62
    v_cvt_pk_bf16_f32 v33, v63, v63
    v_lshlrev_b32 v33, 16, v33
    v_sub_f32 v63, v14, v60
    v_cvt_pk_bf16_f32 v63, v63, v63
    v_lshlrev_b32 v63, 16, v63
    v_mul_f32 v63, v63, v62
    v_cvt_pk_bf16_f32 v34, v63, v63
    v_lshlrev_b32 v34, 16, v34
    v_sub_f32 v63, v15, v60
    v_cvt_pk_bf16_f32 v63, v63, v63
    v_lshlrev_b32 v63, 16, v63
    v_mul_f32 v63, v63, v62
    v_cvt_pk_bf16_f32 v35, v63, v63
    v_lshlrev_b32 v35, 16, v35
    v_sub_f32 v63, v16, v60
    v_cvt_pk_bf16_f32 v63, v63, v63
    v_lshlrev_b32 v63, 16, v63
    v_mul_f32 v63, v63, v62
    v_cvt_pk_bf16_f32 v36, v63, v63
    v_lshlrev_b32 v36, 16, v36
    v_mul_f32 v30, v30, v20
    v_cvt_pk_bf16_f32 v30, v30, v30
    v_lshlrev_b32 v30, 16, v30
    v_add_f32 v10, v10, v30
    v_cvt_pk_bf16_f32 v10, v10, v10
    v_lshlrev_b32 v10, 16, v10
    v_mul_f32 v31, v31, v21
    v_cvt_pk_bf16_f32 v31, v31, v31
    v_lshlrev_b32 v31, 16, v31
    v_add_f32 v11, v11, v31
    v_cvt_pk_bf16_f32 v11, v11, v11
    v_lshlrev_b32 v11, 16, v11
    v_mul_f32 v32, v32, v22
    v_cvt_pk_bf16_f32 v32, v32, v32
    v_lshlrev_b32 v32, 16, v32
    v_add_f32 v12, v12, v32
    v_cvt_pk_bf16_f32 v12, v12, v12
    v_lshlrev_b32 v12, 16, v12
    v_mul_f32 v33, v33, v23
    v_cvt_pk_bf16_f32 v33, v33, v33
    v_lshlrev_b32 v33, 16, v33
    v_add_f32 v13, v13, v33
    v_cvt_pk_bf16_f32 v13, v13, v13
    v_lshlrev_b32 v13, 16, v13
    v_mul_f32 v34, v34, v24
    v_cvt_pk_bf16_f32 v34, v34, v34
    v_lshlrev_b32 v34, 16, v34
    v_add_f32 v14, v14, v34
    v_cvt_pk_bf16_f32 v14, v14, v14
    v_lshlrev_b32 v14, 16, v14
    v_mul_f32 v35, v35, v25
    v_cvt_pk_bf16_f32 v35, v35, v35
    v_lshlrev_b32 v35, 16, v35
    v_add_f32 v15, v15, v35
    v_cvt_pk_bf16_f32 v15, v15, v15
    v_lshlrev_b32 v15, 16, v15
    v_mul_f32 v36, v36, v26
    v_cvt_pk_bf16_f32 v36, v36, v36
    v_lshlrev_b32 v36, 16, v36
    v_add_f32 v16, v16, v36
    v_cvt_pk_bf16_f32 v16, v16, v16
    v_lshlrev_b32 v16, 16, v16
    v_mov_b32 v60, v10
    v_add_f32 v60, v60, v11
    v_add_f32 v60, v60, v12
    v_add_f32 v60, v60, v13
    v_add_f32 v60, v60, v14
    v_add_f32 v60, v60, v15
    v_add_f32 v60, v60, v16
    ds_swizzle_b32 v61, v60 offset:1055
    s_waitcnt lgkmcnt(0)
    v_add_f32 v60, v60, v61
    ds_swizzle_b32 v61, v60 offset:2079
    s_waitcnt lgkmcnt(0)
    v_add_f32 v60, v60, v61
    ds_swizzle_b32 v61, v60 offset:4127
    s_waitcnt lgkmcnt(0)
    v_add_f32 v60, v60, v61
    ds_swizzle_b32 v61, v60 offset:8223
    s_waitcnt lgkmcnt(0)
    v_add_f32 v60, v60, v61
    ds_swizzle_b32 v61, v60 offset:16415
    s_waitcnt lgkmcnt(0)
    v_add_f32 v60, v60, v61
    s_nop 0
    v_readlane_b32 s30, v60, 0
    v_readlane_b32 s31, v60, 32
    s_nop 1
    v_mov_b32 v60, s30
    v_add_f32 v60, s31, v60
    v_mul_f32 v60, 0x3b124925, v60
    v_mov_b32 v62, 0
    v_sub_f32 v63, v10, v60
    v_fmac_f32 v62, v63, v63
    v_sub_f32 v63, v11, v60
    v_fmac_f32 v62, v63, v63
    v_sub_f32 v63, v12, v60
    v_fmac_f32 v62, v63, v63
    v_sub_f32 v63, v13, v60
    v_fmac_f32 v62, v63, v63
    v_sub_f32 v63, v14, v60
    v_fmac_f32 v62, v63, v63
    v_sub_f32 v63, v15, v60
    v_fmac_f32 v62, v63, v63
    v_sub_f32 v63, v16, v60
    v_fmac_f32 v62, v63, v63
    ds_swizzle_b32 v63, v62 offset:1055
    s_waitcnt lgkmcnt(0)
    v_add_f32 v62, v62, v63
    ds_swizzle_b32 v63, v62 offset:2079
    s_waitcnt lgkmcnt(0)
    v_add_f32 v62, v62, v63
    ds_swizzle_b32 v63, v62 offset:4127
    s_waitcnt lgkmcnt(0)
    v_add_f32 v62, v62, v63
    ds_swizzle_b32 v63, v62 offset:8223
    s_waitcnt lgkmcnt(0)
    v_add_f32 v62, v62, v63
    ds_swizzle_b32 v63, v62 offset:16415
    s_waitcnt lgkmcnt(0)
    v_add_f32 v62, v62, v63
    s_nop 0
    v_readlane_b32 s30, v62, 0
    v_readlane_b32 s31, v62, 32
    s_nop 1
    v_mov_b32 v62, s30
    v_add_f32 v62, s31, v62
    v_mul_f32 v62, 0x3b124925, v62
    v_cvt_pk_bf16_f32 v62, v62, v62
    v_lshlrev_b32 v62, 16, v62
    v_cvt_pk_bf16_f32 v60, v60, v60
    v_lshlrev_b32 v60, 16, v60
    v_add_f32 v62, 0x3727c5ac, v62
    v_cvt_pk_bf16_f32 v62, v62, v62
    v_lshlrev_b32 v62, 16, v62
    v_sqrt_f32 v62, v62
    s_nop 0
    v_cvt_pk_bf16_f32 v62, v62, v62
    v_lshlrev_b32 v62, 16, v62
    v_rcp_f32 v62, v62
    s_nop 0
    v_sub_f32 v63, v10, v60
    v_cvt_pk_bf16_f32 v63, v63, v63
    v_lshlrev_b32 v63, 16, v63
    v_mul_f32 v63, v63, v62
    v_cvt_pk_bf16_f32 v30, v63, v63
    v_lshlrev_b32 v30, 16, v30
    v_sub_f32 v63, v11, v60
    v_cvt_pk_bf16_f32 v63, v63, v63
    v_lshlrev_b32 v63, 16, v63
    v_mul_f32 v63, v63, v62
    v_cvt_pk_bf16_f32 v31, v63, v63
    v_lshlrev_b32 v31, 16, v31
    v_sub_f32 v63, v12, v60
    v_cvt_pk_bf16_f32 v63, v63, v63
    v_lshlrev_b32 v63, 16, v63
    v_mul_f32 v63, v63, v62
    v_cvt_pk_bf16_f32 v32, v63, v63
    v_lshlrev_b32 v32, 16, v32
    v_sub_f32 v63, v13, v60
    v_cvt_pk_bf16_f32 v63, v63, v63
    v_lshlrev_b32 v63, 16, v63
    v_mul_f32 v63, v63, v62
    v_cvt_pk_bf16_f32 v33, v63, v63
    v_lshlrev_b32 v33, 16, v33
    v_sub_f32 v63, v14, v60
    v_cvt_pk_bf16_f32 v63, v63, v63
    v_lshlrev_b32 v63, 16, v63
    v_mul_f32 v63, v63, v62
    v_cvt_pk_bf16_f32 v34, v63, v63
    v_lshlrev_b32 v34, 16, v34
    v_sub_f32 v63, v15, v60
    v_cvt_pk_bf16_f32 v63, v63, v63
    v_lshlrev_b32 v63, 16, v63
    v_mul_f32 v63, v63, v62
    v_cvt_pk_bf16_f32 v35, v63, v63
    v_lshlrev_b32 v35, 16, v35
    v_sub_f32 v63, v16, v60
    v_cvt_pk_bf16_f32 v63, v63, v63
    v_lshlrev_b32 v63, 16, v63
    v_mul_f32 v63, v63, v62
    v_cvt_pk_bf16_f32 v36, v63, v63
    v_lshlrev_b32 v36, 16, v36
    v_add_u32 v3, 16515072, v1
    v_add_u32 v4, 18350080, v1
    v_lshrrev_b32 v10, 16, v10
    v_lshrrev_b32 v30, 16, v30
    buffer_store_short v10, v3, s[8:11], 0 offen offset:0
    buffer_store_short v30, v4, s[8:11], 0 offen offset:0
    v_lshrrev_b32 v11, 16, v11
    v_lshrrev_b32 v31, 16, v31
    buffer_store_short v11, v3, s[8:11], 0 offen offset:128
    buffer_store_short v31, v4, s[8:11], 0 offen offset:128
    v_lshrrev_b32 v12, 16, v12
    v_lshrrev_b32 v32, 16, v32
    buffer_store_short v12, v3, s[8:11], 0 offen offset:256
    buffer_store_short v32, v4, s[8:11], 0 offen offset:256
    v_lshrrev_b32 v13, 16, v13
    v_lshrrev_b32 v33, 16, v33
    buffer_store_short v13, v3, s[8:11], 0 offen offset:384
    buffer_store_short v33, v4, s[8:11], 0 offen offset:384
    v_lshrrev_b32 v14, 16, v14
    v_lshrrev_b32 v34, 16, v34
    buffer_store_short v14, v3, s[8:11], 0 offen offset:512
    buffer_store_short v34, v4, s[8:11], 0 offen offset:512
    v_lshrrev_b32 v15, 16, v15
    v_lshrrev_b32 v35, 16, v35
    buffer_store_short v15, v3, s[8:11], 0 offen offset:640
    buffer_store_short v35, v4, s[8:11], 0 offen offset:640
    v_lshrrev_b32 v16, 16, v16
    v_lshrrev_b32 v36, 16, v36
    buffer_store_short v16, v3, s[8:11], 0 offen offset:768
    buffer_store_short v36, v4, s[8:11], 0 offen offset:768
rowb_kernel_end:
    s_endpgm
.globl qkv_kernel
.p2align 8
.type qkv_kernel,@function
qkv_kernel:
    s_cmp_ge_u32 s2, 3072
    s_cbranch_scc1 qkv_kernel_end
    s_load_dwordx2 s[8:9], s[0:1], 120
    s_waitcnt lgkmcnt(0)
    s_mov_b32 s10, 111149056
    s_mov_b32 s11, 0x00020000
    v_lshrrev_b32 v1, 6, v0
    s_nop 0
    v_readfirstlane_b32 s3, v1
    s_lshl_b32 s4, s2, 2
    s_add_u32 s3, s3, s4
    s_lshr_b32 s5, s3, 6
    s_and_b32 s6, s3, 63
    v_and_b32 v1, 15, v0
    v_bfe_u32 v2, v0, 4, 2
    s_mul_i32 s7, s5, 64
    s_mul_i32 s16, s6, 32
    v_add_u32 v3, s7, v1
    v_mul_u32_u24 v3, 896, v3
    v_lshl_add_u32 v3, v2, 4, v3
    v_add_u32 v3, 0, v3
    v_add_u32 v4, s16, v1
    v_mul_u32_u24 v4, 896, v4
    v_lshl_add_u32 v4, v2, 4, v4
    v_add_u32 v4, 18350080, v4
    v_mov_b32 v64, 0
    v_mov_b32 v65, 0
    v_mov_b32 v66, 0
    v_mov_b32 v67, 0
    v_mov_b32 v68, 0
    v_mov_b32 v69, 0
    v_mov_b32 v70, 0
    v_mov_b32 v71, 0
    v_mov_b32 v72, 0
    v_mov_b32 v73, 0
    v_mov_b32 v74, 0
    v_mov_b32 v75, 0
    v_mov_b32 v76, 0
    v_mov_b32 v77, 0
    v_mov_b32 v78, 0
    v_mov_b32 v79, 0
    v_mov_b32 v80, 0
    v_mov_b32 v81, 0
    v_mov_b32 v82, 0
    v_mov_b32 v83, 0
    v_mov_b32 v84, 0
    v_mov_b32 v85, 0
    v_mov_b32 v86, 0
    v_mov_b32 v87, 0
    v_mov_b32 v88, 0
    v_mov_b32 v89, 0
    v_mov_b32 v90, 0
    v_mov_b32 v91, 0
    v_mov_b32 v92, 0
    v_mov_b32 v93, 0
    v_mov_b32 v94, 0
    v_mov_b32 v95, 0
    s_mov_b32 s17, 0
qkv_kernel_k:
    s_add_u32 s18, s17, 0
    buffer_load_dwordx4 v[16:19], v3, s[8:11], s18 offen
    s_add_u32 s18, s17, 14336
    buffer_load_dwordx4 v[20:23], v3, s[8:11], s18 offen
    s_add_u32 s18, s17, 28672
    buffer_load_dwordx4 v[24:27], v3, s[8:11], s18 offen
    s_add_u32 s18, s17, 43008
    buffer_load_dwordx4 v[28:31], v3, s[8:11], s18 offen
    s_add_u32 s18, s17, 0
    buffer_load_dwordx4 v[40:43], v4, s[8:11], s18 offen
    s_add_u32 s18, s17, 14336
    buffer_load_dwordx4 v[44:47], v4, s[8:11], s18 offen
    s_waitcnt vmcnt(0)
    v_mfma_f32_16x16x32_bf16 v[64:67], v[16:19], v[40:43], v[64:67]
    v_mfma_f32_16x16x32_bf16 v[68:71], v[16:19], v[44:47], v[68:71]
    v_mfma_f32_16x16x32_bf16 v[72:75], v[20:23], v[40:43], v[72:75]
    v_mfma_f32_16x16x32_bf16 v[76:79], v[20:23], v[44:47], v[76:79]
    v_mfma_f32_16x16x32_bf16 v[80:83], v[24:27], v[40:43], v[80:83]
    v_mfma_f32_16x16x32_bf16 v[84:87], v[24:27], v[44:47], v[84:87]
    v_mfma_f32_16x16x32_bf16 v[88:91], v[28:31], v[40:43], v[88:91]
    v_mfma_f32_16x16x32_bf16 v[92:95], v[28:31], v[44:47], v[92:95]
    s_add_u32 s17, s17, 64
    s_cmp_lt_u32 s17, 896
    s_cbranch_scc1 qkv_kernel_k
    s_nop 7
    s_nop 7
    v_add_u32 v5, s16, v1
    v_mul_u32_u24 v5, 24576, v5
    v_lshl_add_u32 v5, v2, 3, v5
    s_lshl_b32 s7, s7, 1
    v_add_u32 v5, s7, v5
    v_cvt_pk_bf16_f32 v6, v64, v65
    v_cvt_pk_bf16_f32 v7, v66, v67
    v_add_u32 v10, 20185088, v5
    buffer_store_dwordx2 v[6:7], v10, s[8:11], 0 offen
    s_nop 1
    v_cvt_pk_bf16_f32 v6, v68, v69
    v_cvt_pk_bf16_f32 v7, v70, v71
    v_add_u32 v10, 20578304, v5
    buffer_store_dwordx2 v[6:7], v10, s[8:11], 0 offen
    s_nop 1
    v_cvt_pk_bf16_f32 v6, v72, v73
    v_cvt_pk_bf16_f32 v7, v74, v75
    v_add_u32 v10, 20185120, v5
    buffer_store_dwordx2 v[6:7], v10, s[8:11], 0 offen
    s_nop 1
    v_cvt_pk_bf16_f32 v6, v76, v77
    v_cvt_pk_bf16_f32 v7, v78, v79
    v_add_u32 v10, 20578336, v5
    buffer_store_dwordx2 v[6:7], v10, s[8:11], 0 offen
    s_nop 1
    v_cvt_pk_bf16_f32 v6, v80, v81
    v_cvt_pk_bf16_f32 v7, v82, v83
    v_add_u32 v10, 20185152, v5
    buffer_store_dwordx2 v[6:7], v10, s[8:11], 0 offen
    s_nop 1
    v_cvt_pk_bf16_f32 v6, v84, v85
    v_cvt_pk_bf16_f32 v7, v86, v87
    v_add_u32 v10, 20578368, v5
    buffer_store_dwordx2 v[6:7], v10, s[8:11], 0 offen
    s_nop 1
    v_cvt_pk_bf16_f32 v6, v88, v89
    v_cvt_pk_bf16_f32 v7, v90, v91
    v_add_u32 v10, 20185184, v5
    buffer_store_dwordx2 v[6:7], v10, s[8:11], 0 offen
    s_nop 1
    v_cvt_pk_bf16_f32 v6, v92, v93
    v_cvt_pk_bf16_f32 v7, v94, v95
    v_add_u32 v10, 20578400, v5
    buffer_store_dwordx2 v[6:7], v10, s[8:11], 0 offen
    s_nop 1
qkv_kernel_end:
    s_endpgm
.globl woa_kernel
.p2align 8
.type woa_kernel,@function
woa_kernel:
    s_cmp_ge_u32 s2, 448
    s_cbranch_scc1 woa_kernel_end
    s_load_dwordx2 s[8:9], s[0:1], 120
    s_waitcnt lgkmcnt(0)
    s_mov_b32 s10, 111149056
    s_mov_b32 s11, 0x00020000
    v_lshrrev_b32 v1, 6, v0
    s_nop 0
    v_readfirstlane_b32 s3, v1
    s_lshl_b32 s4, s2, 2
    s_add_u32 s3, s3, s4
    s_lshr_b32 s5, s3, 7
    s_and_b32 s6, s3, 127
    v_and_b32 v1, 15, v0
    v_bfe_u32 v2, v0, 4, 2
    s_mul_i32 s7, s5, 32
    s_mul_i32 s16, s6, 16
    v_add_u32 v3, s7, v1
    v_mul_u32_u24 v3, 8192, v3
    v_lshl_add_u32 v3, v2, 4, v3
    v_add_u32 v3, 11010048, v3
    v_add_u32 v4, s16, v1
    v_mul_u32_u24 v4, 8192, v4
    v_lshl_add_u32 v4, v2, 4, v4
    v_add_u32 v4, 78905344, v4
    v_mov_b32 v64, 0
    v_mov_b32 v65, 0
    v_mov_b32 v66, 0
    v_mov_b32 v67, 0
    v_mov_b32 v68, 0
    v_mov_b32 v69, 0
    v_mov_b32 v70, 0
    v_mov_b32 v71, 0
    s_mov_b32 s17, 0
woa_kernel_k:
    s_add_u32 s18, s17, 0
    buffer_load_dwordx4 v[16:19], v3, s[8:11], s18 offen
    s_add_u32 s18, s17, 131072
    buffer_load_dwordx4 v[20:23], v3, s[8:11], s18 offen
    s_add_u32 s18, s17, 0
    buffer_load_dwordx4 v[40:43], v4, s[8:11], s18 offen
    s_waitcnt vmcnt(0)
    v_mfma_f32_16x16x32_bf16 v[64:67], v[16:19], v[40:43], v[64:67]
    v_mfma_f32_16x16x32_bf16 v[68:71], v[20:23], v[40:43], v[68:71]
    s_add_u32 s17, s17, 64
    s_cmp_lt_u32 s17, 8192
    s_cbranch_scc1 woa_kernel_k
    s_nop 7
    s_nop 7
    v_add_u32 v5, s16, v1
    v_mul_u32_u24 v5, 896, v5
    v_lshl_add_u32 v5, v2, 3, v5
    s_lshl_b32 s7, s7, 1
    v_add_u32 v5, s7, v5
    v_cvt_pk_bf16_f32 v6, v64, v65
    v_cvt_pk_bf16_f32 v7, v66, v67
    v_add_u32 v10, 16515072, v5
    buffer_load_dwordx2 v[8:9], v10, s[8:11], 0 offen
    s_waitcnt vmcnt(0)
    v_lshlrev_b32 v12, 16, v6
    v_and_b32 v13, 0xffff0000, v6
    v_lshlrev_b32 v14, 16, v8
    v_and_b32 v15, 0xffff0000, v8
    v_add_f32 v12, v12, v14
    v_add_f32 v13, v13, v15
    v_cvt_pk_bf16_f32 v6, v12, v13
    v_lshlrev_b32 v12, 16, v7
    v_and_b32 v13, 0xffff0000, v7
    v_lshlrev_b32 v14, 16, v9
    v_and_b32 v15, 0xffff0000, v9
    v_add_f32 v12, v12, v14
    v_add_f32 v13, v13, v15
    v_cvt_pk_bf16_f32 v7, v12, v13
    buffer_store_dwordx2 v[6:7], v10, s[8:11], 0 offen
    s_nop 1
    v_cvt_pk_bf16_f32 v6, v68, v69
    v_cvt_pk_bf16_f32 v7, v70, v71
    v_add_u32 v10, 16515104, v5
    buffer_load_dwordx2 v[8:9], v10, s[8:11], 0 offen
    s_waitcnt vmcnt(0)
    v_lshlrev_b32 v12, 16, v6
    v_and_b32 v13, 0xffff0000, v6
    v_lshlrev_b32 v14, 16, v8
    v_and_b32 v15, 0xffff0000, v8
    v_add_f32 v12, v12, v14
    v_add_f32 v13, v13, v15
    v_cvt_pk_bf16_f32 v6, v12, v13
    v_lshlrev_b32 v12, 16, v7
    v_and_b32 v13, 0xffff0000, v7
    v_lshlrev_b32 v14, 16, v9
    v_and_b32 v15, 0xffff0000, v9
    v_add_f32 v12, v12, v14
    v_add_f32 v13, v13, v15
    v_cvt_pk_bf16_f32 v7, v12, v13
    buffer_store_dwordx2 v[6:7], v10, s[8:11], 0 offen
    s_nop 1
woa_kernel_end:
    s_endpgm
.globl wob_kernel
.p2align 8
.type wob_kernel,@function
wob_kernel:
    s_cmp_ge_u32 s2, 448
    s_cbranch_scc1 wob_kernel_end
    s_load_dwordx2 s[8:9], s[0:1], 120
    s_waitcnt lgkmcnt(0)
    s_mov_b32 s10, 111149056
    s_mov_b32 s11, 0x00020000
    s_load_dwordx2 s[12:13], s[0:1], 104
    s_waitcnt lgkmcnt(0)
    s_mov_b32 s14, 1835008
    s_mov_b32 s15, 0x00020000
    v_lshrrev_b32 v1, 6, v0
    s_nop 0
    v_readfirstlane_b32 s3, v1
    s_lshl_b32 s4, s2, 2
    s_add_u32 s3, s3, s4
    s_lshr_b32 s5, s3, 7
    s_and_b32 s6, s3, 127
    v_and_b32 v1, 15, v0
    v_bfe_u32 v2, v0, 4, 2
    s_mul_i32 s7, s5, 32
    s_mul_i32 s16, s6, 16
    v_add_u32 v3, s7, v1
    v_mul_u32_u24 v3, 8192, v3
    v_lshl_add_u32 v3, v2, 4, v3
    v_add_u32 v3, 11010048, v3
    v_add_u32 v4, s16, v1
    v_mul_u32_u24 v4, 8192, v4
    v_lshl_add_u32 v4, v2, 4, v4
    v_add_u32 v4, 78905344, v4
    v_mov_b32 v64, 0
    v_mov_b32 v65, 0
    v_mov_b32 v66, 0
    v_mov_b32 v67, 0
    v_mov_b32 v68, 0
    v_mov_b32 v69, 0
    v_mov_b32 v70, 0
    v_mov_b32 v71, 0
    s_mov_b32 s17, 0
wob_kernel_k:
    s_add_u32 s18, s17, 0
    buffer_load_dwordx4 v[16:19], v3, s[8:11], s18 offen
    s_add_u32 s18, s17, 131072
    buffer_load_dwordx4 v[20:23], v3, s[8:11], s18 offen
    s_add_u32 s18, s17, 0
    buffer_load_dwordx4 v[40:43], v4, s[8:11], s18 offen
    s_waitcnt vmcnt(0)
    v_mfma_f32_16x16x32_bf16 v[64:67], v[16:19], v[40:43], v[64:67]
    v_mfma_f32_16x16x32_bf16 v[68:71], v[20:23], v[40:43], v[68:71]
    s_add_u32 s17, s17, 64
    s_cmp_lt_u32 s17, 8192
    s_cbranch_scc1 wob_kernel_k
    s_nop 7
    s_nop 7
    v_add_u32 v5, s16, v1
    v_mul_u32_u24 v5, 896, v5
    v_lshl_add_u32 v5, v2, 3, v5
    s_lshl_b32 s7, s7, 1
    v_add_u32 v5, s7, v5
    v_cvt_pk_bf16_f32 v6, v64, v65
    v_cvt_pk_bf16_f32 v7, v66, v67
    v_add_u32 v10, 16515072, v5
    buffer_load_dwordx2 v[8:9], v10, s[8:11], 0 offen
    s_waitcnt vmcnt(0)
    v_lshlrev_b32 v12, 16, v6
    v_and_b32 v13, 0xffff0000, v6
    v_lshlrev_b32 v14, 16, v8
    v_and_b32 v15, 0xffff0000, v8
    v_add_f32 v12, v12, v14
    v_add_f32 v13, v13, v15
    v_cvt_pk_bf16_f32 v6, v12, v13
    v_lshlrev_b32 v12, 16, v7
    v_and_b32 v13, 0xffff0000, v7
    v_lshlrev_b32 v14, 16, v9
    v_and_b32 v15, 0xffff0000, v9
    v_add_f32 v12, v12, v14
    v_add_f32 v13, v13, v15
    v_cvt_pk_bf16_f32 v7, v12, v13
    v_add_u32 v10, 0, v5
    buffer_store_dwordx2 v[6:7], v10, s[12:15], 0 offen
    s_nop 1
    v_cvt_pk_bf16_f32 v6, v68, v69
    v_cvt_pk_bf16_f32 v7, v70, v71
    v_add_u32 v10, 16515104, v5
    buffer_load_dwordx2 v[8:9], v10, s[8:11], 0 offen
    s_waitcnt vmcnt(0)
    v_lshlrev_b32 v12, 16, v6
    v_and_b32 v13, 0xffff0000, v6
    v_lshlrev_b32 v14, 16, v8
    v_and_b32 v15, 0xffff0000, v8
    v_add_f32 v12, v12, v14
    v_add_f32 v13, v13, v15
    v_cvt_pk_bf16_f32 v6, v12, v13
    v_lshlrev_b32 v12, 16, v7
    v_and_b32 v13, 0xffff0000, v7
    v_lshlrev_b32 v14, 16, v9
    v_and_b32 v15, 0xffff0000, v9
    v_add_f32 v12, v12, v14
    v_add_f32 v13, v13, v15
    v_cvt_pk_bf16_f32 v7, v12, v13
    v_add_u32 v10, 32, v5
    buffer_store_dwordx2 v[6:7], v10, s[12:15], 0 offen
    s_nop 1
wob_kernel_end:
    s_endpgm
.globl cha_kernel
.p2align 8
.type cha_kernel,@function
cha_kernel:
    s_cmp_ge_u32 s2, 64
    s_cbranch_scc1 cha_kernel_end
    s_load_dwordx2 s[8:9], s[0:1], 120
    s_waitcnt lgkmcnt(0)
    s_mov_b32 s10, 111149056
    s_mov_b32 s11, 0x00020000
    s_load_dwordx2 s[12:13], s[0:1], 56
    s_waitcnt lgkmcnt(0)
    s_mov_b32 s14, 7168
    s_mov_b32 s15, 0x00020000
    v_lshrrev_b32 v1, 6, v0
    s_nop 0
    v_readfirstlane_b32 s3, v1
    v_and_b32 v63, 63, v0
    v_and_b32 v1, 15, v0
    v_bfe_u32 v2, v0, 4, 2
    s_lshl_b32 s4, s2, 6
    s_lshl_b32 s5, s3, 4
    s_add_u32 s5, s5, s4
    v_add_u32 v3, s5, v1
    v_mul_u32_u24 v3, 896, v3
    v_lshl_add_u32 v3, v2, 4, v3
    v_add_u32 v9, 0, v3
    buffer_load_dwordx4 v[10:13], v9, s[8:11], 0 offen
    s_waitcnt vmcnt(0)
    v_accvgpr_write_b32 a0, v10
    v_accvgpr_write_b32 a1, v11
    v_accvgpr_write_b32 a2, v12
    v_accvgpr_write_b32 a3, v13
    v_add_u32 v9, 64, v3
    buffer_load_dwordx4 v[10:13], v9, s[8:11], 0 offen
    s_waitcnt vmcnt(0)
    v_accvgpr_write_b32 a4, v10
    v_accvgpr_write_b32 a5, v11
    v_accvgpr_write_b32 a6, v12
    v_accvgpr_write_b32 a7, v13
    v_add_u32 v9, 128, v3
    buffer_load_dwordx4 v[10:13], v9, s[8:11], 0 offen
    s_waitcnt vmcnt(0)
    v_accvgpr_write_b32 a8, v10
    v_accvgpr_write_b32 a9, v11
    v_accvgpr_write_b32 a10, v12
    v_accvgpr_write_b32 a11, v13
    v_add_u32 v9, 192, v3
    buffer_load_dwordx4 v[10:13], v9, s[8:11], 0 offen
    s_waitcnt vmcnt(0)
    v_accvgpr_write_b32 a12, v10
    v_accvgpr_write_b32 a13, v11
    v_accvgpr_write_b32 a14, v12
    v_accvgpr_write_b32 a15, v13
    v_add_u32 v9, 256, v3
    buffer_load_dwordx4 v[10:13], v9, s[8:11], 0 offen
    s_waitcnt vmcnt(0)
    v_accvgpr_write_b32 a16, v10
    v_accvgpr_write_b32 a17, v11
    v_accvgpr_write_b32 a18, v12
    v_accvgpr_write_b32 a19, v13
    v_add_u32 v9, 320, v3
    buffer_load_dwordx4 v[10:13], v9, s[8:11], 0 offen
    s_waitcnt vmcnt(0)
    v_accvgpr_write_b32 a20, v10
    v_accvgpr_write_b32 a21, v11
    v_accvgpr_write_b32 a22, v12
    v_accvgpr_write_b32 a23, v13
    v_add_u32 v9, 384, v3
    buffer_load_dwordx4 v[10:13], v9, s[8:11], 0 offen
    s_waitcnt vmcnt(0)
    v_accvgpr_write_b32 a24, v10
    v_accvgpr_write_b32 a25, v11
    v_accvgpr_write_b32 a26, v12
    v_accvgpr_write_b32 a27, v13
    v_add_u32 v9, 448, v3
    buffer_load_dwordx4 v[10:13], v9, s[8:11], 0 offen
    s_waitcnt vmcnt(0)
    v_accvgpr_write_b32 a28, v10
    v_accvgpr_write_b32 a29, v11
    v_accvgpr_write_b32 a30, v12
    v_accvgpr_write_b32 a31, v13
    v_add_u32 v9, 512, v3
    buffer_load_dwordx4 v[10:13], v9, s[8:11], 0 offen
    s_waitcnt vmcnt(0)
    v_accvgpr_write_b32 a32, v10
    v_accvgpr_write_b32 a33, v11
    v_accvgpr_write_b32 a34, v12
    v_accvgpr_write_b32 a35, v13
    v_add_u32 v9, 576, v3
    buffer_load_dwordx4 v[10:13], v9, s[8:11], 0 offen
    s_waitcnt vmcnt(0)
    v_accvgpr_write_b32 a36, v10
    v_accvgpr_write_b32 a37, v11
    v_accvgpr_write_b32 a38, v12
    v_accvgpr_write_b32 a39, v13
    v_add_u32 v9, 640, v3
    buffer_load_dwordx4 v[10:13], v9, s[8:11], 0 offen
    s_waitcnt vmcnt(0)
    v_accvgpr_write_b32 a40, v10
    v_accvgpr_write_b32 a41, v11
    v_accvgpr_write_b32 a42, v12
    v_accvgpr_write_b32 a43, v13
    v_add_u32 v9, 704, v3
    buffer_load_dwordx4 v[10:13], v9, s[8:11], 0 offen
    s_waitcnt vmcnt(0)
    v_accvgpr_write_b32 a44, v10
    v_accvgpr_write_b32 a45, v11
    v_accvgpr_write_b32 a46, v12
    v_accvgpr_write_b32 a47, v13
    v_add_u32 v9, 768, v3
    buffer_load_dwordx4 v[10:13], v9, s[8:11], 0 offen
    s_waitcnt vmcnt(0)
    v_accvgpr_write_b32 a48, v10
    v_accvgpr_write_b32 a49, v11
    v_accvgpr_write_b32 a50, v12
    v_accvgpr_write_b32 a51, v13
    v_add_u32 v9, 832, v3
    buffer_load_dwordx4 v[10:13], v9, s[8:11], 0 offen
    s_waitcnt vmcnt(0)
    v_accvgpr_write_b32 a52, v10
    v_accvgpr_write_b32 a53, v11
    v_accvgpr_write_b32 a54, v12
    v_accvgpr_write_b32 a55, v13
    v_add_u32 v9, 3670016, v3
    buffer_load_dwordx4 v[10:13], v9, s[8:11], 0 offen
    s_waitcnt vmcnt(0)
    v_accvgpr_write_b32 a56, v10
    v_accvgpr_write_b32 a57, v11
    v_accvgpr_write_b32 a58, v12
    v_accvgpr_write_b32 a59, v13
    v_add_u32 v9, 3670080, v3
    buffer_load_dwordx4 v[10:13], v9, s[8:11], 0 offen
    s_waitcnt vmcnt(0)
    v_accvgpr_write_b32 a60, v10
    v_accvgpr_write_b32 a61, v11
    v_accvgpr_write_b32 a62, v12
    v_accvgpr_write_b32 a63, v13
    v_add_u32 v9, 3670144, v3
    buffer_load_dwordx4 v[10:13], v9, s[8:11], 0 offen
    s_waitcnt vmcnt(0)
    v_accvgpr_write_b32 a64, v10
    v_accvgpr_write_b32 a65, v11
    v_accvgpr_write_b32 a66, v12
    v_accvgpr_write_b32 a67, v13
    v_add_u32 v9, 3670208, v3
    buffer_load_dwordx4 v[10:13], v9, s[8:11], 0 offen
    s_waitcnt vmcnt(0)
    v_accvgpr_write_b32 a68, v10
    v_accvgpr_write_b32 a69, v11
    v_accvgpr_write_b32 a70, v12
    v_accvgpr_write_b32 a71, v13
    v_add_u32 v9, 3670272, v3
    buffer_load_dwordx4 v[10:13], v9, s[8:11], 0 offen
    s_waitcnt vmcnt(0)
    v_accvgpr_write_b32 a72, v10
    v_accvgpr_write_b32 a73, v11
    v_accvgpr_write_b32 a74, v12
    v_accvgpr_write_b32 a75, v13
    v_add_u32 v9, 3670336, v3
    buffer_load_dwordx4 v[10:13], v9, s[8:11], 0 offen
    s_waitcnt vmcnt(0)
    v_accvgpr_write_b32 a76, v10
    v_accvgpr_write_b32 a77, v11
    v_accvgpr_write_b32 a78, v12
    v_accvgpr_write_b32 a79, v13
    v_add_u32 v9, 3670400, v3
    buffer_load_dwordx4 v[10:13], v9, s[8:11], 0 offen
    s_waitcnt vmcnt(0)
    v_accvgpr_write_b32 a80, v10
    v_accvgpr_write_b32 a81, v11
    v_accvgpr_write_b32 a82, v12
    v_accvgpr_write_b32 a83, v13
    v_add_u32 v9, 3670464, v3
    buffer_load_dwordx4 v[10:13], v9, s[8:11], 0 offen
    s_waitcnt vmcnt(0)
    v_accvgpr_write_b32 a84, v10
    v_accvgpr_write_b32 a85, v11
    v_accvgpr_write_b32 a86, v12
    v_accvgpr_write_b32 a87, v13
    v_add_u32 v9, 3670528, v3
    buffer_load_dwordx4 v[10:13], v9, s[8:11], 0 offen
    s_waitcnt vmcnt(0)
    v_accvgpr_write_b32 a88, v10
    v_accvgpr_write_b32 a89, v11
    v_accvgpr_write_b32 a90, v12
    v_accvgpr_write_b32 a91, v13
    v_add_u32 v9, 3670592, v3
    buffer_load_dwordx4 v[10:13], v9, s[8:11], 0 offen
    s_waitcnt vmcnt(0)
    v_accvgpr_write_b32 a92, v10
    v_accvgpr_write_b32 a93, v11
    v_accvgpr_write_b32 a94, v12
    v_accvgpr_write_b32 a95, v13
    v_add_u32 v9, 3670656, v3
    buffer_load_dwordx4 v[10:13], v9, s[8:11], 0 offen
    s_waitcnt vmcnt(0)
    v_accvgpr_write_b32 a96, v10
    v_accvgpr_write_b32 a97, v11
    v_accvgpr_write_b32 a98, v12
    v_accvgpr_write_b32 a99, v13
    v_add_u32 v9, 3670720, v3
    buffer_load_dwordx4 v[10:13], v9, s[8:11], 0 offen
    s_waitcnt vmcnt(0)
    v_accvgpr_write_b32 a100, v10
    v_accvgpr_write_b32 a101, v11
    v_accvgpr_write_b32 a102, v12
    v_accvgpr_write_b32 a103, v13
    v_add_u32 v9, 3670784, v3
    buffer_load_dwordx4 v[10:13], v9, s[8:11], 0 offen
    s_waitcnt vmcnt(0)
    v_accvgpr_write_b32 a104, v10
    v_accvgpr_write_b32 a105, v11
    v_accvgpr_write_b32 a106, v12
    v_accvgpr_write_b32 a107, v13
    v_add_u32 v9, 3670848, v3
    buffer_load_dwordx4 v[10:13], v9, s[8:11], 0 offen
    s_waitcnt vmcnt(0)
    v_accvgpr_write_b32 a108, v10
    v_accvgpr_write_b32 a109, v11
    v_accvgpr_write_b32 a110, v12
    v_accvgpr_write_b32 a111, v13
    v_add_u32 v9, 7340032, v3
    buffer_load_dwordx4 v[10:13], v9, s[8:11], 0 offen
    s_waitcnt vmcnt(0)
    v_accvgpr_write_b32 a112, v10
    v_accvgpr_write_b32 a113, v11
    v_accvgpr_write_b32 a114, v12
    v_accvgpr_write_b32 a115, v13
    v_add_u32 v9, 7340096, v3
    buffer_load_dwordx4 v[10:13], v9, s[8:11], 0 offen
    s_waitcnt vmcnt(0)
    v_accvgpr_write_b32 a116, v10
    v_accvgpr_write_b32 a117, v11
    v_accvgpr_write_b32 a118, v12
    v_accvgpr_write_b32 a119, v13
    v_add_u32 v9, 7340160, v3
    buffer_load_dwordx4 v[10:13], v9, s[8:11], 0 offen
    s_waitcnt vmcnt(0)
    v_accvgpr_write_b32 a120, v10
    v_accvgpr_write_b32 a121, v11
    v_accvgpr_write_b32 a122, v12
    v_accvgpr_write_b32 a123, v13
    v_add_u32 v9, 7340224, v3
    buffer_load_dwordx4 v[10:13], v9, s[8:11], 0 offen
    s_waitcnt vmcnt(0)
    v_accvgpr_write_b32 a124, v10
    v_accvgpr_write_b32 a125, v11
    v_accvgpr_write_b32 a126, v12
    v_accvgpr_write_b32 a127, v13
    v_add_u32 v9, 7340288, v3
    buffer_load_dwordx4 v[10:13], v9, s[8:11], 0 offen
    s_waitcnt vmcnt(0)
    v_accvgpr_write_b32 a128, v10
    v_accvgpr_write_b32 a129, v11
    v_accvgpr_write_b32 a130, v12
    v_accvgpr_write_b32 a131, v13
    v_add_u32 v9, 7340352, v3
    buffer_load_dwordx4 v[10:13], v9, s[8:11], 0 offen
    s_waitcnt vmcnt(0)
    v_accvgpr_write_b32 a132, v10
    v_accvgpr_write_b32 a133, v11
    v_accvgpr_write_b32 a134, v12
    v_accvgpr_write_b32 a135, v13
    v_add_u32 v9, 7340416, v3
    buffer_load_dwordx4 v[10:13], v9, s[8:11], 0 offen
    s_waitcnt vmcnt(0)
    v_accvgpr_write_b32 a136, v10
    v_accvgpr_write_b32 a137, v11
    v_accvgpr_write_b32 a138, v12
    v_accvgpr_write_b32 a139, v13
    v_add_u32 v9, 7340480, v3
    buffer_load_dwordx4 v[10:13], v9, s[8:11], 0 offen
    s_waitcnt vmcnt(0)
    v_accvgpr_write_b32 a140, v10
    v_accvgpr_write_b32 a141, v11
    v_accvgpr_write_b32 a142, v12
    v_accvgpr_write_b32 a143, v13
    v_add_u32 v9, 7340544, v3
    buffer_load_dwordx4 v[10:13], v9, s[8:11], 0 offen
    s_waitcnt vmcnt(0)
    v_accvgpr_write_b32 a144, v10
    v_accvgpr_write_b32 a145, v11
    v_accvgpr_write_b32 a146, v12
    v_accvgpr_write_b32 a147, v13
    v_add_u32 v9, 7340608, v3
    buffer_load_dwordx4 v[10:13], v9, s[8:11], 0 offen
    s_waitcnt vmcnt(0)
    v_accvgpr_write_b32 a148, v10
    v_accvgpr_write_b32 a149, v11
    v_accvgpr_write_b32 a150, v12
    v_accvgpr_write_b32 a151, v13
    v_add_u32 v9, 7340672, v3
    buffer_load_dwordx4 v[10:13], v9, s[8:11], 0 offen
    s_waitcnt vmcnt(0)
    v_accvgpr_write_b32 a152, v10
    v_accvgpr_write_b32 a153, v11
    v_accvgpr_write_b32 a154, v12
    v_accvgpr_write_b32 a155, v13
    v_add_u32 v9, 7340736, v3
    buffer_load_dwordx4 v[10:13], v9, s[8:11], 0 offen
    s_waitcnt vmcnt(0)
    v_accvgpr_write_b32 a156, v10
    v_accvgpr_write_b32 a157, v11
    v_accvgpr_write_b32 a158, v12
    v_accvgpr_write_b32 a159, v13
    v_add_u32 v9, 7340800, v3
    buffer_load_dwordx4 v[10:13], v9, s[8:11], 0 offen
    s_waitcnt vmcnt(0)
    v_accvgpr_write_b32 a160, v10
    v_accvgpr_write_b32 a161, v11
    v_accvgpr_write_b32 a162, v12
    v_accvgpr_write_b32 a163, v13
    v_add_u32 v9, 7340864, v3
    buffer_load_dwordx4 v[10:13], v9, s[8:11], 0 offen
    s_waitcnt vmcnt(0)
    v_accvgpr_write_b32 a164, v10
    v_accvgpr_write_b32 a165, v11
    v_accvgpr_write_b32 a166, v12
    v_accvgpr_write_b32 a167, v13
    s_mul_i32 s5, s3, 112
    v_add_u32 v3, s5, v1
    v_lshlrev_b32 v3, 13, v3
    v_lshl_add_u32 v3, v2, 4, v3
    s_lshl_b32 s6, s4, 1
    v_add_u32 v3, s6, v3
    v_add_u32 v9, 11010048, v3
    buffer_load_dwordx4 v[10:13], v9, s[8:11], 0 offen
    s_waitcnt vmcnt(0)
    v_accvgpr_write_b32 a168, v10
    v_accvgpr_write_b32 a169, v11
    v_accvgpr_write_b32 a170, v12
    v_accvgpr_write_b32 a171, v13
    v_add_u32 v9, 11010112, v3
    buffer_load_dwordx4 v[10:13], v9, s[8:11], 0 offen
    s_waitcnt vmcnt(0)
    v_accvgpr_write_b32 a172, v10
    v_accvgpr_write_b32 a173, v11
    v_accvgpr_write_b32 a174, v12
    v_accvgpr_write_b32 a175, v13
    v_add_u32 v9, 11141120, v3
    buffer_load_dwordx4 v[10:13], v9, s[8:11], 0 offen
    s_waitcnt vmcnt(0)
    v_accvgpr_write_b32 a176, v10
    v_accvgpr_write_b32 a177, v11
    v_accvgpr_write_b32 a178, v12
    v_accvgpr_write_b32 a179, v13
    v_add_u32 v9, 11141184, v3
    buffer_load_dwordx4 v[10:13], v9, s[8:11], 0 offen
    s_waitcnt vmcnt(0)
    v_accvgpr_write_b32 a180, v10
    v_accvgpr_write_b32 a181, v11
    v_accvgpr_write_b32 a182, v12
    v_accvgpr_write_b32 a183, v13
    v_add_u32 v9, 11272192, v3
    buffer_load_dwordx4 v[10:13], v9, s[8:11], 0 offen
    s_waitcnt vmcnt(0)
    v_accvgpr_write_b32 a184, v10
    v_accvgpr_write_b32 a185, v11
    v_accvgpr_write_b32 a186, v12
    v_accvgpr_write_b32 a187, v13
    v_add_u32 v9, 11272256, v3
    buffer_load_dwordx4 v[10:13], v9, s[8:11], 0 offen
    s_waitcnt vmcnt(0)
    v_accvgpr_write_b32 a188, v10
    v_accvgpr_write_b32 a189, v11
    v_accvgpr_write_b32 a190, v12
    v_accvgpr_write_b32 a191, v13
    v_add_u32 v9, 11403264, v3
    buffer_load_dwordx4 v[10:13], v9, s[8:11], 0 offen
    s_waitcnt vmcnt(0)
    v_accvgpr_write_b32 a192, v10
    v_accvgpr_write_b32 a193, v11
    v_accvgpr_write_b32 a194, v12
    v_accvgpr_write_b32 a195, v13
    v_add_u32 v9, 11403328, v3
    buffer_load_dwordx4 v[10:13], v9, s[8:11], 0 offen
    s_waitcnt vmcnt(0)
    v_accvgpr_write_b32 a196, v10
    v_accvgpr_write_b32 a197, v11
    v_accvgpr_write_b32 a198, v12
    v_accvgpr_write_b32 a199, v13
    v_add_u32 v9, 11534336, v3
    buffer_load_dwordx4 v[10:13], v9, s[8:11], 0 offen
    s_waitcnt vmcnt(0)
    v_accvgpr_write_b32 a200, v10
    v_accvgpr_write_b32 a201, v11
    v_accvgpr_write_b32 a202, v12
    v_accvgpr_write_b32 a203, v13
    v_add_u32 v9, 11534400, v3
    buffer_load_dwordx4 v[10:13], v9, s[8:11], 0 offen
    s_waitcnt vmcnt(0)
    v_accvgpr_write_b32 a204, v10
    v_accvgpr_write_b32 a205, v11
    v_accvgpr_write_b32 a206, v12
    v_accvgpr_write_b32 a207, v13
    v_add_u32 v9, 11665408, v3
    buffer_load_dwordx4 v[10:13], v9, s[8:11], 0 offen
    s_waitcnt vmcnt(0)
    v_accvgpr_write_b32 a208, v10
    v_accvgpr_write_b32 a209, v11
    v_accvgpr_write_b32 a210, v12
    v_accvgpr_write_b32 a211, v13
    v_add_u32 v9, 11665472, v3
    buffer_load_dwordx4 v[10:13], v9, s[8:11], 0 offen
    s_waitcnt vmcnt(0)
    v_accvgpr_write_b32 a212, v10
    v_accvgpr_write_b32 a213, v11
    v_accvgpr_write_b32 a214, v12
    v_accvgpr_write_b32 a215, v13
    v_add_u32 v9, 11796480, v3
    buffer_load_dwordx4 v[10:13], v9, s[8:11], 0 offen
    s_waitcnt vmcnt(0)
    v_accvgpr_write_b32 a216, v10
    v_accvgpr_write_b32 a217, v11
    v_accvgpr_write_b32 a218, v12
    v_accvgpr_write_b32 a219, v13
    v_add_u32 v9, 11796544, v3
    buffer_load_dwordx4 v[10:13], v9, s[8:11], 0 offen
    s_waitcnt vmcnt(0)
    v_accvgpr_write_b32 a220, v10
    v_accvgpr_write_b32 a221, v11
    v_accvgpr_write_b32 a222, v12
    v_accvgpr_write_b32 a223, v13
    v_lshlrev_b32 v9, 2, v0
    v_add_u32 v8, 0, v9
    buffer_load_dword v10, v8, s[12:15], 0 offen
    s_waitcnt vmcnt(0)
    ds_write_b32 v9, v10 offset:0
    v_add_u32 v8, 1024, v9
    buffer_load_dword v10, v8, s[12:15], 0 offen
    s_waitcnt vmcnt(0)
    ds_write_b32 v9, v10 offset:1024
    v_add_u32 v8, 2048, v9
    buffer_load_dword v10, v8, s[12:15], 0 offen
    s_waitcnt vmcnt(0)
    ds_write_b32 v9, v10 offset:2048
    v_add_u32 v8, 3072, v9
    buffer_load_dword v10, v8, s[12:15], 0 offen
    s_waitcnt vmcnt(0)
    ds_write_b32 v9, v10 offset:3072
    v_add_u32 v8, 4096, v9
    buffer_load_dword v10, v8, s[12:15], 0 offen
    s_waitcnt vmcnt(0)
    ds_write_b32 v9, v10 offset:4096
    v_add_u32 v8, 5120, v9
    buffer_load_dword v10, v8, s[12:15], 0 offen
    s_waitcnt vmcnt(0)
    ds_write_b32 v9, v10 offset:5120
    v_add_u32 v8, 6144, v9
    buffer_load_dword v10, v8, s[12:15], 0 offen
    s_waitcnt vmcnt(0)
    ds_write_b32 v9, v10 offset:6144
    v_and_b32 v4, 7, v1
    v_mul_u32_u24 v4, 896, v4
    v_lshl_add_u32 v4, v2, 4, v4
    v_xor_b32 v60, 16, v63
    v_lshlrev_b32 v60, 2, v60
    v_xor_b32 v61, 32, v63
    v_lshlrev_b32 v61, 2, v61
    s_mov_b32 s20, 0
    s_waitcnt lgkmcnt(0)
    s_barrier
cha_kernel_step:
    v_mov_b32 v32, 0
    v_mov_b32 v33, 0
    v_mov_b32 v34, 0
    v_mov_b32 v35, 0
    v_mov_b32 v36, 0
    v_mov_b32 v37, 0
    v_mov_b32 v38, 0
    v_mov_b32 v39, 0
    v_mov_b32 v40, 0
    v_mov_b32 v41, 0
    v_mov_b32 v42, 0
    v_mov_b32 v43, 0
    ds_read_b128 v[10:13], v4 offset:0
    s_waitcnt lgkmcnt(0)
    v_mfma_f32_16x16x32_bf16 v[32:35], a[0:3], v[10:13], v[32:35]
    v_mfma_f32_16x16x32_bf16 v[36:39], a[56:59], v[10:13], v[36:39]
    v_mfma_f32_16x16x32_bf16 v[40:43], a[112:115], v[10:13], v[40:43]
    ds_read_b128 v[10:13], v4 offset:64
    s_waitcnt lgkmcnt(0)
    v_mfma_f32_16x16x32_bf16 v[32:35], a[4:7], v[10:13], v[32:35]
    v_mfma_f32_16x16x32_bf16 v[36:39], a[60:63], v[10:13], v[36:39]
    v_mfma_f32_16x16x32_bf16 v[40:43], a[116:119], v[10:13], v[40:43]
    ds_read_b128 v[10:13], v4 offset:128
    s_waitcnt lgkmcnt(0)
    v_mfma_f32_16x16x32_bf16 v[32:35], a[8:11], v[10:13], v[32:35]
    v_mfma_f32_16x16x32_bf16 v[36:39], a[64:67], v[10:13], v[36:39]
    v_mfma_f32_16x16x32_bf16 v[40:43], a[120:123], v[10:13], v[40:43]
    ds_read_b128 v[10:13], v4 offset:192
    s_waitcnt lgkmcnt(0)
    v_mfma_f32_16x16x32_bf16 v[32:35], a[12:15], v[10:13], v[32:35]
    v_mfma_f32_16x16x32_bf16 v[36:39], a[68:71], v[10:13], v[36:39]
    v_mfma_f32_16x16x32_bf16 v[40:43], a[124:127], v[10:13], v[40:43]
    ds_read_b128 v[10:13], v4 offset:256
    s_waitcnt lgkmcnt(0)
    v_mfma_f32_16x16x32_bf16 v[32:35], a[16:19], v[10:13], v[32:35]
    v_mfma_f32_16x16x32_bf16 v[36:39], a[72:75], v[10:13], v[36:39]
    v_mfma_f32_16x16x32_bf16 v[40:43], a[128:131], v[10:13], v[40:43]
    ds_read_b128 v[10:13], v4 offset:320
    s_waitcnt lgkmcnt(0)
    v_mfma_f32_16x16x32_bf16 v[32:35], a[20:23], v[10:13], v[32:35]
    v_mfma_f32_16x16x32_bf16 v[36:39], a[76:79], v[10:13], v[36:39]
    v_mfma_f32_16x16x32_bf16 v[40:43], a[132:135], v[10:13], v[40:43]
    ds_read_b128 v[10:13], v4 offset:384
    s_waitcnt lgkmcnt(0)
    v_mfma_f32_16x16x32_bf16 v[32:35], a[24:27], v[10:13], v[32:35]
    v_mfma_f32_16x16x32_bf16 v[36:39], a[80:83], v[10:13], v[36:39]
    v_mfma_f32_16x16x32_bf16 v[40:43], a[136:139], v[10:13], v[40:43]
    ds_read_b128 v[10:13], v4 offset:448
    s_waitcnt lgkmcnt(0)
    v_mfma_f32_16x16x32_bf16 v[32:35], a[28:31], v[10:13], v[32:35]
    v_mfma_f32_16x16x32_bf16 v[36:39], a[84:87], v[10:13], v[36:39]
    v_mfma_f32_16x16x32_bf16 v[40:43], a[140:143], v[10:13], v[40:43]
    ds_read_b128 v[10:13], v4 offset:512
    s_waitcnt lgkmcnt(0)
    v_mfma_f32_16x16x32_bf16 v[32:35], a[32:35], v[10:13], v[32:35]
    v_mfma_f32_16x16x32_bf16 v[36:39], a[88:91], v[10:13], v[36:39]
    v_mfma_f32_16x16x32_bf16 v[40:43], a[144:147], v[10:13], v[40:43]
    ds_read_b128 v[10:13], v4 offset:576
    s_waitcnt lgkmcnt(0)
    v_mfma_f32_16x16x32_bf16 v[32:35], a[36:39], v[10:13], v[32:35]
    v_mfma_f32_16x16x32_bf16 v[36:39], a[92:95], v[10:13], v[36:39]
    v_mfma_f32_16x16x32_bf16 v[40:43], a[148:151], v[10:13], v[40:43]
    ds_read_b128 v[10:13], v4 offset:640
    s_waitcnt lgkmcnt(0)
    v_mfma_f32_16x16x32_bf16 v[32:35], a[40:43], v[10:13], v[32:35]
    v_mfma_f32_16x16x32_bf16 v[36:39], a[96:99], v[10:13], v[36:39]
    v_mfma_f32_16x16x32_bf16 v[40:43], a[152:155], v[10:13], v[40:43]
    ds_read_b128 v[10:13], v4 offset:704
    s_waitcnt lgkmcnt(0)
    v_mfma_f32_16x16x32_bf16 v[32:35], a[44:47], v[10:13], v[32:35]
    v_mfma_f32_16x16x32_bf16 v[36:39], a[100:103], v[10:13], v[36:39]
    v_mfma_f32_16x16x32_bf16 v[40:43], a[156:159], v[10:13], v[40:43]
    ds_read_b128 v[10:13], v4 offset:768
    s_waitcnt lgkmcnt(0)
    v_mfma_f32_16x16x32_bf16 v[32:35], a[48:51], v[10:13], v[32:35]
    v_mfma_f32_16x16x32_bf16 v[36:39], a[104:107], v[10:13], v[36:39]
    v_mfma_f32_16x16x32_bf16 v[40:43], a[160:163], v[10:13], v[40:43]
    ds_read_b128 v[10:13], v4 offset:832
    s_waitcnt lgkmcnt(0)
    v_mfma_f32_16x16x32_bf16 v[32:35], a[52:55], v[10:13], v[32:35]
    v_mfma_f32_16x16x32_bf16 v[36:39], a[108:111], v[10:13], v[36:39]
    v_mfma_f32_16x16x32_bf16 v[40:43], a[164:167], v[10:13], v[40:43]
    s_nop 7
    s_nop 7
    v_lshlrev_b32 v5, 7, v1
    v_lshl_add_u32 v5, v2, 3, v5
    s_lshl_b32 s5, s3, 5
    v_add_u32 v5, s5, v5
    s_lshl_b32 s21, s20, 17
    v_lshl_add_u32 v6, v1, 14, s21
    s_lshl_b32 s6, s4, 1
    v_add_u32 v6, s6, v6
    v_lshl_add_u32 v6, v2, 3, v6
    v_add_u32 v6, s5, v6
    v_add_u32 v6, 70516736, v6
    v_cmp_gt_u32 vcc, 8, v1
    s_and_saveexec_b64 s[30:31], vcc
    v_cvt_pk_bf16_f32 v10, v32, v33
    v_cvt_pk_bf16_f32 v11, v34, v35
    ds_write_b64 v5, v[10:11] offset:7168
    s_nop 1
    v_cvt_pk_bf16_f32 v10, v36, v37
    v_cvt_pk_bf16_f32 v11, v38, v39
    ds_write_b64 v5, v[10:11] offset:8192
    buffer_store_dwordx2 v[10:11], v6, s[8:11], 0 offen offset:0
    v_add_u32 v6, 0x2000, v6
    s_nop 1
    v_cvt_pk_bf16_f32 v10, v40, v41
    v_cvt_pk_bf16_f32 v11, v42, v43
    ds_write_b64 v5, v[10:11] offset:9216
    buffer_store_dwordx2 v[10:11], v6, s[8:11], 0 offen offset:0
    v_add_u32 v6, 0x2000, v6
    s_nop 1
    s_mov_b64 exec, s[30:31]
    s_waitcnt lgkmcnt(0)
    s_barrier
    s_cmp_lg_u32 s3, 0
    s_cbranch_scc1 cha_kernel_w
    s_lshl_b32 s22, s20, 5
    v_add_u32 v7, s22, v1
    v_subrev_u32 v7, 8, v7
    v_max_i32 v7, 0, v7
    v_mul_u32_u24 v7, 24576, v7
    v_add_u32 v7, s6, v7
    v_lshl_add_u32 v7, v2, 4, v7
    v_add_u32 v7, 20193280, v7
    v_min_u32 v8, 7, v1
    v_add_u32 v8, s22, v8
    v_add_u32 v8, 24, v8
    v_mul_u32_u24 v8, 24576, v8
    v_add_u32 v8, s6, v8
    v_lshl_add_u32 v8, v2, 4, v8
    v_add_u32 v8, 20193280, v8
    v_and_b32 v9, 7, v1
    v_lshlrev_b32 v9, 7, v9
    v_lshl_add_u32 v9, v2, 4, v9
    v_mov_b32 v32, 0
    v_mov_b32 v33, 0
    v_mov_b32 v34, 0
    v_mov_b32 v35, 0
    v_mov_b32 v36, 0
    v_mov_b32 v37, 0
    v_mov_b32 v38, 0
    v_mov_b32 v39, 0
    v_mov_b32 v40, 0
    v_mov_b32 v41, 0
    v_mov_b32 v42, 0
    v_mov_b32 v43, 0
    v_cmp_gt_u32 vcc, 8, v1
    buffer_load_dwordx4 v[10:13], v7, s[8:11], 0 offen offset:0
    v_add_u32 v28, 0x60000, v7
    buffer_load_dwordx4 v[14:17], v28, s[8:11], 0 offen offset:0
    buffer_load_dwordx4 v[18:21], v8, s[8:11], 0 offen offset:0
    ds_read_b128 v[22:25], v9 offset:8192
    ds_read_b128 v[44:47], v9 offset:7168
    s_waitcnt vmcnt(0) lgkmcnt(0)
    v_cndmask_b32 v10, v10, v22, vcc
    v_cndmask_b32 v11, v11, v23, vcc
    v_cndmask_b32 v12, v12, v24, vcc
    v_cndmask_b32 v13, v13, v25, vcc
    s_nop 1
    v_mfma_f32_16x16x32_bf16 v[32:35], v[10:13], v[44:47], v[32:35]
    v_mfma_f32_16x16x32_bf16 v[36:39], v[14:17], v[44:47], v[36:39]
    v_mfma_f32_16x16x32_bf16 v[40:43], v[18:21], v[44:47], v[40:43]
    buffer_load_dwordx4 v[10:13], v7, s[8:11], 0 offen offset:64
    v_add_u32 v28, 0x60000, v7
    buffer_load_dwordx4 v[14:17], v28, s[8:11], 0 offen offset:64
    buffer_load_dwordx4 v[18:21], v8, s[8:11], 0 offen offset:64
    ds_read_b128 v[22:25], v9 offset:8256
    ds_read_b128 v[44:47], v9 offset:7232
    s_waitcnt vmcnt(0) lgkmcnt(0)
    v_cndmask_b32 v10, v10, v22, vcc
    v_cndmask_b32 v11, v11, v23, vcc
    v_cndmask_b32 v12, v12, v24, vcc
    v_cndmask_b32 v13, v13, v25, vcc
    s_nop 1
    v_mfma_f32_16x16x32_bf16 v[32:35], v[10:13], v[44:47], v[32:35]
    v_mfma_f32_16x16x32_bf16 v[36:39], v[14:17], v[44:47], v[36:39]
    v_mfma_f32_16x16x32_bf16 v[40:43], v[18:21], v[44:47], v[40:43]
    s_nop 7
    s_nop 7
    s_add_u32 s23, s20, 0
    s_lshl_b32 s23, s23, 6
    s_add_u32 s24, s23, s2
    s_mul_i32 s24, s24, 1536
    s_add_u32 s24, s24, 95682560
    s_and_b32 s25, s2, 60
    s_add_u32 s25, s25, s23
    s_mul_i32 s25, s25, 1536
    s_add_u32 s25, s25, 95682560
    v_and_b32 v28, 7, v1
    v_lshl_add_u32 v28, v2, 3, v28
    v_lshlrev_b32 v28, 4, v28
    v_cmp_gt_u32 vcc, 8, v1
    s_and_saveexec_b64 s[30:31], vcc
    buffer_store_dwordx4 v[32:35], v28, s[8:11], s24 offen offset:0 sc1
    buffer_store_dwordx4 v[36:39], v28, s[8:11], s24 offen offset:512 sc1
    buffer_store_dwordx4 v[40:43], v28, s[8:11], s24 offen offset:1024 sc1
    s_mov_b64 exec, s[30:31]
    v_add_u32 v5, 3072, v28
cha_kernel_p1:
    buffer_load_dwordx4 v[64:67], v28, s[8:11], s25 offen offset:0 sc1
    buffer_load_dwordx4 v[80:83], v28, s[8:11], s25 offen offset:512 sc1
    buffer_load_dwordx4 v[96:99], v28, s[8:11], s25 offen offset:1024 sc1
    buffer_load_dwordx4 v[68:71], v28, s[8:11], s25 offen offset:1536 sc1
    buffer_load_dwordx4 v[84:87], v28, s[8:11], s25 offen offset:2048 sc1
    buffer_load_dwordx4 v[100:103], v28, s[8:11], s25 offen offset:2560 sc1
    buffer_load_dwordx4 v[72:75], v5, s[8:11], s25 offen offset:0 sc1
    buffer_load_dwordx4 v[88:91], v5, s[8:11], s25 offen offset:512 sc1
    buffer_load_dwordx4 v[104:107], v5, s[8:11], s25 offen offset:1024 sc1
    buffer_load_dwordx4 v[76:79], v5, s[8:11], s25 offen offset:1536 sc1
    buffer_load_dwordx4 v[92:95], v5, s[8:11], s25 offen offset:2048 sc1
    buffer_load_dwordx4 v[108:111], v5, s[8:11], s25 offen offset:2560 sc1
    s_waitcnt vmcnt(0)
    v_mov_b32 v29, 0
    v_cmp_eq_u32 vcc, -1, v64
    s_nop 1
    v_addc_co_u32 v29, vcc, 0, v29, vcc
    v_cmp_eq_u32 vcc, -1, v80
    s_nop 1
    v_addc_co_u32 v29, vcc, 0, v29, vcc
    v_cmp_gt_u32 s[32:33], 2, v2
    v_cmp_eq_u32 vcc, -1, v96
    s_and_b64 vcc, vcc, s[32:33]
    s_nop 1
    v_addc_co_u32 v29, vcc, 0, v29, vcc
    v_cmp_eq_u32 vcc, -1, v68
    s_nop 1
    v_addc_co_u32 v29, vcc, 0, v29, vcc
    v_cmp_eq_u32 vcc, -1, v84
    s_nop 1
    v_addc_co_u32 v29, vcc, 0, v29, vcc
    v_cmp_gt_u32 s[32:33], 2, v2
    v_cmp_eq_u32 vcc, -1, v100
    s_and_b64 vcc, vcc, s[32:33]
    s_nop 1
    v_addc_co_u32 v29, vcc, 0, v29, vcc
    v_cmp_eq_u32 vcc, -1, v72
    s_nop 1
    v_addc_co_u32 v29, vcc, 0, v29, vcc
    v_cmp_eq_u32 vcc, -1, v88
    s_nop 1
    v_addc_co_u32 v29, vcc, 0, v29, vcc
    v_cmp_gt_u32 s[32:33], 2, v2
    v_cmp_eq_u32 vcc, -1, v104
    s_and_b64 vcc, vcc, s[32:33]
    s_nop 1
    v_addc_co_u32 v29, vcc, 0, v29, vcc
    v_cmp_eq_u32 vcc, -1, v76
    s_nop 1
    v_addc_co_u32 v29, vcc, 0, v29, vcc
    v_cmp_eq_u32 vcc, -1, v92
    s_nop 1
    v_addc_co_u32 v29, vcc, 0, v29, vcc
    v_cmp_gt_u32 s[32:33], 2, v2
    v_cmp_eq_u32 vcc, -1, v108
    s_and_b64 vcc, vcc, s[32:33]
    s_nop 1
    v_addc_co_u32 v29, vcc, 0, v29, vcc
    v_cmp_ne_u32 vcc, 0, v29
    s_nop 1
    s_cbranch_vccnz cha_kernel_p1
    v_add_f32 v32, v64, v68
    v_add_f32 v32, v32, v72
    v_add_f32 v32, v32, v76
    v_cvt_pk_bf16_f32 v32, v32, v32
    v_lshlrev_b32 v32, 16, v32
    v_mul_f32 v32, 0x3d800000, v32
    v_add_f32 v33, v65, v69
    v_add_f32 v33, v33, v73
    v_add_f32 v33, v33, v77
    v_cvt_pk_bf16_f32 v33, v33, v33
    v_lshlrev_b32 v33, 16, v33
    v_mul_f32 v33, 0x3d800000, v33
    v_add_f32 v34, v66, v70
    v_add_f32 v34, v34, v74
    v_add_f32 v34, v34, v78
    v_cvt_pk_bf16_f32 v34, v34, v34
    v_lshlrev_b32 v34, 16, v34
    v_mul_f32 v34, 0x3d800000, v34
    v_add_f32 v35, v67, v71
    v_add_f32 v35, v35, v75
    v_add_f32 v35, v35, v79
    v_cvt_pk_bf16_f32 v35, v35, v35
    v_lshlrev_b32 v35, 16, v35
    v_mul_f32 v35, 0x3d800000, v35
    v_add_f32 v36, v80, v84
    v_add_f32 v36, v36, v88
    v_add_f32 v36, v36, v92
    v_cvt_pk_bf16_f32 v36, v36, v36
    v_lshlrev_b32 v36, 16, v36
    v_mul_f32 v36, 0x3d800000, v36
    v_add_f32 v37, v81, v85
    v_add_f32 v37, v37, v89
    v_add_f32 v37, v37, v93
    v_cvt_pk_bf16_f32 v37, v37, v37
    v_lshlrev_b32 v37, 16, v37
    v_mul_f32 v37, 0x3d800000, v37
    v_add_f32 v38, v82, v86
    v_add_f32 v38, v38, v90
    v_add_f32 v38, v38, v94
    v_cvt_pk_bf16_f32 v38, v38, v38
    v_lshlrev_b32 v38, 16, v38
    v_mul_f32 v38, 0x3d800000, v38
    v_add_f32 v39, v83, v87
    v_add_f32 v39, v39, v91
    v_add_f32 v39, v39, v95
    v_cvt_pk_bf16_f32 v39, v39, v39
    v_lshlrev_b32 v39, 16, v39
    v_mul_f32 v39, 0x3d800000, v39
    v_add_f32 v40, v96, v100
    v_add_f32 v40, v40, v104
    v_add_f32 v40, v40, v108
    v_cvt_pk_bf16_f32 v40, v40, v40
    v_lshlrev_b32 v40, 16, v40
    v_mul_f32 v40, 0x3d800000, v40
    v_cmp_gt_u32 vcc, 2, v2
    v_mov_b32 v57, 0xce6e6b28
    s_nop 0
    v_cndmask_b32 v40, v57, v40, vcc
    v_add_f32 v41, v97, v101
    v_add_f32 v41, v41, v105
    v_add_f32 v41, v41, v109
    v_cvt_pk_bf16_f32 v41, v41, v41
    v_lshlrev_b32 v41, 16, v41
    v_mul_f32 v41, 0x3d800000, v41
    v_cmp_gt_u32 vcc, 2, v2
    v_mov_b32 v57, 0xce6e6b28
    s_nop 0
    v_cndmask_b32 v41, v57, v41, vcc
    v_add_f32 v42, v98, v102
    v_add_f32 v42, v42, v106
    v_add_f32 v42, v42, v110
    v_cvt_pk_bf16_f32 v42, v42, v42
    v_lshlrev_b32 v42, 16, v42
    v_mul_f32 v42, 0x3d800000, v42
    v_cmp_gt_u32 vcc, 2, v2
    v_mov_b32 v57, 0xce6e6b28
    s_nop 0
    v_cndmask_b32 v42, v57, v42, vcc
    v_add_f32 v43, v99, v103
    v_add_f32 v43, v43, v107
    v_add_f32 v43, v43, v111
    v_cvt_pk_bf16_f32 v43, v43, v43
    v_lshlrev_b32 v43, 16, v43
    v_mul_f32 v43, 0x3d800000, v43
    v_cmp_gt_u32 vcc, 2, v2
    v_mov_b32 v57, 0xce6e6b28
    s_nop 0
    v_cndmask_b32 v43, v57, v43, vcc
    v_mov_b32 v56, v32
    v_max_f32 v56, v56, v33
    v_max_f32 v56, v56, v34
    v_max_f32 v56, v56, v35
    v_max_f32 v56, v56, v36
    v_max_f32 v56, v56, v37
    v_max_f32 v56, v56, v38
    v_max_f32 v56, v56, v39
    v_max_f32 v56, v56, v40
    v_max_f32 v56, v56, v41
    v_max_f32 v56, v56, v42
    v_max_f32 v56, v56, v43
    ds_bpermute_b32 v9, v60, v56
    s_waitcnt lgkmcnt(0)
    v_max_f32 v56, v56, v9
    ds_bpermute_b32 v9, v61, v56
    s_waitcnt lgkmcnt(0)
    v_max_f32 v56, v56, v9
    v_mov_b32 v55, 0
    v_sub_f32 v32, v32, v56
    v_mul_f32 v32, 0x3fb8aa3b, v32
    v_exp_f32 v32, v32
    s_nop 0
    v_add_f32 v55, v55, v32
    v_sub_f32 v33, v33, v56
    v_mul_f32 v33, 0x3fb8aa3b, v33
    v_exp_f32 v33, v33
    s_nop 0
    v_add_f32 v55, v55, v33
    v_sub_f32 v34, v34, v56
    v_mul_f32 v34, 0x3fb8aa3b, v34
    v_exp_f32 v34, v34
    s_nop 0
    v_add_f32 v55, v55, v34
    v_sub_f32 v35, v35, v56
    v_mul_f32 v35, 0x3fb8aa3b, v35
    v_exp_f32 v35, v35
    s_nop 0
    v_add_f32 v55, v55, v35
    v_sub_f32 v36, v36, v56
    v_mul_f32 v36, 0x3fb8aa3b, v36
    v_exp_f32 v36, v36
    s_nop 0
    v_add_f32 v55, v55, v36
    v_sub_f32 v37, v37, v56
    v_mul_f32 v37, 0x3fb8aa3b, v37
    v_exp_f32 v37, v37
    s_nop 0
    v_add_f32 v55, v55, v37
    v_sub_f32 v38, v38, v56
    v_mul_f32 v38, 0x3fb8aa3b, v38
    v_exp_f32 v38, v38
    s_nop 0
    v_add_f32 v55, v55, v38
    v_sub_f32 v39, v39, v56
    v_mul_f32 v39, 0x3fb8aa3b, v39
    v_exp_f32 v39, v39
    s_nop 0
    v_add_f32 v55, v55, v39
    v_sub_f32 v40, v40, v56
    v_mul_f32 v40, 0x3fb8aa3b, v40
    v_exp_f32 v40, v40
    s_nop 0
    v_add_f32 v55, v55, v40
    v_sub_f32 v41, v41, v56
    v_mul_f32 v41, 0x3fb8aa3b, v41
    v_exp_f32 v41, v41
    s_nop 0
    v_add_f32 v55, v55, v41
    v_sub_f32 v42, v42, v56
    v_mul_f32 v42, 0x3fb8aa3b, v42
    v_exp_f32 v42, v42
    s_nop 0
    v_add_f32 v55, v55, v42
    v_sub_f32 v43, v43, v56
    v_mul_f32 v43, 0x3fb8aa3b, v43
    v_exp_f32 v43, v43
    s_nop 0
    v_add_f32 v55, v55, v43
    ds_bpermute_b32 v9, v60, v55
    s_waitcnt lgkmcnt(0)
    v_add_f32 v55, v55, v9
    ds_bpermute_b32 v9, v61, v55
    s_waitcnt lgkmcnt(0)
    v_add_f32 v55, v55, v9
    v_rcp_f32 v55, v55
    s_nop 0
    v_mul_f32 v32, v32, v55
    v_cvt_pk_bf16_f32 v32, v32, v32
    v_lshlrev_b32 v32, 16, v32
    v_mul_f32 v33, v33, v55
    v_cvt_pk_bf16_f32 v33, v33, v33
    v_lshlrev_b32 v33, 16, v33
    v_mul_f32 v34, v34, v55
    v_cvt_pk_bf16_f32 v34, v34, v34
    v_lshlrev_b32 v34, 16, v34
    v_mul_f32 v35, v35, v55
    v_cvt_pk_bf16_f32 v35, v35, v35
    v_lshlrev_b32 v35, 16, v35
    v_mul_f32 v36, v36, v55
    v_cvt_pk_bf16_f32 v36, v36, v36
    v_lshlrev_b32 v36, 16, v36
    v_mul_f32 v37, v37, v55
    v_cvt_pk_bf16_f32 v37, v37, v37
    v_lshlrev_b32 v37, 16, v37
    v_mul_f32 v38, v38, v55
    v_cvt_pk_bf16_f32 v38, v38, v38
    v_lshlrev_b32 v38, 16, v38
    v_mul_f32 v39, v39, v55
    v_cvt_pk_bf16_f32 v39, v39, v39
    v_lshlrev_b32 v39, 16, v39
    v_mul_f32 v40, v40, v55
    v_cvt_pk_bf16_f32 v40, v40, v40
    v_lshlrev_b32 v40, 16, v40
    v_mul_f32 v41, v41, v55
    v_cvt_pk_bf16_f32 v41, v41, v41
    v_lshlrev_b32 v41, 16, v41
    v_mul_f32 v42, v42, v55
    v_cvt_pk_bf16_f32 v42, v42, v42
    v_lshlrev_b32 v42, 16, v42
    v_mul_f32 v43, v43, v55
    v_cvt_pk_bf16_f32 v43, v43, v43
    v_lshlrev_b32 v43, 16, v43
    s_mul_i32 s26, s22, 24576
    s_add_u32 s26, s26, s6
    s_add_u32 s26, s26, 20201472
    v_lshlrev_b32 v9, 1, v63
    s_add_u32 s27, s26, 0
    buffer_load_ushort v72, v9, s[8:11], s27 offen
    s_add_u32 s27, s26, 24576
    buffer_load_ushort v73, v9, s[8:11], s27 offen
    s_add_u32 s27, s26, 49152
    buffer_load_ushort v74, v9, s[8:11], s27 offen
    s_add_u32 s27, s26, 73728
    buffer_load_ushort v75, v9, s[8:11], s27 offen
    s_add_u32 s27, s26, 98304
    buffer_load_ushort v76, v9, s[8:11], s27 offen
    s_add_u32 s27, s26, 122880
    buffer_load_ushort v77, v9, s[8:11], s27 offen
    s_add_u32 s27, s26, 147456
    buffer_load_ushort v78, v9, s[8:11], s27 offen
    s_add_u32 s27, s26, 172032
    buffer_load_ushort v79, v9, s[8:11], s27 offen
    s_add_u32 s27, s26, 196608
    buffer_load_ushort v80, v9, s[8:11], s27 offen
    s_add_u32 s27, s26, 221184
    buffer_load_ushort v81, v9, s[8:11], s27 offen
    s_add_u32 s27, s26, 245760
    buffer_load_ushort v82, v9, s[8:11], s27 offen
    s_add_u32 s27, s26, 270336
    buffer_load_ushort v83, v9, s[8:11], s27 offen
    s_add_u32 s27, s26, 294912
    buffer_load_ushort v84, v9, s[8:11], s27 offen
    s_add_u32 s27, s26, 319488
    buffer_load_ushort v85, v9, s[8:11], s27 offen
    s_add_u32 s27, s26, 344064
    buffer_load_ushort v86, v9, s[8:11], s27 offen
    s_add_u32 s27, s26, 368640
    buffer_load_ushort v87, v9, s[8:11], s27 offen
    s_add_u32 s27, s26, 393216
    buffer_load_ushort v88, v9, s[8:11], s27 offen
    s_add_u32 s27, s26, 417792
    buffer_load_ushort v89, v9, s[8:11], s27 offen
    s_add_u32 s27, s26, 442368
    buffer_load_ushort v90, v9, s[8:11], s27 offen
    s_add_u32 s27, s26, 466944
    buffer_load_ushort v91, v9, s[8:11], s27 offen
    s_add_u32 s27, s26, 491520
    buffer_load_ushort v92, v9, s[8:11], s27 offen
    s_add_u32 s27, s26, 516096
    buffer_load_ushort v93, v9, s[8:11], s27 offen
    s_add_u32 s27, s26, 540672
    buffer_load_ushort v94, v9, s[8:11], s27 offen
    s_add_u32 s27, s26, 565248
    buffer_load_ushort v95, v9, s[8:11], s27 offen
    s_add_u32 s27, s26, 589824
    buffer_load_ushort v96, v9, s[8:11], s27 offen
    s_add_u32 s27, s26, 614400
    buffer_load_ushort v97, v9, s[8:11], s27 offen
    s_add_u32 s27, s26, 638976
    buffer_load_ushort v98, v9, s[8:11], s27 offen
    s_add_u32 s27, s26, 663552
    buffer_load_ushort v99, v9, s[8:11], s27 offen
    s_add_u32 s27, s26, 688128
    buffer_load_ushort v100, v9, s[8:11], s27 offen
    s_add_u32 s27, s26, 712704
    buffer_load_ushort v101, v9, s[8:11], s27 offen
    s_add_u32 s27, s26, 737280
    buffer_load_ushort v102, v9, s[8:11], s27 offen
    s_add_u32 s27, s26, 761856
    buffer_load_ushort v103, v9, s[8:11], s27 offen
    ds_read_u16 v64, v9 offset:9216
    ds_read_u16 v65, v9 offset:9344
    ds_read_u16 v66, v9 offset:9472
    ds_read_u16 v67, v9 offset:9600
    ds_read_u16 v68, v9 offset:9728
    ds_read_u16 v69, v9 offset:9856
    ds_read_u16 v70, v9 offset:9984
    ds_read_u16 v71, v9 offset:10112
    s_waitcnt vmcnt(0) lgkmcnt(0)
    v_lshlrev_b32 v64, 16, v64
    v_lshlrev_b32 v65, 16, v65
    v_lshlrev_b32 v66, 16, v66
    v_lshlrev_b32 v67, 16, v67
    v_lshlrev_b32 v68, 16, v68
    v_lshlrev_b32 v69, 16, v69
    v_lshlrev_b32 v70, 16, v70
    v_lshlrev_b32 v71, 16, v71
    v_lshlrev_b32 v72, 16, v72
    v_lshlrev_b32 v73, 16, v73
    v_lshlrev_b32 v74, 16, v74
    v_lshlrev_b32 v75, 16, v75
    v_lshlrev_b32 v76, 16, v76
    v_lshlrev_b32 v77, 16, v77
    v_lshlrev_b32 v78, 16, v78
    v_lshlrev_b32 v79, 16, v79
    v_lshlrev_b32 v80, 16, v80
    v_lshlrev_b32 v81, 16, v81
    v_lshlrev_b32 v82, 16, v82
    v_lshlrev_b32 v83, 16, v83
    v_lshlrev_b32 v84, 16, v84
    v_lshlrev_b32 v85, 16, v85
    v_lshlrev_b32 v86, 16, v86
    v_lshlrev_b32 v87, 16, v87
    v_lshlrev_b32 v88, 16, v88
    v_lshlrev_b32 v89, 16, v89
    v_lshlrev_b32 v90, 16, v90
    v_lshlrev_b32 v91, 16, v91
    v_lshlrev_b32 v92, 16, v92
    v_lshlrev_b32 v93, 16, v93
    v_lshlrev_b32 v94, 16, v94
    v_lshlrev_b32 v95, 16, v95
    v_lshlrev_b32 v96, 16, v96
    v_lshlrev_b32 v97, 16, v97
    v_lshlrev_b32 v98, 16, v98
    v_lshlrev_b32 v99, 16, v99
    v_lshlrev_b32 v100, 16, v100
    v_lshlrev_b32 v101, 16, v101
    v_lshlrev_b32 v102, 16, v102
    v_lshlrev_b32 v103, 16, v103
    v_mov_b32 v110, 0
    v_readlane_b32 s27, v32, 0
    s_nop 1
    v_fmac_f32 v110, s27, v64
    v_readlane_b32 s27, v33, 0
    s_nop 1
    v_fmac_f32 v110, s27, v65
    v_readlane_b32 s27, v34, 0
    s_nop 1
    v_fmac_f32 v110, s27, v66
    v_readlane_b32 s27, v35, 0
    s_nop 1
    v_fmac_f32 v110, s27, v67
    v_readlane_b32 s27, v32, 16
    s_nop 1
    v_fmac_f32 v110, s27, v68
    v_readlane_b32 s27, v33, 16
    s_nop 1
    v_fmac_f32 v110, s27, v69
    v_readlane_b32 s27, v34, 16
    s_nop 1
    v_fmac_f32 v110, s27, v70
    v_readlane_b32 s27, v35, 16
    s_nop 1
    v_fmac_f32 v110, s27, v71
    v_readlane_b32 s27, v32, 32
    s_nop 1
    v_fmac_f32 v110, s27, v72
    v_readlane_b32 s27, v33, 32
    s_nop 1
    v_fmac_f32 v110, s27, v73
    v_readlane_b32 s27, v34, 32
    s_nop 1
    v_fmac_f32 v110, s27, v74
    v_readlane_b32 s27, v35, 32
    s_nop 1
    v_fmac_f32 v110, s27, v75
    v_readlane_b32 s27, v32, 48
    s_nop 1
    v_fmac_f32 v110, s27, v76
    v_readlane_b32 s27, v33, 48
    s_nop 1
    v_fmac_f32 v110, s27, v77
    v_readlane_b32 s27, v34, 48
    s_nop 1
    v_fmac_f32 v110, s27, v78
    v_readlane_b32 s27, v35, 48
    s_nop 1
    v_fmac_f32 v110, s27, v79
    v_readlane_b32 s27, v36, 0
    s_nop 1
    v_fmac_f32 v110, s27, v80
    v_readlane_b32 s27, v37, 0
    s_nop 1
    v_fmac_f32 v110, s27, v81
    v_readlane_b32 s27, v38, 0
    s_nop 1
    v_fmac_f32 v110, s27, v82
    v_readlane_b32 s27, v39, 0
    s_nop 1
    v_fmac_f32 v110, s27, v83
    v_readlane_b32 s27, v36, 16
    s_nop 1
    v_fmac_f32 v110, s27, v84
    v_readlane_b32 s27, v37, 16
    s_nop 1
    v_fmac_f32 v110, s27, v85
    v_readlane_b32 s27, v38, 16
    s_nop 1
    v_fmac_f32 v110, s27, v86
    v_readlane_b32 s27, v39, 16
    s_nop 1
    v_fmac_f32 v110, s27, v87
    v_readlane_b32 s27, v36, 32
    s_nop 1
    v_fmac_f32 v110, s27, v88
    v_readlane_b32 s27, v37, 32
    s_nop 1
    v_fmac_f32 v110, s27, v89
    v_readlane_b32 s27, v38, 32
    s_nop 1
    v_fmac_f32 v110, s27, v90
    v_readlane_b32 s27, v39, 32
    s_nop 1
    v_fmac_f32 v110, s27, v91
    v_readlane_b32 s27, v36, 48
    s_nop 1
    v_fmac_f32 v110, s27, v92
    v_readlane_b32 s27, v37, 48
    s_nop 1
    v_fmac_f32 v110, s27, v93
    v_readlane_b32 s27, v38, 48
    s_nop 1
    v_fmac_f32 v110, s27, v94
    v_readlane_b32 s27, v39, 48
    s_nop 1
    v_fmac_f32 v110, s27, v95
    v_readlane_b32 s27, v40, 0
    s_nop 1
    v_fmac_f32 v110, s27, v96
    v_readlane_b32 s27, v41, 0
    s_nop 1
    v_fmac_f32 v110, s27, v97
    v_readlane_b32 s27, v42, 0
    s_nop 1
    v_fmac_f32 v110, s27, v98
    v_readlane_b32 s27, v43, 0
    s_nop 1
    v_fmac_f32 v110, s27, v99
    v_readlane_b32 s27, v40, 16
    s_nop 1
    v_fmac_f32 v110, s27, v100
    v_readlane_b32 s27, v41, 16
    s_nop 1
    v_fmac_f32 v110, s27, v101
    v_readlane_b32 s27, v42, 16
    s_nop 1
    v_fmac_f32 v110, s27, v102
    v_readlane_b32 s27, v43, 16
    s_nop 1
    v_fmac_f32 v110, s27, v103
    v_cvt_pk_bf16_f32 v110, v110, v110
    ds_write_b16 v9, v110 offset:10240
    v_mov_b32 v110, 0
    v_readlane_b32 s27, v32, 1
    s_nop 1
    v_fmac_f32 v110, s27, v64
    v_readlane_b32 s27, v33, 1
    s_nop 1
    v_fmac_f32 v110, s27, v65
    v_readlane_b32 s27, v34, 1
    s_nop 1
    v_fmac_f32 v110, s27, v66
    v_readlane_b32 s27, v35, 1
    s_nop 1
    v_fmac_f32 v110, s27, v67
    v_readlane_b32 s27, v32, 17
    s_nop 1
    v_fmac_f32 v110, s27, v68
    v_readlane_b32 s27, v33, 17
    s_nop 1
    v_fmac_f32 v110, s27, v69
    v_readlane_b32 s27, v34, 17
    s_nop 1
    v_fmac_f32 v110, s27, v70
    v_readlane_b32 s27, v35, 17
    s_nop 1
    v_fmac_f32 v110, s27, v71
    v_readlane_b32 s27, v32, 33
    s_nop 1
    v_fmac_f32 v110, s27, v72
    v_readlane_b32 s27, v33, 33
    s_nop 1
    v_fmac_f32 v110, s27, v73
    v_readlane_b32 s27, v34, 33
    s_nop 1
    v_fmac_f32 v110, s27, v74
    v_readlane_b32 s27, v35, 33
    s_nop 1
    v_fmac_f32 v110, s27, v75
    v_readlane_b32 s27, v32, 49
    s_nop 1
    v_fmac_f32 v110, s27, v76
    v_readlane_b32 s27, v33, 49
    s_nop 1
    v_fmac_f32 v110, s27, v77
    v_readlane_b32 s27, v34, 49
    s_nop 1
    v_fmac_f32 v110, s27, v78
    v_readlane_b32 s27, v35, 49
    s_nop 1
    v_fmac_f32 v110, s27, v79
    v_readlane_b32 s27, v36, 1
    s_nop 1
    v_fmac_f32 v110, s27, v80
    v_readlane_b32 s27, v37, 1
    s_nop 1
    v_fmac_f32 v110, s27, v81
    v_readlane_b32 s27, v38, 1
    s_nop 1
    v_fmac_f32 v110, s27, v82
    v_readlane_b32 s27, v39, 1
    s_nop 1
    v_fmac_f32 v110, s27, v83
    v_readlane_b32 s27, v36, 17
    s_nop 1
    v_fmac_f32 v110, s27, v84
    v_readlane_b32 s27, v37, 17
    s_nop 1
    v_fmac_f32 v110, s27, v85
    v_readlane_b32 s27, v38, 17
    s_nop 1
    v_fmac_f32 v110, s27, v86
    v_readlane_b32 s27, v39, 17
    s_nop 1
    v_fmac_f32 v110, s27, v87
    v_readlane_b32 s27, v36, 33
    s_nop 1
    v_fmac_f32 v110, s27, v88
    v_readlane_b32 s27, v37, 33
    s_nop 1
    v_fmac_f32 v110, s27, v89
    v_readlane_b32 s27, v38, 33
    s_nop 1
    v_fmac_f32 v110, s27, v90
    v_readlane_b32 s27, v39, 33
    s_nop 1
    v_fmac_f32 v110, s27, v91
    v_readlane_b32 s27, v36, 49
    s_nop 1
    v_fmac_f32 v110, s27, v92
    v_readlane_b32 s27, v37, 49
    s_nop 1
    v_fmac_f32 v110, s27, v93
    v_readlane_b32 s27, v38, 49
    s_nop 1
    v_fmac_f32 v110, s27, v94
    v_readlane_b32 s27, v39, 49
    s_nop 1
    v_fmac_f32 v110, s27, v95
    v_readlane_b32 s27, v40, 1
    s_nop 1
    v_fmac_f32 v110, s27, v96
    v_readlane_b32 s27, v41, 1
    s_nop 1
    v_fmac_f32 v110, s27, v97
    v_readlane_b32 s27, v42, 1
    s_nop 1
    v_fmac_f32 v110, s27, v98
    v_readlane_b32 s27, v43, 1
    s_nop 1
    v_fmac_f32 v110, s27, v99
    v_readlane_b32 s27, v40, 17
    s_nop 1
    v_fmac_f32 v110, s27, v100
    v_readlane_b32 s27, v41, 17
    s_nop 1
    v_fmac_f32 v110, s27, v101
    v_readlane_b32 s27, v42, 17
    s_nop 1
    v_fmac_f32 v110, s27, v102
    v_readlane_b32 s27, v43, 17
    s_nop 1
    v_fmac_f32 v110, s27, v103
    v_cvt_pk_bf16_f32 v110, v110, v110
    ds_write_b16 v9, v110 offset:10368
    v_mov_b32 v110, 0
    v_readlane_b32 s27, v32, 2
    s_nop 1
    v_fmac_f32 v110, s27, v64
    v_readlane_b32 s27, v33, 2
    s_nop 1
    v_fmac_f32 v110, s27, v65
    v_readlane_b32 s27, v34, 2
    s_nop 1
    v_fmac_f32 v110, s27, v66
    v_readlane_b32 s27, v35, 2
    s_nop 1
    v_fmac_f32 v110, s27, v67
    v_readlane_b32 s27, v32, 18
    s_nop 1
    v_fmac_f32 v110, s27, v68
    v_readlane_b32 s27, v33, 18
    s_nop 1
    v_fmac_f32 v110, s27, v69
    v_readlane_b32 s27, v34, 18
    s_nop 1
    v_fmac_f32 v110, s27, v70
    v_readlane_b32 s27, v35, 18
    s_nop 1
    v_fmac_f32 v110, s27, v71
    v_readlane_b32 s27, v32, 34
    s_nop 1
    v_fmac_f32 v110, s27, v72
    v_readlane_b32 s27, v33, 34
    s_nop 1
    v_fmac_f32 v110, s27, v73
    v_readlane_b32 s27, v34, 34
    s_nop 1
    v_fmac_f32 v110, s27, v74
    v_readlane_b32 s27, v35, 34
    s_nop 1
    v_fmac_f32 v110, s27, v75
    v_readlane_b32 s27, v32, 50
    s_nop 1
    v_fmac_f32 v110, s27, v76
    v_readlane_b32 s27, v33, 50
    s_nop 1
    v_fmac_f32 v110, s27, v77
    v_readlane_b32 s27, v34, 50
    s_nop 1
    v_fmac_f32 v110, s27, v78
    v_readlane_b32 s27, v35, 50
    s_nop 1
    v_fmac_f32 v110, s27, v79
    v_readlane_b32 s27, v36, 2
    s_nop 1
    v_fmac_f32 v110, s27, v80
    v_readlane_b32 s27, v37, 2
    s_nop 1
    v_fmac_f32 v110, s27, v81
    v_readlane_b32 s27, v38, 2
    s_nop 1
    v_fmac_f32 v110, s27, v82
    v_readlane_b32 s27, v39, 2
    s_nop 1
    v_fmac_f32 v110, s27, v83
    v_readlane_b32 s27, v36, 18
    s_nop 1
    v_fmac_f32 v110, s27, v84
    v_readlane_b32 s27, v37, 18
    s_nop 1
    v_fmac_f32 v110, s27, v85
    v_readlane_b32 s27, v38, 18
    s_nop 1
    v_fmac_f32 v110, s27, v86
    v_readlane_b32 s27, v39, 18
    s_nop 1
    v_fmac_f32 v110, s27, v87
    v_readlane_b32 s27, v36, 34
    s_nop 1
    v_fmac_f32 v110, s27, v88
    v_readlane_b32 s27, v37, 34
    s_nop 1
    v_fmac_f32 v110, s27, v89
    v_readlane_b32 s27, v38, 34
    s_nop 1
    v_fmac_f32 v110, s27, v90
    v_readlane_b32 s27, v39, 34
    s_nop 1
    v_fmac_f32 v110, s27, v91
    v_readlane_b32 s27, v36, 50
    s_nop 1
    v_fmac_f32 v110, s27, v92
    v_readlane_b32 s27, v37, 50
    s_nop 1
    v_fmac_f32 v110, s27, v93
    v_readlane_b32 s27, v38, 50
    s_nop 1
    v_fmac_f32 v110, s27, v94
    v_readlane_b32 s27, v39, 50
    s_nop 1
    v_fmac_f32 v110, s27, v95
    v_readlane_b32 s27, v40, 2
    s_nop 1
    v_fmac_f32 v110, s27, v96
    v_readlane_b32 s27, v41, 2
    s_nop 1
    v_fmac_f32 v110, s27, v97
    v_readlane_b32 s27, v42, 2
    s_nop 1
    v_fmac_f32 v110, s27, v98
    v_readlane_b32 s27, v43, 2
    s_nop 1
    v_fmac_f32 v110, s27, v99
    v_readlane_b32 s27, v40, 18
    s_nop 1
    v_fmac_f32 v110, s27, v100
    v_readlane_b32 s27, v41, 18
    s_nop 1
    v_fmac_f32 v110, s27, v101
    v_readlane_b32 s27, v42, 18
    s_nop 1
    v_fmac_f32 v110, s27, v102
    v_readlane_b32 s27, v43, 18
    s_nop 1
    v_fmac_f32 v110, s27, v103
    v_cvt_pk_bf16_f32 v110, v110, v110
    ds_write_b16 v9, v110 offset:10496
    v_mov_b32 v110, 0
    v_readlane_b32 s27, v32, 3
    s_nop 1
    v_fmac_f32 v110, s27, v64
    v_readlane_b32 s27, v33, 3
    s_nop 1
    v_fmac_f32 v110, s27, v65
    v_readlane_b32 s27, v34, 3
    s_nop 1
    v_fmac_f32 v110, s27, v66
    v_readlane_b32 s27, v35, 3
    s_nop 1
    v_fmac_f32 v110, s27, v67
    v_readlane_b32 s27, v32, 19
    s_nop 1
    v_fmac_f32 v110, s27, v68
    v_readlane_b32 s27, v33, 19
    s_nop 1
    v_fmac_f32 v110, s27, v69
    v_readlane_b32 s27, v34, 19
    s_nop 1
    v_fmac_f32 v110, s27, v70
    v_readlane_b32 s27, v35, 19
    s_nop 1
    v_fmac_f32 v110, s27, v71
    v_readlane_b32 s27, v32, 35
    s_nop 1
    v_fmac_f32 v110, s27, v72
    v_readlane_b32 s27, v33, 35
    s_nop 1
    v_fmac_f32 v110, s27, v73
    v_readlane_b32 s27, v34, 35
    s_nop 1
    v_fmac_f32 v110, s27, v74
    v_readlane_b32 s27, v35, 35
    s_nop 1
    v_fmac_f32 v110, s27, v75
    v_readlane_b32 s27, v32, 51
    s_nop 1
    v_fmac_f32 v110, s27, v76
    v_readlane_b32 s27, v33, 51
    s_nop 1
    v_fmac_f32 v110, s27, v77
    v_readlane_b32 s27, v34, 51
    s_nop 1
    v_fmac_f32 v110, s27, v78
    v_readlane_b32 s27, v35, 51
    s_nop 1
    v_fmac_f32 v110, s27, v79
    v_readlane_b32 s27, v36, 3
    s_nop 1
    v_fmac_f32 v110, s27, v80
    v_readlane_b32 s27, v37, 3
    s_nop 1
    v_fmac_f32 v110, s27, v81
    v_readlane_b32 s27, v38, 3
    s_nop 1
    v_fmac_f32 v110, s27, v82
    v_readlane_b32 s27, v39, 3
    s_nop 1
    v_fmac_f32 v110, s27, v83
    v_readlane_b32 s27, v36, 19
    s_nop 1
    v_fmac_f32 v110, s27, v84
    v_readlane_b32 s27, v37, 19
    s_nop 1
    v_fmac_f32 v110, s27, v85
    v_readlane_b32 s27, v38, 19
    s_nop 1
    v_fmac_f32 v110, s27, v86
    v_readlane_b32 s27, v39, 19
    s_nop 1
    v_fmac_f32 v110, s27, v87
    v_readlane_b32 s27, v36, 35
    s_nop 1
    v_fmac_f32 v110, s27, v88
    v_readlane_b32 s27, v37, 35
    s_nop 1
    v_fmac_f32 v110, s27, v89
    v_readlane_b32 s27, v38, 35
    s_nop 1
    v_fmac_f32 v110, s27, v90
    v_readlane_b32 s27, v39, 35
    s_nop 1
    v_fmac_f32 v110, s27, v91
    v_readlane_b32 s27, v36, 51
    s_nop 1
    v_fmac_f32 v110, s27, v92
    v_readlane_b32 s27, v37, 51
    s_nop 1
    v_fmac_f32 v110, s27, v93
    v_readlane_b32 s27, v38, 51
    s_nop 1
    v_fmac_f32 v110, s27, v94
    v_readlane_b32 s27, v39, 51
    s_nop 1
    v_fmac_f32 v110, s27, v95
    v_readlane_b32 s27, v40, 3
    s_nop 1
    v_fmac_f32 v110, s27, v96
    v_readlane_b32 s27, v41, 3
    s_nop 1
    v_fmac_f32 v110, s27, v97
    v_readlane_b32 s27, v42, 3
    s_nop 1
    v_fmac_f32 v110, s27, v98
    v_readlane_b32 s27, v43, 3
    s_nop 1
    v_fmac_f32 v110, s27, v99
    v_readlane_b32 s27, v40, 19
    s_nop 1
    v_fmac_f32 v110, s27, v100
    v_readlane_b32 s27, v41, 19
    s_nop 1
    v_fmac_f32 v110, s27, v101
    v_readlane_b32 s27, v42, 19
    s_nop 1
    v_fmac_f32 v110, s27, v102
    v_readlane_b32 s27, v43, 19
    s_nop 1
    v_fmac_f32 v110, s27, v103
    v_cvt_pk_bf16_f32 v110, v110, v110
    ds_write_b16 v9, v110 offset:10624
    v_mov_b32 v110, 0
    v_readlane_b32 s27, v32, 4
    s_nop 1
    v_fmac_f32 v110, s27, v64
    v_readlane_b32 s27, v33, 4
    s_nop 1
    v_fmac_f32 v110, s27, v65
    v_readlane_b32 s27, v34, 4
    s_nop 1
    v_fmac_f32 v110, s27, v66
    v_readlane_b32 s27, v35, 4
    s_nop 1
    v_fmac_f32 v110, s27, v67
    v_readlane_b32 s27, v32, 20
    s_nop 1
    v_fmac_f32 v110, s27, v68
    v_readlane_b32 s27, v33, 20
    s_nop 1
    v_fmac_f32 v110, s27, v69
    v_readlane_b32 s27, v34, 20
    s_nop 1
    v_fmac_f32 v110, s27, v70
    v_readlane_b32 s27, v35, 20
    s_nop 1
    v_fmac_f32 v110, s27, v71
    v_readlane_b32 s27, v32, 36
    s_nop 1
    v_fmac_f32 v110, s27, v72
    v_readlane_b32 s27, v33, 36
    s_nop 1
    v_fmac_f32 v110, s27, v73
    v_readlane_b32 s27, v34, 36
    s_nop 1
    v_fmac_f32 v110, s27, v74
    v_readlane_b32 s27, v35, 36
    s_nop 1
    v_fmac_f32 v110, s27, v75
    v_readlane_b32 s27, v32, 52
    s_nop 1
    v_fmac_f32 v110, s27, v76
    v_readlane_b32 s27, v33, 52
    s_nop 1
    v_fmac_f32 v110, s27, v77
    v_readlane_b32 s27, v34, 52
    s_nop 1
    v_fmac_f32 v110, s27, v78
    v_readlane_b32 s27, v35, 52
    s_nop 1
    v_fmac_f32 v110, s27, v79
    v_readlane_b32 s27, v36, 4
    s_nop 1
    v_fmac_f32 v110, s27, v80
    v_readlane_b32 s27, v37, 4
    s_nop 1
    v_fmac_f32 v110, s27, v81
    v_readlane_b32 s27, v38, 4
    s_nop 1
    v_fmac_f32 v110, s27, v82
    v_readlane_b32 s27, v39, 4
    s_nop 1
    v_fmac_f32 v110, s27, v83
    v_readlane_b32 s27, v36, 20
    s_nop 1
    v_fmac_f32 v110, s27, v84
    v_readlane_b32 s27, v37, 20
    s_nop 1
    v_fmac_f32 v110, s27, v85
    v_readlane_b32 s27, v38, 20
    s_nop 1
    v_fmac_f32 v110, s27, v86
    v_readlane_b32 s27, v39, 20
    s_nop 1
    v_fmac_f32 v110, s27, v87
    v_readlane_b32 s27, v36, 36
    s_nop 1
    v_fmac_f32 v110, s27, v88
    v_readlane_b32 s27, v37, 36
    s_nop 1
    v_fmac_f32 v110, s27, v89
    v_readlane_b32 s27, v38, 36
    s_nop 1
    v_fmac_f32 v110, s27, v90
    v_readlane_b32 s27, v39, 36
    s_nop 1
    v_fmac_f32 v110, s27, v91
    v_readlane_b32 s27, v36, 52
    s_nop 1
    v_fmac_f32 v110, s27, v92
    v_readlane_b32 s27, v37, 52
    s_nop 1
    v_fmac_f32 v110, s27, v93
    v_readlane_b32 s27, v38, 52
    s_nop 1
    v_fmac_f32 v110, s27, v94
    v_readlane_b32 s27, v39, 52
    s_nop 1
    v_fmac_f32 v110, s27, v95
    v_readlane_b32 s27, v40, 4
    s_nop 1
    v_fmac_f32 v110, s27, v96
    v_readlane_b32 s27, v41, 4
    s_nop 1
    v_fmac_f32 v110, s27, v97
    v_readlane_b32 s27, v42, 4
    s_nop 1
    v_fmac_f32 v110, s27, v98
    v_readlane_b32 s27, v43, 4
    s_nop 1
    v_fmac_f32 v110, s27, v99
    v_readlane_b32 s27, v40, 20
    s_nop 1
    v_fmac_f32 v110, s27, v100
    v_readlane_b32 s27, v41, 20
    s_nop 1
    v_fmac_f32 v110, s27, v101
    v_readlane_b32 s27, v42, 20
    s_nop 1
    v_fmac_f32 v110, s27, v102
    v_readlane_b32 s27, v43, 20
    s_nop 1
    v_fmac_f32 v110, s27, v103
    v_cvt_pk_bf16_f32 v110, v110, v110
    ds_write_b16 v9, v110 offset:10752
    v_mov_b32 v110, 0
    v_readlane_b32 s27, v32, 5
    s_nop 1
    v_fmac_f32 v110, s27, v64
    v_readlane_b32 s27, v33, 5
    s_nop 1
    v_fmac_f32 v110, s27, v65
    v_readlane_b32 s27, v34, 5
    s_nop 1
    v_fmac_f32 v110, s27, v66
    v_readlane_b32 s27, v35, 5
    s_nop 1
    v_fmac_f32 v110, s27, v67
    v_readlane_b32 s27, v32, 21
    s_nop 1
    v_fmac_f32 v110, s27, v68
    v_readlane_b32 s27, v33, 21
    s_nop 1
    v_fmac_f32 v110, s27, v69
    v_readlane_b32 s27, v34, 21
    s_nop 1
    v_fmac_f32 v110, s27, v70
    v_readlane_b32 s27, v35, 21
    s_nop 1
    v_fmac_f32 v110, s27, v71
    v_readlane_b32 s27, v32, 37
    s_nop 1
    v_fmac_f32 v110, s27, v72
    v_readlane_b32 s27, v33, 37
    s_nop 1
    v_fmac_f32 v110, s27, v73
    v_readlane_b32 s27, v34, 37
    s_nop 1
    v_fmac_f32 v110, s27, v74
    v_readlane_b32 s27, v35, 37
    s_nop 1
    v_fmac_f32 v110, s27, v75
    v_readlane_b32 s27, v32, 53
    s_nop 1
    v_fmac_f32 v110, s27, v76
    v_readlane_b32 s27, v33, 53
    s_nop 1
    v_fmac_f32 v110, s27, v77
    v_readlane_b32 s27, v34, 53
    s_nop 1
    v_fmac_f32 v110, s27, v78
    v_readlane_b32 s27, v35, 53
    s_nop 1
    v_fmac_f32 v110, s27, v79
    v_readlane_b32 s27, v36, 5
    s_nop 1
    v_fmac_f32 v110, s27, v80
    v_readlane_b32 s27, v37, 5
    s_nop 1
    v_fmac_f32 v110, s27, v81
    v_readlane_b32 s27, v38, 5
    s_nop 1
    v_fmac_f32 v110, s27, v82
    v_readlane_b32 s27, v39, 5
    s_nop 1
    v_fmac_f32 v110, s27, v83
    v_readlane_b32 s27, v36, 21
    s_nop 1
    v_fmac_f32 v110, s27, v84
    v_readlane_b32 s27, v37, 21
    s_nop 1
    v_fmac_f32 v110, s27, v85
    v_readlane_b32 s27, v38, 21
    s_nop 1
    v_fmac_f32 v110, s27, v86
    v_readlane_b32 s27, v39, 21
    s_nop 1
    v_fmac_f32 v110, s27, v87
    v_readlane_b32 s27, v36, 37
    s_nop 1
    v_fmac_f32 v110, s27, v88
    v_readlane_b32 s27, v37, 37
    s_nop 1
    v_fmac_f32 v110, s27, v89
    v_readlane_b32 s27, v38, 37
    s_nop 1
    v_fmac_f32 v110, s27, v90
    v_readlane_b32 s27, v39, 37
    s_nop 1
    v_fmac_f32 v110, s27, v91
    v_readlane_b32 s27, v36, 53
    s_nop 1
    v_fmac_f32 v110, s27, v92
    v_readlane_b32 s27, v37, 53
    s_nop 1
    v_fmac_f32 v110, s27, v93
    v_readlane_b32 s27, v38, 53
    s_nop 1
    v_fmac_f32 v110, s27, v94
    v_readlane_b32 s27, v39, 53
    s_nop 1
    v_fmac_f32 v110, s27, v95
    v_readlane_b32 s27, v40, 5
    s_nop 1
    v_fmac_f32 v110, s27, v96
    v_readlane_b32 s27, v41, 5
    s_nop 1
    v_fmac_f32 v110, s27, v97
    v_readlane_b32 s27, v42, 5
    s_nop 1
    v_fmac_f32 v110, s27, v98
    v_readlane_b32 s27, v43, 5
    s_nop 1
    v_fmac_f32 v110, s27, v99
    v_readlane_b32 s27, v40, 21
    s_nop 1
    v_fmac_f32 v110, s27, v100
    v_readlane_b32 s27, v41, 21
    s_nop 1
    v_fmac_f32 v110, s27, v101
    v_readlane_b32 s27, v42, 21
    s_nop 1
    v_fmac_f32 v110, s27, v102
    v_readlane_b32 s27, v43, 21
    s_nop 1
    v_fmac_f32 v110, s27, v103
    v_cvt_pk_bf16_f32 v110, v110, v110
    ds_write_b16 v9, v110 offset:10880
    v_mov_b32 v110, 0
    v_readlane_b32 s27, v32, 6
    s_nop 1
    v_fmac_f32 v110, s27, v64
    v_readlane_b32 s27, v33, 6
    s_nop 1
    v_fmac_f32 v110, s27, v65
    v_readlane_b32 s27, v34, 6
    s_nop 1
    v_fmac_f32 v110, s27, v66
    v_readlane_b32 s27, v35, 6
    s_nop 1
    v_fmac_f32 v110, s27, v67
    v_readlane_b32 s27, v32, 22
    s_nop 1
    v_fmac_f32 v110, s27, v68
    v_readlane_b32 s27, v33, 22
    s_nop 1
    v_fmac_f32 v110, s27, v69
    v_readlane_b32 s27, v34, 22
    s_nop 1
    v_fmac_f32 v110, s27, v70
    v_readlane_b32 s27, v35, 22
    s_nop 1
    v_fmac_f32 v110, s27, v71
    v_readlane_b32 s27, v32, 38
    s_nop 1
    v_fmac_f32 v110, s27, v72
    v_readlane_b32 s27, v33, 38
    s_nop 1
    v_fmac_f32 v110, s27, v73
    v_readlane_b32 s27, v34, 38
    s_nop 1
    v_fmac_f32 v110, s27, v74
    v_readlane_b32 s27, v35, 38
    s_nop 1
    v_fmac_f32 v110, s27, v75
    v_readlane_b32 s27, v32, 54
    s_nop 1
    v_fmac_f32 v110, s27, v76
    v_readlane_b32 s27, v33, 54
    s_nop 1
    v_fmac_f32 v110, s27, v77
    v_readlane_b32 s27, v34, 54
    s_nop 1
    v_fmac_f32 v110, s27, v78
    v_readlane_b32 s27, v35, 54
    s_nop 1
    v_fmac_f32 v110, s27, v79
    v_readlane_b32 s27, v36, 6
    s_nop 1
    v_fmac_f32 v110, s27, v80
    v_readlane_b32 s27, v37, 6
    s_nop 1
    v_fmac_f32 v110, s27, v81
    v_readlane_b32 s27, v38, 6
    s_nop 1
    v_fmac_f32 v110, s27, v82
    v_readlane_b32 s27, v39, 6
    s_nop 1
    v_fmac_f32 v110, s27, v83
    v_readlane_b32 s27, v36, 22
    s_nop 1
    v_fmac_f32 v110, s27, v84
    v_readlane_b32 s27, v37, 22
    s_nop 1
    v_fmac_f32 v110, s27, v85
    v_readlane_b32 s27, v38, 22
    s_nop 1
    v_fmac_f32 v110, s27, v86
    v_readlane_b32 s27, v39, 22
    s_nop 1
    v_fmac_f32 v110, s27, v87
    v_readlane_b32 s27, v36, 38
    s_nop 1
    v_fmac_f32 v110, s27, v88
    v_readlane_b32 s27, v37, 38
    s_nop 1
    v_fmac_f32 v110, s27, v89
    v_readlane_b32 s27, v38, 38
    s_nop 1
    v_fmac_f32 v110, s27, v90
    v_readlane_b32 s27, v39, 38
    s_nop 1
    v_fmac_f32 v110, s27, v91
    v_readlane_b32 s27, v36, 54
    s_nop 1
    v_fmac_f32 v110, s27, v92
    v_readlane_b32 s27, v37, 54
    s_nop 1
    v_fmac_f32 v110, s27, v93
    v_readlane_b32 s27, v38, 54
    s_nop 1
    v_fmac_f32 v110, s27, v94
    v_readlane_b32 s27, v39, 54
    s_nop 1
    v_fmac_f32 v110, s27, v95
    v_readlane_b32 s27, v40, 6
    s_nop 1
    v_fmac_f32 v110, s27, v96
    v_readlane_b32 s27, v41, 6
    s_nop 1
    v_fmac_f32 v110, s27, v97
    v_readlane_b32 s27, v42, 6
    s_nop 1
    v_fmac_f32 v110, s27, v98
    v_readlane_b32 s27, v43, 6
    s_nop 1
    v_fmac_f32 v110, s27, v99
    v_readlane_b32 s27, v40, 22
    s_nop 1
    v_fmac_f32 v110, s27, v100
    v_readlane_b32 s27, v41, 22
    s_nop 1
    v_fmac_f32 v110, s27, v101
    v_readlane_b32 s27, v42, 22
    s_nop 1
    v_fmac_f32 v110, s27, v102
    v_readlane_b32 s27, v43, 22
    s_nop 1
    v_fmac_f32 v110, s27, v103
    v_cvt_pk_bf16_f32 v110, v110, v110
    ds_write_b16 v9, v110 offset:11008
    v_mov_b32 v110, 0
    v_readlane_b32 s27, v32, 7
    s_nop 1
    v_fmac_f32 v110, s27, v64
    v_readlane_b32 s27, v33, 7
    s_nop 1
    v_fmac_f32 v110, s27, v65
    v_readlane_b32 s27, v34, 7
    s_nop 1
    v_fmac_f32 v110, s27, v66
    v_readlane_b32 s27, v35, 7
    s_nop 1
    v_fmac_f32 v110, s27, v67
    v_readlane_b32 s27, v32, 23
    s_nop 1
    v_fmac_f32 v110, s27, v68
    v_readlane_b32 s27, v33, 23
    s_nop 1
    v_fmac_f32 v110, s27, v69
    v_readlane_b32 s27, v34, 23
    s_nop 1
    v_fmac_f32 v110, s27, v70
    v_readlane_b32 s27, v35, 23
    s_nop 1
    v_fmac_f32 v110, s27, v71
    v_readlane_b32 s27, v32, 39
    s_nop 1
    v_fmac_f32 v110, s27, v72
    v_readlane_b32 s27, v33, 39
    s_nop 1
    v_fmac_f32 v110, s27, v73
    v_readlane_b32 s27, v34, 39
    s_nop 1
    v_fmac_f32 v110, s27, v74
    v_readlane_b32 s27, v35, 39
    s_nop 1
    v_fmac_f32 v110, s27, v75
    v_readlane_b32 s27, v32, 55
    s_nop 1
    v_fmac_f32 v110, s27, v76
    v_readlane_b32 s27, v33, 55
    s_nop 1
    v_fmac_f32 v110, s27, v77
    v_readlane_b32 s27, v34, 55
    s_nop 1
    v_fmac_f32 v110, s27, v78
    v_readlane_b32 s27, v35, 55
    s_nop 1
    v_fmac_f32 v110, s27, v79
    v_readlane_b32 s27, v36, 7
    s_nop 1
    v_fmac_f32 v110, s27, v80
    v_readlane_b32 s27, v37, 7
    s_nop 1
    v_fmac_f32 v110, s27, v81
    v_readlane_b32 s27, v38, 7
    s_nop 1
    v_fmac_f32 v110, s27, v82
    v_readlane_b32 s27, v39, 7
    s_nop 1
    v_fmac_f32 v110, s27, v83
    v_readlane_b32 s27, v36, 23
    s_nop 1
    v_fmac_f32 v110, s27, v84
    v_readlane_b32 s27, v37, 23
    s_nop 1
    v_fmac_f32 v110, s27, v85
    v_readlane_b32 s27, v38, 23
    s_nop 1
    v_fmac_f32 v110, s27, v86
    v_readlane_b32 s27, v39, 23
    s_nop 1
    v_fmac_f32 v110, s27, v87
    v_readlane_b32 s27, v36, 39
    s_nop 1
    v_fmac_f32 v110, s27, v88
    v_readlane_b32 s27, v37, 39
    s_nop 1
    v_fmac_f32 v110, s27, v89
    v_readlane_b32 s27, v38, 39
    s_nop 1
    v_fmac_f32 v110, s27, v90
    v_readlane_b32 s27, v39, 39
    s_nop 1
    v_fmac_f32 v110, s27, v91
    v_readlane_b32 s27, v36, 55
    s_nop 1
    v_fmac_f32 v110, s27, v92
    v_readlane_b32 s27, v37, 55
    s_nop 1
    v_fmac_f32 v110, s27, v93
    v_readlane_b32 s27, v38, 55
    s_nop 1
    v_fmac_f32 v110, s27, v94
    v_readlane_b32 s27, v39, 55
    s_nop 1
    v_fmac_f32 v110, s27, v95
    v_readlane_b32 s27, v40, 7
    s_nop 1
    v_fmac_f32 v110, s27, v96
    v_readlane_b32 s27, v41, 7
    s_nop 1
    v_fmac_f32 v110, s27, v97
    v_readlane_b32 s27, v42, 7
    s_nop 1
    v_fmac_f32 v110, s27, v98
    v_readlane_b32 s27, v43, 7
    s_nop 1
    v_fmac_f32 v110, s27, v99
    v_readlane_b32 s27, v40, 23
    s_nop 1
    v_fmac_f32 v110, s27, v100
    v_readlane_b32 s27, v41, 23
    s_nop 1
    v_fmac_f32 v110, s27, v101
    v_readlane_b32 s27, v42, 23
    s_nop 1
    v_fmac_f32 v110, s27, v102
    v_readlane_b32 s27, v43, 23
    s_nop 1
    v_fmac_f32 v110, s27, v103
    v_cvt_pk_bf16_f32 v110, v110, v110
    ds_write_b16 v9, v110 offset:11136
    s_waitcnt lgkmcnt(0)
cha_kernel_w:
    s_barrier
    v_and_b32 v9, 7, v1
    v_lshlrev_b32 v9, 7, v9
    v_lshl_add_u32 v9, v2, 4, v9
    ds_read_b128 v[10:13], v9 offset:10240
    ds_read_b128 v[14:17], v9 offset:10304
    s_waitcnt lgkmcnt(0)
    v_mov_b32 v32, 0
    v_mov_b32 v33, 0
    v_mov_b32 v34, 0
    v_mov_b32 v35, 0
    s_nop 1
    v_mfma_f32_16x16x32_bf16 v[32:35], a[168:171], v[10:13], v[32:35]
    v_mfma_f32_16x16x32_bf16 v[32:35], a[172:175], v[14:17], v[32:35]
    v_mov_b32 v36, 0
    v_mov_b32 v37, 0
    v_mov_b32 v38, 0
    v_mov_b32 v39, 0
    s_nop 1
    v_mfma_f32_16x16x32_bf16 v[36:39], a[176:179], v[10:13], v[36:39]
    v_mfma_f32_16x16x32_bf16 v[36:39], a[180:183], v[14:17], v[36:39]
    v_mov_b32 v40, 0
    v_mov_b32 v41, 0
    v_mov_b32 v42, 0
    v_mov_b32 v43, 0
    s_nop 1
    v_mfma_f32_16x16x32_bf16 v[40:43], a[184:187], v[10:13], v[40:43]
    v_mfma_f32_16x16x32_bf16 v[40:43], a[188:191], v[14:17], v[40:43]
    v_mov_b32 v44, 0
    v_mov_b32 v45, 0
    v_mov_b32 v46, 0
    v_mov_b32 v47, 0
    s_nop 1
    v_mfma_f32_16x16x32_bf16 v[44:47], a[192:195], v[10:13], v[44:47]
    v_mfma_f32_16x16x32_bf16 v[44:47], a[196:199], v[14:17], v[44:47]
    v_mov_b32 v48, 0
    v_mov_b32 v49, 0
    v_mov_b32 v50, 0
    v_mov_b32 v51, 0
    s_nop 1
    v_mfma_f32_16x16x32_bf16 v[48:51], a[200:203], v[10:13], v[48:51]
    v_mfma_f32_16x16x32_bf16 v[48:51], a[204:207], v[14:17], v[48:51]
    v_mov_b32 v52, 0
    v_mov_b32 v53, 0
    v_mov_b32 v54, 0
    v_mov_b32 v55, 0
    s_nop 1
    v_mfma_f32_16x16x32_bf16 v[52:55], a[208:211], v[10:13], v[52:55]
    v_mfma_f32_16x16x32_bf16 v[52:55], a[212:215], v[14:17], v[52:55]
    v_mov_b32 v56, 0
    v_mov_b32 v57, 0
    v_mov_b32 v58, 0
    v_mov_b32 v59, 0
    s_nop 1
    v_mfma_f32_16x16x32_bf16 v[56:59], a[216:219], v[10:13], v[56:59]
    v_mfma_f32_16x16x32_bf16 v[56:59], a[220:223], v[14:17], v[56:59]
    s_nop 7
    s_nop 7
    s_and_b32 s28, s20, 1
    s_mul_i32 s28, s28, 917504
    s_add_u32 s28, s28, 108265472
    s_mul_i32 s29, s2, 224
    s_add_u32 s29, s29, s28
    v_cmp_gt_u32 vcc, 8, v1
    s_and_saveexec_b64 s[30:31], vcc
    s_mul_i32 s5, s3, 112
    v_lshl_add_u32 v5, v2, 2, s5
    v_add_u32 v5, 0, v5
    v_mul_u32_u24 v6, 9363, v5
    v_lshrrev_b32 v6, 16, v6
    v_mul_u32_u24 v7, 7, v6
    v_sub_u32 v7, v5, v7
    v_mul_u32_u24 v6, 14336, v6
    v_mul_u32_u24 v8, 28, v1
    v_lshl_add_u32 v6, v7, 2, v6
    v_add_u32 v6, v6, v8
    buffer_store_dword v32, v6, s[8:11], s29 offen sc1
    s_mul_i32 s5, s3, 112
    v_lshl_add_u32 v5, v2, 2, s5
    v_add_u32 v5, 1, v5
    v_mul_u32_u24 v6, 9363, v5
    v_lshrrev_b32 v6, 16, v6
    v_mul_u32_u24 v7, 7, v6
    v_sub_u32 v7, v5, v7
    v_mul_u32_u24 v6, 14336, v6
    v_mul_u32_u24 v8, 28, v1
    v_lshl_add_u32 v6, v7, 2, v6
    v_add_u32 v6, v6, v8
    buffer_store_dword v33, v6, s[8:11], s29 offen sc1
    s_mul_i32 s5, s3, 112
    v_lshl_add_u32 v5, v2, 2, s5
    v_add_u32 v5, 2, v5
    v_mul_u32_u24 v6, 9363, v5
    v_lshrrev_b32 v6, 16, v6
    v_mul_u32_u24 v7, 7, v6
    v_sub_u32 v7, v5, v7
    v_mul_u32_u24 v6, 14336, v6
    v_mul_u32_u24 v8, 28, v1
    v_lshl_add_u32 v6, v7, 2, v6
    v_add_u32 v6, v6, v8
    buffer_store_dword v34, v6, s[8:11], s29 offen sc1
    s_mul_i32 s5, s3, 112
    v_lshl_add_u32 v5, v2, 2, s5
    v_add_u32 v5, 3, v5
    v_mul_u32_u24 v6, 9363, v5
    v_lshrrev_b32 v6, 16, v6
    v_mul_u32_u24 v7, 7, v6
    v_sub_u32 v7, v5, v7
    v_mul_u32_u24 v6, 14336, v6
    v_mul_u32_u24 v8, 28, v1
    v_lshl_add_u32 v6, v7, 2, v6
    v_add_u32 v6, v6, v8
    buffer_store_dword v35, v6, s[8:11], s29 offen sc1
    s_mul_i32 s5, s3, 112
    v_lshl_add_u32 v5, v2, 2, s5
    v_add_u32 v5, 16, v5
    v_mul_u32_u24 v6, 9363, v5
    v_lshrrev_b32 v6, 16, v6
    v_mul_u32_u24 v7, 7, v6
    v_sub_u32 v7, v5, v7
    v_mul_u32_u24 v6, 14336, v6
    v_mul_u32_u24 v8, 28, v1
    v_lshl_add_u32 v6, v7, 2, v6
    v_add_u32 v6, v6, v8
    buffer_store_dword v36, v6, s[8:11], s29 offen sc1
    s_mul_i32 s5, s3, 112
    v_lshl_add_u32 v5, v2, 2, s5
    v_add_u32 v5, 17, v5
    v_mul_u32_u24 v6, 9363, v5
    v_lshrrev_b32 v6, 16, v6
    v_mul_u32_u24 v7, 7, v6
    v_sub_u32 v7, v5, v7
    v_mul_u32_u24 v6, 14336, v6
    v_mul_u32_u24 v8, 28, v1
    v_lshl_add_u32 v6, v7, 2, v6
    v_add_u32 v6, v6, v8
    buffer_store_dword v37, v6, s[8:11], s29 offen sc1
    s_mul_i32 s5, s3, 112
    v_lshl_add_u32 v5, v2, 2, s5
    v_add_u32 v5, 18, v5
    v_mul_u32_u24 v6, 9363, v5
    v_lshrrev_b32 v6, 16, v6
    v_mul_u32_u24 v7, 7, v6
    v_sub_u32 v7, v5, v7
    v_mul_u32_u24 v6, 14336, v6
    v_mul_u32_u24 v8, 28, v1
    v_lshl_add_u32 v6, v7, 2, v6
    v_add_u32 v6, v6, v8
    buffer_store_dword v38, v6, s[8:11], s29 offen sc1
    s_mul_i32 s5, s3, 112
    v_lshl_add_u32 v5, v2, 2, s5
    v_add_u32 v5, 19, v5
    v_mul_u32_u24 v6, 9363, v5
    v_lshrrev_b32 v6, 16, v6
    v_mul_u32_u24 v7, 7, v6
    v_sub_u32 v7, v5, v7
    v_mul_u32_u24 v6, 14336, v6
    v_mul_u32_u24 v8, 28, v1
    v_lshl_add_u32 v6, v7, 2, v6
    v_add_u32 v6, v6, v8
    buffer_store_dword v39, v6, s[8:11], s29 offen sc1
    s_mul_i32 s5, s3, 112
    v_lshl_add_u32 v5, v2, 2, s5
    v_add_u32 v5, 32, v5
    v_mul_u32_u24 v6, 9363, v5
    v_lshrrev_b32 v6, 16, v6
    v_mul_u32_u24 v7, 7, v6
    v_sub_u32 v7, v5, v7
    v_mul_u32_u24 v6, 14336, v6
    v_mul_u32_u24 v8, 28, v1
    v_lshl_add_u32 v6, v7, 2, v6
    v_add_u32 v6, v6, v8
    buffer_store_dword v40, v6, s[8:11], s29 offen sc1
    s_mul_i32 s5, s3, 112
    v_lshl_add_u32 v5, v2, 2, s5
    v_add_u32 v5, 33, v5
    v_mul_u32_u24 v6, 9363, v5
    v_lshrrev_b32 v6, 16, v6
    v_mul_u32_u24 v7, 7, v6
    v_sub_u32 v7, v5, v7
    v_mul_u32_u24 v6, 14336, v6
    v_mul_u32_u24 v8, 28, v1
    v_lshl_add_u32 v6, v7, 2, v6
    v_add_u32 v6, v6, v8
    buffer_store_dword v41, v6, s[8:11], s29 offen sc1
    s_mul_i32 s5, s3, 112
    v_lshl_add_u32 v5, v2, 2, s5
    v_add_u32 v5, 34, v5
    v_mul_u32_u24 v6, 9363, v5
    v_lshrrev_b32 v6, 16, v6
    v_mul_u32_u24 v7, 7, v6
    v_sub_u32 v7, v5, v7
    v_mul_u32_u24 v6, 14336, v6
    v_mul_u32_u24 v8, 28, v1
    v_lshl_add_u32 v6, v7, 2, v6
    v_add_u32 v6, v6, v8
    buffer_store_dword v42, v6, s[8:11], s29 offen sc1
    s_mul_i32 s5, s3, 112
    v_lshl_add_u32 v5, v2, 2, s5
    v_add_u32 v5, 35, v5
    v_mul_u32_u24 v6, 9363, v5
    v_lshrrev_b32 v6, 16, v6
    v_mul_u32_u24 v7, 7, v6
    v_sub_u32 v7, v5, v7
    v_mul_u32_u24 v6, 14336, v6
    v_mul_u32_u24 v8, 28, v1
    v_lshl_add_u32 v6, v7, 2, v6
    v_add_u32 v6, v6, v8
    buffer_store_dword v43, v6, s[8:11], s29 offen sc1
    s_mul_i32 s5, s3, 112
    v_lshl_add_u32 v5, v2, 2, s5
    v_add_u32 v5, 48, v5
    v_mul_u32_u24 v6, 9363, v5
    v_lshrrev_b32 v6, 16, v6
    v_mul_u32_u24 v7, 7, v6
    v_sub_u32 v7, v5, v7
    v_mul_u32_u24 v6, 14336, v6
    v_mul_u32_u24 v8, 28, v1
    v_lshl_add_u32 v6, v7, 2, v6
    v_add_u32 v6, v6, v8
    buffer_store_dword v44, v6, s[8:11], s29 offen sc1
    s_mul_i32 s5, s3, 112
    v_lshl_add_u32 v5, v2, 2, s5
    v_add_u32 v5, 49, v5
    v_mul_u32_u24 v6, 9363, v5
    v_lshrrev_b32 v6, 16, v6
    v_mul_u32_u24 v7, 7, v6
    v_sub_u32 v7, v5, v7
    v_mul_u32_u24 v6, 14336, v6
    v_mul_u32_u24 v8, 28, v1
    v_lshl_add_u32 v6, v7, 2, v6
    v_add_u32 v6, v6, v8
    buffer_store_dword v45, v6, s[8:11], s29 offen sc1
    s_mul_i32 s5, s3, 112
    v_lshl_add_u32 v5, v2, 2, s5
    v_add_u32 v5, 50, v5
    v_mul_u32_u24 v6, 9363, v5
    v_lshrrev_b32 v6, 16, v6
    v_mul_u32_u24 v7, 7, v6
    v_sub_u32 v7, v5, v7
    v_mul_u32_u24 v6, 14336, v6
    v_mul_u32_u24 v8, 28, v1
    v_lshl_add_u32 v6, v7, 2, v6
    v_add_u32 v6, v6, v8
    buffer_store_dword v46, v6, s[8:11], s29 offen sc1
    s_mul_i32 s5, s3, 112
    v_lshl_add_u32 v5, v2, 2, s5
    v_add_u32 v5, 51, v5
    v_mul_u32_u24 v6, 9363, v5
    v_lshrrev_b32 v6, 16, v6
    v_mul_u32_u24 v7, 7, v6
    v_sub_u32 v7, v5, v7
    v_mul_u32_u24 v6, 14336, v6
    v_mul_u32_u24 v8, 28, v1
    v_lshl_add_u32 v6, v7, 2, v6
    v_add_u32 v6, v6, v8
    buffer_store_dword v47, v6, s[8:11], s29 offen sc1
    s_mul_i32 s5, s3, 112
    v_lshl_add_u32 v5, v2, 2, s5
    v_add_u32 v5, 64, v5
    v_mul_u32_u24 v6, 9363, v5
    v_lshrrev_b32 v6, 16, v6
    v_mul_u32_u24 v7, 7, v6
    v_sub_u32 v7, v5, v7
    v_mul_u32_u24 v6, 14336, v6
    v_mul_u32_u24 v8, 28, v1
    v_lshl_add_u32 v6, v7, 2, v6
    v_add_u32 v6, v6, v8
    buffer_store_dword v48, v6, s[8:11], s29 offen sc1
    s_mul_i32 s5, s3, 112
    v_lshl_add_u32 v5, v2, 2, s5
    v_add_u32 v5, 65, v5
    v_mul_u32_u24 v6, 9363, v5
    v_lshrrev_b32 v6, 16, v6
    v_mul_u32_u24 v7, 7, v6
    v_sub_u32 v7, v5, v7
    v_mul_u32_u24 v6, 14336, v6
    v_mul_u32_u24 v8, 28, v1
    v_lshl_add_u32 v6, v7, 2, v6
    v_add_u32 v6, v6, v8
    buffer_store_dword v49, v6, s[8:11], s29 offen sc1
    s_mul_i32 s5, s3, 112
    v_lshl_add_u32 v5, v2, 2, s5
    v_add_u32 v5, 66, v5
    v_mul_u32_u24 v6, 9363, v5
    v_lshrrev_b32 v6, 16, v6
    v_mul_u32_u24 v7, 7, v6
    v_sub_u32 v7, v5, v7
    v_mul_u32_u24 v6, 14336, v6
    v_mul_u32_u24 v8, 28, v1
    v_lshl_add_u32 v6, v7, 2, v6
    v_add_u32 v6, v6, v8
    buffer_store_dword v50, v6, s[8:11], s29 offen sc1
    s_mul_i32 s5, s3, 112
    v_lshl_add_u32 v5, v2, 2, s5
    v_add_u32 v5, 67, v5
    v_mul_u32_u24 v6, 9363, v5
    v_lshrrev_b32 v6, 16, v6
    v_mul_u32_u24 v7, 7, v6
    v_sub_u32 v7, v5, v7
    v_mul_u32_u24 v6, 14336, v6
    v_mul_u32_u24 v8, 28, v1
    v_lshl_add_u32 v6, v7, 2, v6
    v_add_u32 v6, v6, v8
    buffer_store_dword v51, v6, s[8:11], s29 offen sc1
    s_mul_i32 s5, s3, 112
    v_lshl_add_u32 v5, v2, 2, s5
    v_add_u32 v5, 80, v5
    v_mul_u32_u24 v6, 9363, v5
    v_lshrrev_b32 v6, 16, v6
    v_mul_u32_u24 v7, 7, v6
    v_sub_u32 v7, v5, v7
    v_mul_u32_u24 v6, 14336, v6
    v_mul_u32_u24 v8, 28, v1
    v_lshl_add_u32 v6, v7, 2, v6
    v_add_u32 v6, v6, v8
    buffer_store_dword v52, v6, s[8:11], s29 offen sc1
    s_mul_i32 s5, s3, 112
    v_lshl_add_u32 v5, v2, 2, s5
    v_add_u32 v5, 81, v5
    v_mul_u32_u24 v6, 9363, v5
    v_lshrrev_b32 v6, 16, v6
    v_mul_u32_u24 v7, 7, v6
    v_sub_u32 v7, v5, v7
    v_mul_u32_u24 v6, 14336, v6
    v_mul_u32_u24 v8, 28, v1
    v_lshl_add_u32 v6, v7, 2, v6
    v_add_u32 v6, v6, v8
    buffer_store_dword v53, v6, s[8:11], s29 offen sc1
    s_mul_i32 s5, s3, 112
    v_lshl_add_u32 v5, v2, 2, s5
    v_add_u32 v5, 82, v5
    v_mul_u32_u24 v6, 9363, v5
    v_lshrrev_b32 v6, 16, v6
    v_mul_u32_u24 v7, 7, v6
    v_sub_u32 v7, v5, v7
    v_mul_u32_u24 v6, 14336, v6
    v_mul_u32_u24 v8, 28, v1
    v_lshl_add_u32 v6, v7, 2, v6
    v_add_u32 v6, v6, v8
    buffer_store_dword v54, v6, s[8:11], s29 offen sc1
    s_mul_i32 s5, s3, 112
    v_lshl_add_u32 v5, v2, 2, s5
    v_add_u32 v5, 83, v5
    v_mul_u32_u24 v6, 9363, v5
    v_lshrrev_b32 v6, 16, v6
    v_mul_u32_u24 v7, 7, v6
    v_sub_u32 v7, v5, v7
    v_mul_u32_u24 v6, 14336, v6
    v_mul_u32_u24 v8, 28, v1
    v_lshl_add_u32 v6, v7, 2, v6
    v_add_u32 v6, v6, v8
    buffer_store_dword v55, v6, s[8:11], s29 offen sc1
    s_mul_i32 s5, s3, 112
    v_lshl_add_u32 v5, v2, 2, s5
    v_add_u32 v5, 96, v5
    v_mul_u32_u24 v6, 9363, v5
    v_lshrrev_b32 v6, 16, v6
    v_mul_u32_u24 v7, 7, v6
    v_sub_u32 v7, v5, v7
    v_mul_u32_u24 v6, 14336, v6
    v_mul_u32_u24 v8, 28, v1
    v_lshl_add_u32 v6, v7, 2, v6
    v_add_u32 v6, v6, v8
    buffer_store_dword v56, v6, s[8:11], s29 offen sc1
    s_mul_i32 s5, s3, 112
    v_lshl_add_u32 v5, v2, 2, s5
    v_add_u32 v5, 97, v5
    v_mul_u32_u24 v6, 9363, v5
    v_lshrrev_b32 v6, 16, v6
    v_mul_u32_u24 v7, 7, v6
    v_sub_u32 v7, v5, v7
    v_mul_u32_u24 v6, 14336, v6
    v_mul_u32_u24 v8, 28, v1
    v_lshl_add_u32 v6, v7, 2, v6
    v_add_u32 v6, v6, v8
    buffer_store_dword v57, v6, s[8:11], s29 offen sc1
    s_mul_i32 s5, s3, 112
    v_lshl_add_u32 v5, v2, 2, s5
    v_add_u32 v5, 98, v5
    v_mul_u32_u24 v6, 9363, v5
    v_lshrrev_b32 v6, 16, v6
    v_mul_u32_u24 v7, 7, v6
    v_sub_u32 v7, v5, v7
    v_mul_u32_u24 v6, 14336, v6
    v_mul_u32_u24 v8, 28, v1
    v_lshl_add_u32 v6, v7, 2, v6
    v_add_u32 v6, v6, v8
    buffer_store_dword v58, v6, s[8:11], s29 offen sc1
    s_mul_i32 s5, s3, 112
    v_lshl_add_u32 v5, v2, 2, s5
    v_add_u32 v5, 99, v5
    v_mul_u32_u24 v6, 9363, v5
    v_lshrrev_b32 v6, 16, v6
    v_mul_u32_u24 v7, 7, v6
    v_sub_u32 v7, v5, v7
    v_mul_u32_u24 v6, 14336, v6
    v_mul_u32_u24 v8, 28, v1
    v_lshl_add_u32 v6, v7, 2, v6
    v_add_u32 v6, v6, v8
    buffer_store_dword v59, v6, s[8:11], s29 offen sc1
    s_mov_b64 exec, s[30:31]
    v_cmp_gt_u32 vcc, 224, v0
    s_and_saveexec_b64 s[30:31], vcc
    s_cbranch_execz cha_kernel_r2
    v_mul_u32_u24 v5, 1171, v0
    v_lshrrev_b32 v5, 16, v5
    v_mul_u32_u24 v6, 56, v5
    v_sub_u32 v6, v0, v6
    v_mul_u32_u24 v7, 3584, v5
    v_lshl_add_u32 v7, v6, 2, v7
    s_mul_i32 s29, s2, 14336
    s_add_u32 s29, s29, s28
cha_kernel_p2:
    v_mov_b32 v29, 0
    buffer_load_dword v64, v7, s[8:11], s29 offen offset:0 sc1
    buffer_load_dword v65, v7, s[8:11], s29 offen offset:224 sc1
    buffer_load_dword v66, v7, s[8:11], s29 offen offset:448 sc1
    buffer_load_dword v67, v7, s[8:11], s29 offen offset:672 sc1
    buffer_load_dword v68, v7, s[8:11], s29 offen offset:896 sc1
    buffer_load_dword v69, v7, s[8:11], s29 offen offset:1120 sc1
    buffer_load_dword v70, v7, s[8:11], s29 offen offset:1344 sc1
    buffer_load_dword v71, v7, s[8:11], s29 offen offset:1568 sc1
    buffer_load_dword v72, v7, s[8:11], s29 offen offset:1792 sc1
    buffer_load_dword v73, v7, s[8:11], s29 offen offset:2016 sc1
    buffer_load_dword v74, v7, s[8:11], s29 offen offset:2240 sc1
    buffer_load_dword v75, v7, s[8:11], s29 offen offset:2464 sc1
    buffer_load_dword v76, v7, s[8:11], s29 offen offset:2688 sc1
    buffer_load_dword v77, v7, s[8:11], s29 offen offset:2912 sc1
    buffer_load_dword v78, v7, s[8:11], s29 offen offset:3136 sc1
    buffer_load_dword v79, v7, s[8:11], s29 offen offset:3360 sc1
    s_waitcnt vmcnt(0)
    v_cmp_eq_u32 vcc, -1, v64
    s_nop 1
    v_addc_co_u32 v29, vcc, 0, v29, vcc
    v_cmp_eq_u32 vcc, -1, v65
    s_nop 1
    v_addc_co_u32 v29, vcc, 0, v29, vcc
    v_cmp_eq_u32 vcc, -1, v66
    s_nop 1
    v_addc_co_u32 v29, vcc, 0, v29, vcc
    v_cmp_eq_u32 vcc, -1, v67
    s_nop 1
    v_addc_co_u32 v29, vcc, 0, v29, vcc
    v_cmp_eq_u32 vcc, -1, v68
    s_nop 1
    v_addc_co_u32 v29, vcc, 0, v29, vcc
    v_cmp_eq_u32 vcc, -1, v69
    s_nop 1
    v_addc_co_u32 v29, vcc, 0, v29, vcc
    v_cmp_eq_u32 vcc, -1, v70
    s_nop 1
    v_addc_co_u32 v29, vcc, 0, v29, vcc
    v_cmp_eq_u32 vcc, -1, v71
    s_nop 1
    v_addc_co_u32 v29, vcc, 0, v29, vcc
    v_cmp_eq_u32 vcc, -1, v72
    s_nop 1
    v_addc_co_u32 v29, vcc, 0, v29, vcc
    v_cmp_eq_u32 vcc, -1, v73
    s_nop 1
    v_addc_co_u32 v29, vcc, 0, v29, vcc
    v_cmp_eq_u32 vcc, -1, v74
    s_nop 1
    v_addc_co_u32 v29, vcc, 0, v29, vcc
    v_cmp_eq_u32 vcc, -1, v75
    s_nop 1
    v_addc_co_u32 v29, vcc, 0, v29, vcc
    v_cmp_eq_u32 vcc, -1, v76
    s_nop 1
    v_addc_co_u32 v29, vcc, 0, v29, vcc
    v_cmp_eq_u32 vcc, -1, v77
    s_nop 1
    v_addc_co_u32 v29, vcc, 0, v29, vcc
    v_cmp_eq_u32 vcc, -1, v78
    s_nop 1
    v_addc_co_u32 v29, vcc, 0, v29, vcc
    v_cmp_eq_u32 vcc, -1, v79
    s_nop 1
    v_addc_co_u32 v29, vcc, 0, v29, vcc
    v_cmp_ne_u32 vcc, 0, v29
    s_nop 1
    s_cbranch_vccnz cha_kernel_p2
    v_mov_b32 v8, -1
    buffer_store_dword v8, v7, s[8:11], s29 offen offset:0 sc1
    buffer_store_dword v8, v7, s[8:11], s29 offen offset:224 sc1
    buffer_store_dword v8, v7, s[8:11], s29 offen offset:448 sc1
    buffer_store_dword v8, v7, s[8:11], s29 offen offset:672 sc1
    buffer_store_dword v8, v7, s[8:11], s29 offen offset:896 sc1
    buffer_store_dword v8, v7, s[8:11], s29 offen offset:1120 sc1
    buffer_store_dword v8, v7, s[8:11], s29 offen offset:1344 sc1
    buffer_store_dword v8, v7, s[8:11], s29 offen offset:1568 sc1
    buffer_store_dword v8, v7, s[8:11], s29 offen offset:1792 sc1
    buffer_store_dword v8, v7, s[8:11], s29 offen offset:2016 sc1
    buffer_store_dword v8, v7, s[8:11], s29 offen offset:2240 sc1
    buffer_store_dword v8, v7, s[8:11], s29 offen offset:2464 sc1
    buffer_store_dword v8, v7, s[8:11], s29 offen offset:2688 sc1
    buffer_store_dword v8, v7, s[8:11], s29 offen offset:2912 sc1
    buffer_store_dword v8, v7, s[8:11], s29 offen offset:3136 sc1
    buffer_store_dword v8, v7, s[8:11], s29 offen offset:3360 sc1
    v_add_f32 v64, v64, v65
    v_add_f32 v64, v64, v66
    v_add_f32 v64, v64, v67
    v_add_f32 v64, v64, v68
    v_add_f32 v64, v64, v69
    v_add_f32 v64, v64, v70
    v_add_f32 v64, v64, v71
    v_add_f32 v64, v64, v72
    v_add_f32 v64, v64, v73
    v_add_f32 v64, v64, v74
    v_add_f32 v64, v64, v75
    v_add_f32 v64, v64, v76
    v_add_f32 v64, v64, v77
    v_add_f32 v64, v64, v78
    v_add_f32 v64, v64, v79
    v_lshlrev_b32 v9, 2, v0
    ds_write_b32 v9, v64 offset:11264
cha_kernel_r2:
    s_mov_b64 exec, s[30:31]
    s_waitcnt vmcnt(0) lgkmcnt(0)
    s_barrier
    s_add_u32 s24, s23, s2
    s_lshl_b32 s24, s24, 7
    s_add_u32 s24, s24, 110100480
    v_cmp_gt_u32 vcc, 56, v0
    s_and_saveexec_b64 s[30:31], vcc
    s_cbranch_execz cha_kernel_r3
    v_lshlrev_b32 v9, 2, v0
    ds_read_b32 v10, v9 offset:11264
    ds_read_b32 v11, v9 offset:11488
    ds_read_b32 v12, v9 offset:11712
    ds_read_b32 v13, v9 offset:11936
    s_waitcnt lgkmcnt(0)
    v_add_f32 v10, v10, v11
    v_add_f32 v12, v12, v13
    v_add_f32 v10, v10, v12
    v_cvt_pk_bf16_f32 v10, v10, v10
    v_lshlrev_b32 v9, 1, v0
    buffer_store_short v10, v9, s[8:11], s24 offen sc1
cha_kernel_r3:
    s_mov_b64 exec, s[30:31]
    s_lshl_b32 s25, s23, 7
    s_add_u32 s25, s25, 110100480
    v_lshrrev_b32 v5, 2, v0
    v_and_b32 v6, 3, v0
    v_lshlrev_b32 v7, 7, v5
    v_mul_u32_u24 v8, 28, v6
    v_add_u32 v7, v7, v8
cha_kernel_p3:
    v_mov_b32 v29, 0
    buffer_load_ushort v64, v7, s[8:11], s25 offen offset:0 sc1
    buffer_load_ushort v65, v7, s[8:11], s25 offen offset:2 sc1
    buffer_load_ushort v66, v7, s[8:11], s25 offen offset:4 sc1
    buffer_load_ushort v67, v7, s[8:11], s25 offen offset:6 sc1
    buffer_load_ushort v68, v7, s[8:11], s25 offen offset:8 sc1
    buffer_load_ushort v69, v7, s[8:11], s25 offen offset:10 sc1
    buffer_load_ushort v70, v7, s[8:11], s25 offen offset:12 sc1
    buffer_load_ushort v71, v7, s[8:11], s25 offen offset:14 sc1
    buffer_load_ushort v72, v7, s[8:11], s25 offen offset:16 sc1
    buffer_load_ushort v73, v7, s[8:11], s25 offen offset:18 sc1
    buffer_load_ushort v74, v7, s[8:11], s25 offen offset:20 sc1
    buffer_load_ushort v75, v7, s[8:11], s25 offen offset:22 sc1
    buffer_load_ushort v76, v7, s[8:11], s25 offen offset:24 sc1
    buffer_load_ushort v77, v7, s[8:11], s25 offen offset:26 sc1
    s_waitcnt vmcnt(0)
    v_cmp_eq_u32 vcc, 0xffff, v64
    s_nop 1
    v_addc_co_u32 v29, vcc, 0, v29, vcc
    v_cmp_eq_u32 vcc, 0xffff, v65
    s_nop 1
    v_addc_co_u32 v29, vcc, 0, v29, vcc
    v_cmp_eq_u32 vcc, 0xffff, v66
    s_nop 1
    v_addc_co_u32 v29, vcc, 0, v29, vcc
    v_cmp_eq_u32 vcc, 0xffff, v67
    s_nop 1
    v_addc_co_u32 v29, vcc, 0, v29, vcc
    v_cmp_eq_u32 vcc, 0xffff, v68
    s_nop 1
    v_addc_co_u32 v29, vcc, 0, v29, vcc
    v_cmp_eq_u32 vcc, 0xffff, v69
    s_nop 1
    v_addc_co_u32 v29, vcc, 0, v29, vcc
    v_cmp_eq_u32 vcc, 0xffff, v70
    s_nop 1
    v_addc_co_u32 v29, vcc, 0, v29, vcc
    v_cmp_eq_u32 vcc, 0xffff, v71
    s_nop 1
    v_addc_co_u32 v29, vcc, 0, v29, vcc
    v_cmp_eq_u32 vcc, 0xffff, v72
    s_nop 1
    v_addc_co_u32 v29, vcc, 0, v29, vcc
    v_cmp_eq_u32 vcc, 0xffff, v73
    s_nop 1
    v_addc_co_u32 v29, vcc, 0, v29, vcc
    v_cmp_eq_u32 vcc, 0xffff, v74
    s_nop 1
    v_addc_co_u32 v29, vcc, 0, v29, vcc
    v_cmp_eq_u32 vcc, 0xffff, v75
    s_nop 1
    v_addc_co_u32 v29, vcc, 0, v29, vcc
    v_cmp_eq_u32 vcc, 0xffff, v76
    s_nop 1
    v_addc_co_u32 v29, vcc, 0, v29, vcc
    v_cmp_eq_u32 vcc, 0xffff, v77
    s_nop 1
    v_addc_co_u32 v29, vcc, 0, v29, vcc
    v_cmp_ne_u32 vcc, 0, v29
    s_nop 1
    s_cbranch_vccnz cha_kernel_p3
    v_mul_u32_u24 v8, 1792, v6
    v_mul_u32_u24 v9, 14, v5
    v_add_u32 v8, v8, v9
    ds_write_b16 v8, v64 offset:0
    ds_write_b16 v8, v65 offset:2
    ds_write_b16 v8, v66 offset:4
    ds_write_b16 v8, v67 offset:6
    ds_write_b16 v8, v68 offset:8
    ds_write_b16 v8, v69 offset:10
    ds_write_b16 v8, v70 offset:12
    ds_write_b16 v8, v71 offset:896
    ds_write_b16 v8, v72 offset:898
    ds_write_b16 v8, v73 offset:900
    ds_write_b16 v8, v74 offset:902
    ds_write_b16 v8, v75 offset:904
    ds_write_b16 v8, v76 offset:906
    ds_write_b16 v8, v77 offset:908
    s_waitcnt lgkmcnt(0)
    s_barrier
    s_add_u32 s20, s20, 1
    s_cmp_lt_u32 s20, 64
    s_cbranch_scc1 cha_kernel_step
cha_kernel_end:
    s_endpgm
.globl chb_kernel
.p2align 8
.type chb_kernel,@function
chb_kernel:
    s_cmp_ge_u32 s2, 64
    s_cbranch_scc1 chb_kernel_end
    s_load_dwordx2 s[8:9], s[0:1], 120
    s_waitcnt lgkmcnt(0)
    s_mov_b32 s10, 111149056
    s_mov_b32 s11, 0x00020000
    s_load_dwordx2 s[12:13], s[0:1], 56
    s_waitcnt lgkmcnt(0)
    s_mov_b32 s14, 7168
    s_mov_b32 s15, 0x00020000
    v_lshrrev_b32 v1, 6, v0
    s_nop 0
    v_readfirstlane_b32 s3, v1
    v_and_b32 v63, 63, v0
    v_and_b32 v1, 15, v0
    v_bfe_u32 v2, v0, 4, 2
    s_lshl_b32 s4, s2, 6
    s_lshl_b32 s5, s3, 4
    s_add_u32 s5, s5, s4
    v_add_u32 v3, s5, v1
    v_mul_u32_u24 v3, 896, v3
    v_lshl_add_u32 v3, v2, 4, v3
    v_add_u32 v9, 0, v3
    buffer_load_dwordx4 v[10:13], v9, s[8:11], 0 offen
    s_waitcnt vmcnt(0)
    v_accvgpr_write_b32 a0, v10
    v_accvgpr_write_b32 a1, v11
    v_accvgpr_write_b32 a2, v12
    v_accvgpr_write_b32 a3, v13
    v_add_u32 v9, 64, v3
    buffer_load_dwordx4 v[10:13], v9, s[8:11], 0 offen
    s_waitcnt vmcnt(0)
    v_accvgpr_write_b32 a4, v10
    v_accvgpr_write_b32 a5, v11
    v_accvgpr_write_b32 a6, v12
    v_accvgpr_write_b32 a7, v13
    v_add_u32 v9, 128, v3
    buffer_load_dwordx4 v[10:13], v9, s[8:11], 0 offen
    s_waitcnt vmcnt(0)
    v_accvgpr_write_b32 a8, v10
    v_accvgpr_write_b32 a9, v11
    v_accvgpr_write_b32 a10, v12
    v_accvgpr_write_b32 a11, v13
    v_add_u32 v9, 192, v3
    buffer_load_dwordx4 v[10:13], v9, s[8:11], 0 offen
    s_waitcnt vmcnt(0)
    v_accvgpr_write_b32 a12, v10
    v_accvgpr_write_b32 a13, v11
    v_accvgpr_write_b32 a14, v12
    v_accvgpr_write_b32 a15, v13
    v_add_u32 v9, 256, v3
    buffer_load_dwordx4 v[10:13], v9, s[8:11], 0 offen
    s_waitcnt vmcnt(0)
    v_accvgpr_write_b32 a16, v10
    v_accvgpr_write_b32 a17, v11
    v_accvgpr_write_b32 a18, v12
    v_accvgpr_write_b32 a19, v13
    v_add_u32 v9, 320, v3
    buffer_load_dwordx4 v[10:13], v9, s[8:11], 0 offen
    s_waitcnt vmcnt(0)
    v_accvgpr_write_b32 a20, v10
    v_accvgpr_write_b32 a21, v11
    v_accvgpr_write_b32 a22, v12
    v_accvgpr_write_b32 a23, v13
    v_add_u32 v9, 384, v3
    buffer_load_dwordx4 v[10:13], v9, s[8:11], 0 offen
    s_waitcnt vmcnt(0)
    v_accvgpr_write_b32 a24, v10
    v_accvgpr_write_b32 a25, v11
    v_accvgpr_write_b32 a26, v12
    v_accvgpr_write_b32 a27, v13
    v_add_u32 v9, 448, v3
    buffer_load_dwordx4 v[10:13], v9, s[8:11], 0 offen
    s_waitcnt vmcnt(0)
    v_accvgpr_write_b32 a28, v10
    v_accvgpr_write_b32 a29, v11
    v_accvgpr_write_b32 a30, v12
    v_accvgpr_write_b32 a31, v13
    v_add_u32 v9, 512, v3
    buffer_load_dwordx4 v[10:13], v9, s[8:11], 0 offen
    s_waitcnt vmcnt(0)
    v_accvgpr_write_b32 a32, v10
    v_accvgpr_write_b32 a33, v11
    v_accvgpr_write_b32 a34, v12
    v_accvgpr_write_b32 a35, v13
    v_add_u32 v9, 576, v3
    buffer_load_dwordx4 v[10:13], v9, s[8:11], 0 offen
    s_waitcnt vmcnt(0)
    v_accvgpr_write_b32 a36, v10
    v_accvgpr_write_b32 a37, v11
    v_accvgpr_write_b32 a38, v12
    v_accvgpr_write_b32 a39, v13
    v_add_u32 v9, 640, v3
    buffer_load_dwordx4 v[10:13], v9, s[8:11], 0 offen
    s_waitcnt vmcnt(0)
    v_accvgpr_write_b32 a40, v10
    v_accvgpr_write_b32 a41, v11
    v_accvgpr_write_b32 a42, v12
    v_accvgpr_write_b32 a43, v13
    v_add_u32 v9, 704, v3
    buffer_load_dwordx4 v[10:13], v9, s[8:11], 0 offen
    s_waitcnt vmcnt(0)
    v_accvgpr_write_b32 a44, v10
    v_accvgpr_write_b32 a45, v11
    v_accvgpr_write_b32 a46, v12
    v_accvgpr_write_b32 a47, v13
    v_add_u32 v9, 768, v3
    buffer_load_dwordx4 v[10:13], v9, s[8:11], 0 offen
    s_waitcnt vmcnt(0)
    v_accvgpr_write_b32 a48, v10
    v_accvgpr_write_b32 a49, v11
    v_accvgpr_write_b32 a50, v12
    v_accvgpr_write_b32 a51, v13
    v_add_u32 v9, 832, v3
    buffer_load_dwordx4 v[10:13], v9, s[8:11], 0 offen
    s_waitcnt vmcnt(0)
    v_accvgpr_write_b32 a52, v10
    v_accvgpr_write_b32 a53, v11
    v_accvgpr_write_b32 a54, v12
    v_accvgpr_write_b32 a55, v13
    v_add_u32 v9, 3670016, v3
    buffer_load_dwordx4 v[10:13], v9, s[8:11], 0 offen
    s_waitcnt vmcnt(0)
    v_accvgpr_write_b32 a56, v10
    v_accvgpr_write_b32 a57, v11
    v_accvgpr_write_b32 a58, v12
    v_accvgpr_write_b32 a59, v13
    v_add_u32 v9, 3670080, v3
    buffer_load_dwordx4 v[10:13], v9, s[8:11], 0 offen
    s_waitcnt vmcnt(0)
    v_accvgpr_write_b32 a60, v10
    v_accvgpr_write_b32 a61, v11
    v_accvgpr_write_b32 a62, v12
    v_accvgpr_write_b32 a63, v13
    v_add_u32 v9, 3670144, v3
    buffer_load_dwordx4 v[10:13], v9, s[8:11], 0 offen
    s_waitcnt vmcnt(0)
    v_accvgpr_write_b32 a64, v10
    v_accvgpr_write_b32 a65, v11
    v_accvgpr_write_b32 a66, v12
    v_accvgpr_write_b32 a67, v13
    v_add_u32 v9, 3670208, v3
    buffer_load_dwordx4 v[10:13], v9, s[8:11], 0 offen
    s_waitcnt vmcnt(0)
    v_accvgpr_write_b32 a68, v10
    v_accvgpr_write_b32 a69, v11
    v_accvgpr_write_b32 a70, v12
    v_accvgpr_write_b32 a71, v13
    v_add_u32 v9, 3670272, v3
    buffer_load_dwordx4 v[10:13], v9, s[8:11], 0 offen
    s_waitcnt vmcnt(0)
    v_accvgpr_write_b32 a72, v10
    v_accvgpr_write_b32 a73, v11
    v_accvgpr_write_b32 a74, v12
    v_accvgpr_write_b32 a75, v13
    v_add_u32 v9, 3670336, v3
    buffer_load_dwordx4 v[10:13], v9, s[8:11], 0 offen
    s_waitcnt vmcnt(0)
    v_accvgpr_write_b32 a76, v10
    v_accvgpr_write_b32 a77, v11
    v_accvgpr_write_b32 a78, v12
    v_accvgpr_write_b32 a79, v13
    v_add_u32 v9, 3670400, v3
    buffer_load_dwordx4 v[10:13], v9, s[8:11], 0 offen
    s_waitcnt vmcnt(0)
    v_accvgpr_write_b32 a80, v10
    v_accvgpr_write_b32 a81, v11
    v_accvgpr_write_b32 a82, v12
    v_accvgpr_write_b32 a83, v13
    v_add_u32 v9, 3670464, v3
    buffer_load_dwordx4 v[10:13], v9, s[8:11], 0 offen
    s_waitcnt vmcnt(0)
    v_accvgpr_write_b32 a84, v10
    v_accvgpr_write_b32 a85, v11
    v_accvgpr_write_b32 a86, v12
    v_accvgpr_write_b32 a87, v13
    v_add_u32 v9, 3670528, v3
    buffer_load_dwordx4 v[10:13], v9, s[8:11], 0 offen
    s_waitcnt vmcnt(0)
    v_accvgpr_write_b32 a88, v10
    v_accvgpr_write_b32 a89, v11
    v_accvgpr_write_b32 a90, v12
    v_accvgpr_write_b32 a91, v13
    v_add_u32 v9, 3670592, v3
    buffer_load_dwordx4 v[10:13], v9, s[8:11], 0 offen
    s_waitcnt vmcnt(0)
    v_accvgpr_write_b32 a92, v10
    v_accvgpr_write_b32 a93, v11
    v_accvgpr_write_b32 a94, v12
    v_accvgpr_write_b32 a95, v13
    v_add_u32 v9, 3670656, v3
    buffer_load_dwordx4 v[10:13], v9, s[8:11], 0 offen
    s_waitcnt vmcnt(0)
    v_accvgpr_write_b32 a96, v10
    v_accvgpr_write_b32 a97, v11
    v_accvgpr_write_b32 a98, v12
    v_accvgpr_write_b32 a99, v13
    v_add_u32 v9, 3670720, v3
    buffer_load_dwordx4 v[10:13], v9, s[8:11], 0 offen
    s_waitcnt vmcnt(0)
    v_accvgpr_write_b32 a100, v10
    v_accvgpr_write_b32 a101, v11
    v_accvgpr_write_b32 a102, v12
    v_accvgpr_write_b32 a103, v13
    v_add_u32 v9, 3670784, v3
    buffer_load_dwordx4 v[10:13], v9, s[8:11], 0 offen
    s_waitcnt vmcnt(0)
    v_accvgpr_write_b32 a104, v10
    v_accvgpr_write_b32 a105, v11
    v_accvgpr_write_b32 a106, v12
    v_accvgpr_write_b32 a107, v13
    v_add_u32 v9, 3670848, v3
    buffer_load_dwordx4 v[10:13], v9, s[8:11], 0 offen
    s_waitcnt vmcnt(0)
    v_accvgpr_write_b32 a108, v10
    v_accvgpr_write_b32 a109, v11
    v_accvgpr_write_b32 a110, v12
    v_accvgpr_write_b32 a111, v13
    v_add_u32 v9, 7340032, v3
    buffer_load_dwordx4 v[10:13], v9, s[8:11], 0 offen
    s_waitcnt vmcnt(0)
    v_accvgpr_write_b32 a112, v10
    v_accvgpr_write_b32 a113, v11
    v_accvgpr_write_b32 a114, v12
    v_accvgpr_write_b32 a115, v13
    v_add_u32 v9, 7340096, v3
    buffer_load_dwordx4 v[10:13], v9, s[8:11], 0 offen
    s_waitcnt vmcnt(0)
    v_accvgpr_write_b32 a116, v10
    v_accvgpr_write_b32 a117, v11
    v_accvgpr_write_b32 a118, v12
    v_accvgpr_write_b32 a119, v13
    v_add_u32 v9, 7340160, v3
    buffer_load_dwordx4 v[10:13], v9, s[8:11], 0 offen
    s_waitcnt vmcnt(0)
    v_accvgpr_write_b32 a120, v10
    v_accvgpr_write_b32 a121, v11
    v_accvgpr_write_b32 a122, v12
    v_accvgpr_write_b32 a123, v13
    v_add_u32 v9, 7340224, v3
    buffer_load_dwordx4 v[10:13], v9, s[8:11], 0 offen
    s_waitcnt vmcnt(0)
    v_accvgpr_write_b32 a124, v10
    v_accvgpr_write_b32 a125, v11
    v_accvgpr_write_b32 a126, v12
    v_accvgpr_write_b32 a127, v13
    v_add_u32 v9, 7340288, v3
    buffer_load_dwordx4 v[10:13], v9, s[8:11], 0 offen
    s_waitcnt vmcnt(0)
    v_accvgpr_write_b32 a128, v10
    v_accvgpr_write_b32 a129, v11
    v_accvgpr_write_b32 a130, v12
    v_accvgpr_write_b32 a131, v13
    v_add_u32 v9, 7340352, v3
    buffer_load_dwordx4 v[10:13], v9, s[8:11], 0 offen
    s_waitcnt vmcnt(0)
    v_accvgpr_write_b32 a132, v10
    v_accvgpr_write_b32 a133, v11
    v_accvgpr_write_b32 a134, v12
    v_accvgpr_write_b32 a135, v13
    v_add_u32 v9, 7340416, v3
    buffer_load_dwordx4 v[10:13], v9, s[8:11], 0 offen
    s_waitcnt vmcnt(0)
    v_accvgpr_write_b32 a136, v10
    v_accvgpr_write_b32 a137, v11
    v_accvgpr_write_b32 a138, v12
    v_accvgpr_write_b32 a139, v13
    v_add_u32 v9, 7340480, v3
    buffer_load_dwordx4 v[10:13], v9, s[8:11], 0 offen
    s_waitcnt vmcnt(0)
    v_accvgpr_write_b32 a140, v10
    v_accvgpr_write_b32 a141, v11
    v_accvgpr_write_b32 a142, v12
    v_accvgpr_write_b32 a143, v13
    v_add_u32 v9, 7340544, v3
    buffer_load_dwordx4 v[10:13], v9, s[8:11], 0 offen
    s_waitcnt vmcnt(0)
    v_accvgpr_write_b32 a144, v10
    v_accvgpr_write_b32 a145, v11
    v_accvgpr_write_b32 a146, v12
    v_accvgpr_write_b32 a147, v13
    v_add_u32 v9, 7340608, v3
    buffer_load_dwordx4 v[10:13], v9, s[8:11], 0 offen
    s_waitcnt vmcnt(0)
    v_accvgpr_write_b32 a148, v10
    v_accvgpr_write_b32 a149, v11
    v_accvgpr_write_b32 a150, v12
    v_accvgpr_write_b32 a151, v13
    v_add_u32 v9, 7340672, v3
    buffer_load_dwordx4 v[10:13], v9, s[8:11], 0 offen
    s_waitcnt vmcnt(0)
    v_accvgpr_write_b32 a152, v10
    v_accvgpr_write_b32 a153, v11
    v_accvgpr_write_b32 a154, v12
    v_accvgpr_write_b32 a155, v13
    v_add_u32 v9, 7340736, v3
    buffer_load_dwordx4 v[10:13], v9, s[8:11], 0 offen
    s_waitcnt vmcnt(0)
    v_accvgpr_write_b32 a156, v10
    v_accvgpr_write_b32 a157, v11
    v_accvgpr_write_b32 a158, v12
    v_accvgpr_write_b32 a159, v13
    v_add_u32 v9, 7340800, v3
    buffer_load_dwordx4 v[10:13], v9, s[8:11], 0 offen
    s_waitcnt vmcnt(0)
    v_accvgpr_write_b32 a160, v10
    v_accvgpr_write_b32 a161, v11
    v_accvgpr_write_b32 a162, v12
    v_accvgpr_write_b32 a163, v13
    v_add_u32 v9, 7340864, v3
    buffer_load_dwordx4 v[10:13], v9, s[8:11], 0 offen
    s_waitcnt vmcnt(0)
    v_accvgpr_write_b32 a164, v10
    v_accvgpr_write_b32 a165, v11
    v_accvgpr_write_b32 a166, v12
    v_accvgpr_write_b32 a167, v13
    s_mul_i32 s5, s3, 112
    v_add_u32 v3, s5, v1
    v_lshlrev_b32 v3, 13, v3
    v_lshl_add_u32 v3, v2, 4, v3
    s_lshl_b32 s6, s4, 1
    v_add_u32 v3, s6, v3
    v_add_u32 v9, 11010048, v3
    buffer_load_dwordx4 v[10:13], v9, s[8:11], 0 offen
    s_waitcnt vmcnt(0)
    v_accvgpr_write_b32 a168, v10
    v_accvgpr_write_b32 a169, v11
    v_accvgpr_write_b32 a170, v12
    v_accvgpr_write_b32 a171, v13
    v_add_u32 v9, 11010112, v3
    buffer_load_dwordx4 v[10:13], v9, s[8:11], 0 offen
    s_waitcnt vmcnt(0)
    v_accvgpr_write_b32 a172, v10
    v_accvgpr_write_b32 a173, v11
    v_accvgpr_write_b32 a174, v12
    v_accvgpr_write_b32 a175, v13
    v_add_u32 v9, 11141120, v3
    buffer_load_dwordx4 v[10:13], v9, s[8:11], 0 offen
    s_waitcnt vmcnt(0)
    v_accvgpr_write_b32 a176, v10
    v_accvgpr_write_b32 a177, v11
    v_accvgpr_write_b32 a178, v12
    v_accvgpr_write_b32 a179, v13
    v_add_u32 v9, 11141184, v3
    buffer_load_dwordx4 v[10:13], v9, s[8:11], 0 offen
    s_waitcnt vmcnt(0)
    v_accvgpr_write_b32 a180, v10
    v_accvgpr_write_b32 a181, v11
    v_accvgpr_write_b32 a182, v12
    v_accvgpr_write_b32 a183, v13
    v_add_u32 v9, 11272192, v3
    buffer_load_dwordx4 v[10:13], v9, s[8:11], 0 offen
    s_waitcnt vmcnt(0)
    v_accvgpr_write_b32 a184, v10
    v_accvgpr_write_b32 a185, v11
    v_accvgpr_write_b32 a186, v12
    v_accvgpr_write_b32 a187, v13
    v_add_u32 v9, 11272256, v3
    buffer_load_dwordx4 v[10:13], v9, s[8:11], 0 offen
    s_waitcnt vmcnt(0)
    v_accvgpr_write_b32 a188, v10
    v_accvgpr_write_b32 a189, v11
    v_accvgpr_write_b32 a190, v12
    v_accvgpr_write_b32 a191, v13
    v_add_u32 v9, 11403264, v3
    buffer_load_dwordx4 v[10:13], v9, s[8:11], 0 offen
    s_waitcnt vmcnt(0)
    v_accvgpr_write_b32 a192, v10
    v_accvgpr_write_b32 a193, v11
    v_accvgpr_write_b32 a194, v12
    v_accvgpr_write_b32 a195, v13
    v_add_u32 v9, 11403328, v3
    buffer_load_dwordx4 v[10:13], v9, s[8:11], 0 offen
    s_waitcnt vmcnt(0)
    v_accvgpr_write_b32 a196, v10
    v_accvgpr_write_b32 a197, v11
    v_accvgpr_write_b32 a198, v12
    v_accvgpr_write_b32 a199, v13
    v_add_u32 v9, 11534336, v3
    buffer_load_dwordx4 v[10:13], v9, s[8:11], 0 offen
    s_waitcnt vmcnt(0)
    v_accvgpr_write_b32 a200, v10
    v_accvgpr_write_b32 a201, v11
    v_accvgpr_write_b32 a202, v12
    v_accvgpr_write_b32 a203, v13
    v_add_u32 v9, 11534400, v3
    buffer_load_dwordx4 v[10:13], v9, s[8:11], 0 offen
    s_waitcnt vmcnt(0)
    v_accvgpr_write_b32 a204, v10
    v_accvgpr_write_b32 a205, v11
    v_accvgpr_write_b32 a206, v12
    v_accvgpr_write_b32 a207, v13
    v_add_u32 v9, 11665408, v3
    buffer_load_dwordx4 v[10:13], v9, s[8:11], 0 offen
    s_waitcnt vmcnt(0)
    v_accvgpr_write_b32 a208, v10
    v_accvgpr_write_b32 a209, v11
    v_accvgpr_write_b32 a210, v12
    v_accvgpr_write_b32 a211, v13
    v_add_u32 v9, 11665472, v3
    buffer_load_dwordx4 v[10:13], v9, s[8:11], 0 offen
    s_waitcnt vmcnt(0)
    v_accvgpr_write_b32 a212, v10
    v_accvgpr_write_b32 a213, v11
    v_accvgpr_write_b32 a214, v12
    v_accvgpr_write_b32 a215, v13
    v_add_u32 v9, 11796480, v3
    buffer_load_dwordx4 v[10:13], v9, s[8:11], 0 offen
    s_waitcnt vmcnt(0)
    v_accvgpr_write_b32 a216, v10
    v_accvgpr_write_b32 a217, v11
    v_accvgpr_write_b32 a218, v12
    v_accvgpr_write_b32 a219, v13
    v_add_u32 v9, 11796544, v3
    buffer_load_dwordx4 v[10:13], v9, s[8:11], 0 offen
    s_waitcnt vmcnt(0)
    v_accvgpr_write_b32 a220, v10
    v_accvgpr_write_b32 a221, v11
    v_accvgpr_write_b32 a222, v12
    v_accvgpr_write_b32 a223, v13
    v_lshlrev_b32 v9, 2, v0
    v_add_u32 v8, 0, v9
    buffer_load_dword v10, v8, s[12:15], 0 offen
    s_waitcnt vmcnt(0)
    ds_write_b32 v9, v10 offset:0
    v_add_u32 v8, 1024, v9
    buffer_load_dword v10, v8, s[12:15], 0 offen
    s_waitcnt vmcnt(0)
    ds_write_b32 v9, v10 offset:1024
    v_add_u32 v8, 2048, v9
    buffer_load_dword v10, v8, s[12:15], 0 offen
    s_waitcnt vmcnt(0)
    ds_write_b32 v9, v10 offset:2048
    v_add_u32 v8, 3072, v9
    buffer_load_dword v10, v8, s[12:15], 0 offen
    s_waitcnt vmcnt(0)
    ds_write_b32 v9, v10 offset:3072
    v_add_u32 v8, 4096, v9
    buffer_load_dword v10, v8, s[12:15], 0 offen
    s_waitcnt vmcnt(0)
    ds_write_b32 v9, v10 offset:4096
    v_add_u32 v8, 5120, v9
    buffer_load_dword v10, v8, s[12:15], 0 offen
    s_waitcnt vmcnt(0)
    ds_write_b32 v9, v10 offset:5120
    v_add_u32 v8, 6144, v9
    buffer_load_dword v10, v8, s[12:15], 0 offen
    s_waitcnt vmcnt(0)
    ds_write_b32 v9, v10 offset:6144
    v_and_b32 v4, 7, v1
    v_mul_u32_u24 v4, 896, v4
    v_lshl_add_u32 v4, v2, 4, v4
    v_xor_b32 v60, 16, v63
    v_lshlrev_b32 v60, 2, v60
    v_xor_b32 v61, 32, v63
    v_lshlrev_b32 v61, 2, v61
    s_mov_b32 s20, 0
    s_waitcnt lgkmcnt(0)
    s_barrier
chb_kernel_step:
    v_mov_b32 v32, 0
    v_mov_b32 v33, 0
    v_mov_b32 v34, 0
    v_mov_b32 v35, 0
    v_mov_b32 v36, 0
    v_mov_b32 v37, 0
    v_mov_b32 v38, 0
    v_mov_b32 v39, 0
    v_mov_b32 v40, 0
    v_mov_b32 v41, 0
    v_mov_b32 v42, 0
    v_mov_b32 v43, 0
    ds_read_b128 v[10:13], v4 offset:0
    s_waitcnt lgkmcnt(0)
    v_mfma_f32_16x16x32_bf16 v[32:35], a[0:3], v[10:13], v[32:35]
    v_mfma_f32_16x16x32_bf16 v[36:39], a[56:59], v[10:13], v[36:39]
    v_mfma_f32_16x16x32_bf16 v[40:43], a[112:115], v[10:13], v[40:43]
    ds_read_b128 v[10:13], v4 offset:64
    s_waitcnt lgkmcnt(0)
    v_mfma_f32_16x16x32_bf16 v[32:35], a[4:7], v[10:13], v[32:35]
    v_mfma_f32_16x16x32_bf16 v[36:39], a[60:63], v[10:13], v[36:39]
    v_mfma_f32_16x16x32_bf16 v[40:43], a[116:119], v[10:13], v[40:43]
    ds_read_b128 v[10:13], v4 offset:128
    s_waitcnt lgkmcnt(0)
    v_mfma_f32_16x16x32_bf16 v[32:35], a[8:11], v[10:13], v[32:35]
    v_mfma_f32_16x16x32_bf16 v[36:39], a[64:67], v[10:13], v[36:39]
    v_mfma_f32_16x16x32_bf16 v[40:43], a[120:123], v[10:13], v[40:43]
    ds_read_b128 v[10:13], v4 offset:192
    s_waitcnt lgkmcnt(0)
    v_mfma_f32_16x16x32_bf16 v[32:35], a[12:15], v[10:13], v[32:35]
    v_mfma_f32_16x16x32_bf16 v[36:39], a[68:71], v[10:13], v[36:39]
    v_mfma_f32_16x16x32_bf16 v[40:43], a[124:127], v[10:13], v[40:43]
    ds_read_b128 v[10:13], v4 offset:256
    s_waitcnt lgkmcnt(0)
    v_mfma_f32_16x16x32_bf16 v[32:35], a[16:19], v[10:13], v[32:35]
    v_mfma_f32_16x16x32_bf16 v[36:39], a[72:75], v[10:13], v[36:39]
    v_mfma_f32_16x16x32_bf16 v[40:43], a[128:131], v[10:13], v[40:43]
    ds_read_b128 v[10:13], v4 offset:320
    s_waitcnt lgkmcnt(0)
    v_mfma_f32_16x16x32_bf16 v[32:35], a[20:23], v[10:13], v[32:35]
    v_mfma_f32_16x16x32_bf16 v[36:39], a[76:79], v[10:13], v[36:39]
    v_mfma_f32_16x16x32_bf16 v[40:43], a[132:135], v[10:13], v[40:43]
    ds_read_b128 v[10:13], v4 offset:384
    s_waitcnt lgkmcnt(0)
    v_mfma_f32_16x16x32_bf16 v[32:35], a[24:27], v[10:13], v[32:35]
    v_mfma_f32_16x16x32_bf16 v[36:39], a[80:83], v[10:13], v[36:39]
    v_mfma_f32_16x16x32_bf16 v[40:43], a[136:139], v[10:13], v[40:43]
    ds_read_b128 v[10:13], v4 offset:448
    s_waitcnt lgkmcnt(0)
    v_mfma_f32_16x16x32_bf16 v[32:35], a[28:31], v[10:13], v[32:35]
    v_mfma_f32_16x16x32_bf16 v[36:39], a[84:87], v[10:13], v[36:39]
    v_mfma_f32_16x16x32_bf16 v[40:43], a[140:143], v[10:13], v[40:43]
    ds_read_b128 v[10:13], v4 offset:512
    s_waitcnt lgkmcnt(0)
    v_mfma_f32_16x16x32_bf16 v[32:35], a[32:35], v[10:13], v[32:35]
    v_mfma_f32_16x16x32_bf16 v[36:39], a[88:91], v[10:13], v[36:39]
    v_mfma_f32_16x16x32_bf16 v[40:43], a[144:147], v[10:13], v[40:43]
    ds_read_b128 v[10:13], v4 offset:576
    s_waitcnt lgkmcnt(0)
    v_mfma_f32_16x16x32_bf16 v[32:35], a[36:39], v[10:13], v[32:35]
    v_mfma_f32_16x16x32_bf16 v[36:39], a[92:95], v[10:13], v[36:39]
    v_mfma_f32_16x16x32_bf16 v[40:43], a[148:151], v[10:13], v[40:43]
    ds_read_b128 v[10:13], v4 offset:640
    s_waitcnt lgkmcnt(0)
    v_mfma_f32_16x16x32_bf16 v[32:35], a[40:43], v[10:13], v[32:35]
    v_mfma_f32_16x16x32_bf16 v[36:39], a[96:99], v[10:13], v[36:39]
    v_mfma_f32_16x16x32_bf16 v[40:43], a[152:155], v[10:13], v[40:43]
    ds_read_b128 v[10:13], v4 offset:704
    s_waitcnt lgkmcnt(0)
    v_mfma_f32_16x16x32_bf16 v[32:35], a[44:47], v[10:13], v[32:35]
    v_mfma_f32_16x16x32_bf16 v[36:39], a[100:103], v[10:13], v[36:39]
    v_mfma_f32_16x16x32_bf16 v[40:43], a[156:159], v[10:13], v[40:43]
    ds_read_b128 v[10:13], v4 offset:768
    s_waitcnt lgkmcnt(0)
    v_mfma_f32_16x16x32_bf16 v[32:35], a[48:51], v[10:13], v[32:35]
    v_mfma_f32_16x16x32_bf16 v[36:39], a[104:107], v[10:13], v[36:39]
    v_mfma_f32_16x16x32_bf16 v[40:43], a[160:163], v[10:13], v[40:43]
    ds_read_b128 v[10:13], v4 offset:832
    s_waitcnt lgkmcnt(0)
    v_mfma_f32_16x16x32_bf16 v[32:35], a[52:55], v[10:13], v[32:35]
    v_mfma_f32_16x16x32_bf16 v[36:39], a[108:111], v[10:13], v[36:39]
    v_mfma_f32_16x16x32_bf16 v[40:43], a[164:167], v[10:13], v[40:43]
    s_nop 7
    s_nop 7
    v_lshlrev_b32 v5, 7, v1
    v_lshl_add_u32 v5, v2, 3, v5
    s_lshl_b32 s5, s3, 5
    v_add_u32 v5, s5, v5
    s_lshl_b32 s21, s20, 17
    v_lshl_add_u32 v6, v1, 14, s21
    s_lshl_b32 s6, s4, 1
    v_add_u32 v6, s6, v6
    v_lshl_add_u32 v6, v2, 3, v6
    v_add_u32 v6, s5, v6
    v_add_u32 v6, 70516736, v6
    v_cmp_gt_u32 vcc, 8, v1
    s_and_saveexec_b64 s[30:31], vcc
    v_cvt_pk_bf16_f32 v10, v32, v33
    v_cvt_pk_bf16_f32 v11, v34, v35
    ds_write_b64 v5, v[10:11] offset:7168
    s_nop 1
    v_cvt_pk_bf16_f32 v10, v36, v37
    v_cvt_pk_bf16_f32 v11, v38, v39
    ds_write_b64 v5, v[10:11] offset:8192
    buffer_store_dwordx2 v[10:11], v6, s[8:11], 0 offen offset:0
    v_add_u32 v6, 0x2000, v6
    s_nop 1
    v_cvt_pk_bf16_f32 v10, v40, v41
    v_cvt_pk_bf16_f32 v11, v42, v43
    ds_write_b64 v5, v[10:11] offset:9216
    buffer_store_dwordx2 v[10:11], v6, s[8:11], 0 offen offset:0
    v_add_u32 v6, 0x2000, v6
    s_nop 1
    s_mov_b64 exec, s[30:31]
    s_waitcnt lgkmcnt(0)
    s_barrier
    s_cmp_lg_u32 s3, 0
    s_cbranch_scc1 chb_kernel_w
    s_lshl_b32 s22, s20, 5
    v_add_u32 v7, s22, v1
    v_subrev_u32 v7, 8, v7
    v_max_i32 v7, 0, v7
    v_mul_u32_u24 v7, 24576, v7
    v_add_u32 v7, s6, v7
    v_lshl_add_u32 v7, v2, 4, v7
    v_add_u32 v7, 20193280, v7
    v_min_u32 v8, 7, v1
    v_add_u32 v8, s22, v8
    v_add_u32 v8, 24, v8
    v_mul_u32_u24 v8, 24576, v8
    v_add_u32 v8, s6, v8
    v_lshl_add_u32 v8, v2, 4, v8
    v_add_u32 v8, 20193280, v8
    v_and_b32 v9, 7, v1
    v_lshlrev_b32 v9, 7, v9
    v_lshl_add_u32 v9, v2, 4, v9
    v_mov_b32 v32, 0
    v_mov_b32 v33, 0
    v_mov_b32 v34, 0
    v_mov_b32 v35, 0
    v_mov_b32 v36, 0
    v_mov_b32 v37, 0
    v_mov_b32 v38, 0
    v_mov_b32 v39, 0
    v_mov_b32 v40, 0
    v_mov_b32 v41, 0
    v_mov_b32 v42, 0
    v_mov_b32 v43, 0
    v_cmp_gt_u32 vcc, 8, v1
    buffer_load_dwordx4 v[10:13], v7, s[8:11], 0 offen offset:0
    v_add_u32 v28, 0x60000, v7
    buffer_load_dwordx4 v[14:17], v28, s[8:11], 0 offen offset:0
    buffer_load_dwordx4 v[18:21], v8, s[8:11], 0 offen offset:0
    ds_read_b128 v[22:25], v9 offset:8192
    ds_read_b128 v[44:47], v9 offset:7168
    s_waitcnt vmcnt(0) lgkmcnt(0)
    v_cndmask_b32 v10, v10, v22, vcc
    v_cndmask_b32 v11, v11, v23, vcc
    v_cndmask_b32 v12, v12, v24, vcc
    v_cndmask_b32 v13, v13, v25, vcc
    s_nop 1
    v_mfma_f32_16x16x32_bf16 v[32:35], v[10:13], v[44:47], v[32:35]
    v_mfma_f32_16x16x32_bf16 v[36:39], v[14:17], v[44:47], v[36:39]
    v_mfma_f32_16x16x32_bf16 v[40:43], v[18:21], v[44:47], v[40:43]
    buffer_load_dwordx4 v[10:13], v7, s[8:11], 0 offen offset:64
    v_add_u32 v28, 0x60000, v7
    buffer_load_dwordx4 v[14:17], v28, s[8:11], 0 offen offset:64
    buffer_load_dwordx4 v[18:21], v8, s[8:11], 0 offen offset:64
    ds_read_b128 v[22:25], v9 offset:8256
    ds_read_b128 v[44:47], v9 offset:7232
    s_waitcnt vmcnt(0) lgkmcnt(0)
    v_cndmask_b32 v10, v10, v22, vcc
    v_cndmask_b32 v11, v11, v23, vcc
    v_cndmask_b32 v12, v12, v24, vcc
    v_cndmask_b32 v13, v13, v25, vcc
    s_nop 1
    v_mfma_f32_16x16x32_bf16 v[32:35], v[10:13], v[44:47], v[32:35]
    v_mfma_f32_16x16x32_bf16 v[36:39], v[14:17], v[44:47], v[36:39]
    v_mfma_f32_16x16x32_bf16 v[40:43], v[18:21], v[44:47], v[40:43]
    s_nop 7
    s_nop 7
    s_add_u32 s23, s20, 64
    s_lshl_b32 s23, s23, 6
    s_add_u32 s24, s23, s2
    s_mul_i32 s24, s24, 1536
    s_add_u32 s24, s24, 95682560
    s_and_b32 s25, s2, 60
    s_add_u32 s25, s25, s23
    s_mul_i32 s25, s25, 1536
    s_add_u32 s25, s25, 95682560
    v_and_b32 v28, 7, v1
    v_lshl_add_u32 v28, v2, 3, v28
    v_lshlrev_b32 v28, 4, v28
    v_cmp_gt_u32 vcc, 8, v1
    s_and_saveexec_b64 s[30:31], vcc
    buffer_store_dwordx4 v[32:35], v28, s[8:11], s24 offen offset:0 sc1
    buffer_store_dwordx4 v[36:39], v28, s[8:11], s24 offen offset:512 sc1
    buffer_store_dwordx4 v[40:43], v28, s[8:11], s24 offen offset:1024 sc1
    s_mov_b64 exec, s[30:31]
    v_add_u32 v5, 3072, v28
chb_kernel_p1:
    buffer_load_dwordx4 v[64:67], v28, s[8:11], s25 offen offset:0 sc1
    buffer_load_dwordx4 v[80:83], v28, s[8:11], s25 offen offset:512 sc1
    buffer_load_dwordx4 v[96:99], v28, s[8:11], s25 offen offset:1024 sc1
    buffer_load_dwordx4 v[68:71], v28, s[8:11], s25 offen offset:1536 sc1
    buffer_load_dwordx4 v[84:87], v28, s[8:11], s25 offen offset:2048 sc1
    buffer_load_dwordx4 v[100:103], v28, s[8:11], s25 offen offset:2560 sc1
    buffer_load_dwordx4 v[72:75], v5, s[8:11], s25 offen offset:0 sc1
    buffer_load_dwordx4 v[88:91], v5, s[8:11], s25 offen offset:512 sc1
    buffer_load_dwordx4 v[104:107], v5, s[8:11], s25 offen offset:1024 sc1
    buffer_load_dwordx4 v[76:79], v5, s[8:11], s25 offen offset:1536 sc1
    buffer_load_dwordx4 v[92:95], v5, s[8:11], s25 offen offset:2048 sc1
    buffer_load_dwordx4 v[108:111], v5, s[8:11], s25 offen offset:2560 sc1
    s_waitcnt vmcnt(0)
    v_mov_b32 v29, 0
    v_cmp_eq_u32 vcc, -1, v64
    s_nop 1
    v_addc_co_u32 v29, vcc, 0, v29, vcc
    v_cmp_eq_u32 vcc, -1, v80
    s_nop 1
    v_addc_co_u32 v29, vcc, 0, v29, vcc
    v_cmp_gt_u32 s[32:33], 2, v2
    v_cmp_eq_u32 vcc, -1, v96
    s_and_b64 vcc, vcc, s[32:33]
    s_nop 1
    v_addc_co_u32 v29, vcc, 0, v29, vcc
    v_cmp_eq_u32 vcc, -1, v68
    s_nop 1
    v_addc_co_u32 v29, vcc, 0, v29, vcc
    v_cmp_eq_u32 vcc, -1, v84
    s_nop 1
    v_addc_co_u32 v29, vcc, 0, v29, vcc
    v_cmp_gt_u32 s[32:33], 2, v2
    v_cmp_eq_u32 vcc, -1, v100
    s_and_b64 vcc, vcc, s[32:33]
    s_nop 1
    v_addc_co_u32 v29, vcc, 0, v29, vcc
    v_cmp_eq_u32 vcc, -1, v72
    s_nop 1
    v_addc_co_u32 v29, vcc, 0, v29, vcc
    v_cmp_eq_u32 vcc, -1, v88
    s_nop 1
    v_addc_co_u32 v29, vcc, 0, v29, vcc
    v_cmp_gt_u32 s[32:33], 2, v2
    v_cmp_eq_u32 vcc, -1, v104
    s_and_b64 vcc, vcc, s[32:33]
    s_nop 1
    v_addc_co_u32 v29, vcc, 0, v29, vcc
    v_cmp_eq_u32 vcc, -1, v76
    s_nop 1
    v_addc_co_u32 v29, vcc, 0, v29, vcc
    v_cmp_eq_u32 vcc, -1, v92
    s_nop 1
    v_addc_co_u32 v29, vcc, 0, v29, vcc
    v_cmp_gt_u32 s[32:33], 2, v2
    v_cmp_eq_u32 vcc, -1, v108
    s_and_b64 vcc, vcc, s[32:33]
    s_nop 1
    v_addc_co_u32 v29, vcc, 0, v29, vcc
    v_cmp_ne_u32 vcc, 0, v29
    s_nop 1
    s_cbranch_vccnz chb_kernel_p1
    v_add_f32 v32, v64, v68
    v_add_f32 v32, v32, v72
    v_add_f32 v32, v32, v76
    v_cvt_pk_bf16_f32 v32, v32, v32
    v_lshlrev_b32 v32, 16, v32
    v_mul_f32 v32, 0x3d800000, v32
    v_add_f32 v33, v65, v69
    v_add_f32 v33, v33, v73
    v_add_f32 v33, v33, v77
    v_cvt_pk_bf16_f32 v33, v33, v33
    v_lshlrev_b32 v33, 16, v33
    v_mul_f32 v33, 0x3d800000, v33
    v_add_f32 v34, v66, v70
    v_add_f32 v34, v34, v74
    v_add_f32 v34, v34, v78
    v_cvt_pk_bf16_f32 v34, v34, v34
    v_lshlrev_b32 v34, 16, v34
    v_mul_f32 v34, 0x3d800000, v34
    v_add_f32 v35, v67, v71
    v_add_f32 v35, v35, v75
    v_add_f32 v35, v35, v79
    v_cvt_pk_bf16_f32 v35, v35, v35
    v_lshlrev_b32 v35, 16, v35
    v_mul_f32 v35, 0x3d800000, v35
    v_add_f32 v36, v80, v84
    v_add_f32 v36, v36, v88
    v_add_f32 v36, v36, v92
    v_cvt_pk_bf16_f32 v36, v36, v36
    v_lshlrev_b32 v36, 16, v36
    v_mul_f32 v36, 0x3d800000, v36
    v_add_f32 v37, v81, v85
    v_add_f32 v37, v37, v89
    v_add_f32 v37, v37, v93
    v_cvt_pk_bf16_f32 v37, v37, v37
    v_lshlrev_b32 v37, 16, v37
    v_mul_f32 v37, 0x3d800000, v37
    v_add_f32 v38, v82, v86
    v_add_f32 v38, v38, v90
    v_add_f32 v38, v38, v94
    v_cvt_pk_bf16_f32 v38, v38, v38
    v_lshlrev_b32 v38, 16, v38
    v_mul_f32 v38, 0x3d800000, v38
    v_add_f32 v39, v83, v87
    v_add_f32 v39, v39, v91
    v_add_f32 v39, v39, v95
    v_cvt_pk_bf16_f32 v39, v39, v39
    v_lshlrev_b32 v39, 16, v39
    v_mul_f32 v39, 0x3d800000, v39
    v_add_f32 v40, v96, v100
    v_add_f32 v40, v40, v104
    v_add_f32 v40, v40, v108
    v_cvt_pk_bf16_f32 v40, v40, v40
    v_lshlrev_b32 v40, 16, v40
    v_mul_f32 v40, 0x3d800000, v40
    v_cmp_gt_u32 vcc, 2, v2
    v_mov_b32 v57, 0xce6e6b28
    s_nop 0
    v_cndmask_b32 v40, v57, v40, vcc
    v_add_f32 v41, v97, v101
    v_add_f32 v41, v41, v105
    v_add_f32 v41, v41, v109
    v_cvt_pk_bf16_f32 v41, v41, v41
    v_lshlrev_b32 v41, 16, v41
    v_mul_f32 v41, 0x3d800000, v41
    v_cmp_gt_u32 vcc, 2, v2
    v_mov_b32 v57, 0xce6e6b28
    s_nop 0
    v_cndmask_b32 v41, v57, v41, vcc
    v_add_f32 v42, v98, v102
    v_add_f32 v42, v42, v106
    v_add_f32 v42, v42, v110
    v_cvt_pk_bf16_f32 v42, v42, v42
    v_lshlrev_b32 v42, 16, v42
    v_mul_f32 v42, 0x3d800000, v42
    v_cmp_gt_u32 vcc, 2, v2
    v_mov_b32 v57, 0xce6e6b28
    s_nop 0
    v_cndmask_b32 v42, v57, v42, vcc
    v_add_f32 v43, v99, v103
    v_add_f32 v43, v43, v107
    v_add_f32 v43, v43, v111
    v_cvt_pk_bf16_f32 v43, v43, v43
    v_lshlrev_b32 v43, 16, v43
    v_mul_f32 v43, 0x3d800000, v43
    v_cmp_gt_u32 vcc, 2, v2
    v_mov_b32 v57, 0xce6e6b28
    s_nop 0
    v_cndmask_b32 v43, v57, v43, vcc
    v_mov_b32 v56, v32
    v_max_f32 v56, v56, v33
    v_max_f32 v56, v56, v34
    v_max_f32 v56, v56, v35
    v_max_f32 v56, v56, v36
    v_max_f32 v56, v56, v37
    v_max_f32 v56, v56, v38
    v_max_f32 v56, v56, v39
    v_max_f32 v56, v56, v40
    v_max_f32 v56, v56, v41
    v_max_f32 v56, v56, v42
    v_max_f32 v56, v56, v43
    ds_bpermute_b32 v9, v60, v56
    s_waitcnt lgkmcnt(0)
    v_max_f32 v56, v56, v9
    ds_bpermute_b32 v9, v61, v56
    s_waitcnt lgkmcnt(0)
    v_max_f32 v56, v56, v9
    v_mov_b32 v55, 0
    v_sub_f32 v32, v32, v56
    v_mul_f32 v32, 0x3fb8aa3b, v32
    v_exp_f32 v32, v32
    s_nop 0
    v_add_f32 v55, v55, v32
    v_sub_f32 v33, v33, v56
    v_mul_f32 v33, 0x3fb8aa3b, v33
    v_exp_f32 v33, v33
    s_nop 0
    v_add_f32 v55, v55, v33
    v_sub_f32 v34, v34, v56
    v_mul_f32 v34, 0x3fb8aa3b, v34
    v_exp_f32 v34, v34
    s_nop 0
    v_add_f32 v55, v55, v34
    v_sub_f32 v35, v35, v56
    v_mul_f32 v35, 0x3fb8aa3b, v35
    v_exp_f32 v35, v35
    s_nop 0
    v_add_f32 v55, v55, v35
    v_sub_f32 v36, v36, v56
    v_mul_f32 v36, 0x3fb8aa3b, v36
    v_exp_f32 v36, v36
    s_nop 0
    v_add_f32 v55, v55, v36
    v_sub_f32 v37, v37, v56
    v_mul_f32 v37, 0x3fb8aa3b, v37
    v_exp_f32 v37, v37
    s_nop 0
    v_add_f32 v55, v55, v37
    v_sub_f32 v38, v38, v56
    v_mul_f32 v38, 0x3fb8aa3b, v38
    v_exp_f32 v38, v38
    s_nop 0
    v_add_f32 v55, v55, v38
    v_sub_f32 v39, v39, v56
    v_mul_f32 v39, 0x3fb8aa3b, v39
    v_exp_f32 v39, v39
    s_nop 0
    v_add_f32 v55, v55, v39
    v_sub_f32 v40, v40, v56
    v_mul_f32 v40, 0x3fb8aa3b, v40
    v_exp_f32 v40, v40
    s_nop 0
    v_add_f32 v55, v55, v40
    v_sub_f32 v41, v41, v56
    v_mul_f32 v41, 0x3fb8aa3b, v41
    v_exp_f32 v41, v41
    s_nop 0
    v_add_f32 v55, v55, v41
    v_sub_f32 v42, v42, v56
    v_mul_f32 v42, 0x3fb8aa3b, v42
    v_exp_f32 v42, v42
    s_nop 0
    v_add_f32 v55, v55, v42
    v_sub_f32 v43, v43, v56
    v_mul_f32 v43, 0x3fb8aa3b, v43
    v_exp_f32 v43, v43
    s_nop 0
    v_add_f32 v55, v55, v43
    ds_bpermute_b32 v9, v60, v55
    s_waitcnt lgkmcnt(0)
    v_add_f32 v55, v55, v9
    ds_bpermute_b32 v9, v61, v55
    s_waitcnt lgkmcnt(0)
    v_add_f32 v55, v55, v9
    v_rcp_f32 v55, v55
    s_nop 0
    v_mul_f32 v32, v32, v55
    v_cvt_pk_bf16_f32 v32, v32, v32
    v_lshlrev_b32 v32, 16, v32
    v_mul_f32 v33, v33, v55
    v_cvt_pk_bf16_f32 v33, v33, v33
    v_lshlrev_b32 v33, 16, v33
    v_mul_f32 v34, v34, v55
    v_cvt_pk_bf16_f32 v34, v34, v34
    v_lshlrev_b32 v34, 16, v34
    v_mul_f32 v35, v35, v55
    v_cvt_pk_bf16_f32 v35, v35, v35
    v_lshlrev_b32 v35, 16, v35
    v_mul_f32 v36, v36, v55
    v_cvt_pk_bf16_f32 v36, v36, v36
    v_lshlrev_b32 v36, 16, v36
    v_mul_f32 v37, v37, v55
    v_cvt_pk_bf16_f32 v37, v37, v37
    v_lshlrev_b32 v37, 16, v37
    v_mul_f32 v38, v38, v55
    v_cvt_pk_bf16_f32 v38, v38, v38
    v_lshlrev_b32 v38, 16, v38
    v_mul_f32 v39, v39, v55
    v_cvt_pk_bf16_f32 v39, v39, v39
    v_lshlrev_b32 v39, 16, v39
    v_mul_f32 v40, v40, v55
    v_cvt_pk_bf16_f32 v40, v40, v40
    v_lshlrev_b32 v40, 16, v40
    v_mul_f32 v41, v41, v55
    v_cvt_pk_bf16_f32 v41, v41, v41
    v_lshlrev_b32 v41, 16, v41
    v_mul_f32 v42, v42, v55
    v_cvt_pk_bf16_f32 v42, v42, v42
    v_lshlrev_b32 v42, 16, v42
    v_mul_f32 v43, v43, v55
    v_cvt_pk_bf16_f32 v43, v43, v43
    v_lshlrev_b32 v43, 16, v43
    s_mul_i32 s26, s22, 24576
    s_add_u32 s26, s26, s6
    s_add_u32 s26, s26, 20201472
    v_lshlrev_b32 v9, 1, v63
    s_add_u32 s27, s26, 0
    buffer_load_ushort v72, v9, s[8:11], s27 offen
    s_add_u32 s27, s26, 24576
    buffer_load_ushort v73, v9, s[8:11], s27 offen
    s_add_u32 s27, s26, 49152
    buffer_load_ushort v74, v9, s[8:11], s27 offen
    s_add_u32 s27, s26, 73728
    buffer_load_ushort v75, v9, s[8:11], s27 offen
    s_add_u32 s27, s26, 98304
    buffer_load_ushort v76, v9, s[8:11], s27 offen
    s_add_u32 s27, s26, 122880
    buffer_load_ushort v77, v9, s[8:11], s27 offen
    s_add_u32 s27, s26, 147456
    buffer_load_ushort v78, v9, s[8:11], s27 offen
    s_add_u32 s27, s26, 172032
    buffer_load_ushort v79, v9, s[8:11], s27 offen
    s_add_u32 s27, s26, 196608
    buffer_load_ushort v80, v9, s[8:11], s27 offen
    s_add_u32 s27, s26, 221184
    buffer_load_ushort v81, v9, s[8:11], s27 offen
    s_add_u32 s27, s26, 245760
    buffer_load_ushort v82, v9, s[8:11], s27 offen
    s_add_u32 s27, s26, 270336
    buffer_load_ushort v83, v9, s[8:11], s27 offen
    s_add_u32 s27, s26, 294912
    buffer_load_ushort v84, v9, s[8:11], s27 offen
    s_add_u32 s27, s26, 319488
    buffer_load_ushort v85, v9, s[8:11], s27 offen
    s_add_u32 s27, s26, 344064
    buffer_load_ushort v86, v9, s[8:11], s27 offen
    s_add_u32 s27, s26, 368640
    buffer_load_ushort v87, v9, s[8:11], s27 offen
    s_add_u32 s27, s26, 393216
    buffer_load_ushort v88, v9, s[8:11], s27 offen
    s_add_u32 s27, s26, 417792
    buffer_load_ushort v89, v9, s[8:11], s27 offen
    s_add_u32 s27, s26, 442368
    buffer_load_ushort v90, v9, s[8:11], s27 offen
    s_add_u32 s27, s26, 466944
    buffer_load_ushort v91, v9, s[8:11], s27 offen
    s_add_u32 s27, s26, 491520
    buffer_load_ushort v92, v9, s[8:11], s27 offen
    s_add_u32 s27, s26, 516096
    buffer_load_ushort v93, v9, s[8:11], s27 offen
    s_add_u32 s27, s26, 540672
    buffer_load_ushort v94, v9, s[8:11], s27 offen
    s_add_u32 s27, s26, 565248
    buffer_load_ushort v95, v9, s[8:11], s27 offen
    s_add_u32 s27, s26, 589824
    buffer_load_ushort v96, v9, s[8:11], s27 offen
    s_add_u32 s27, s26, 614400
    buffer_load_ushort v97, v9, s[8:11], s27 offen
    s_add_u32 s27, s26, 638976
    buffer_load_ushort v98, v9, s[8:11], s27 offen
    s_add_u32 s27, s26, 663552
    buffer_load_ushort v99, v9, s[8:11], s27 offen
    s_add_u32 s27, s26, 688128
    buffer_load_ushort v100, v9, s[8:11], s27 offen
    s_add_u32 s27, s26, 712704
    buffer_load_ushort v101, v9, s[8:11], s27 offen
    s_add_u32 s27, s26, 737280
    buffer_load_ushort v102, v9, s[8:11], s27 offen
    s_add_u32 s27, s26, 761856
    buffer_load_ushort v103, v9, s[8:11], s27 offen
    ds_read_u16 v64, v9 offset:9216
    ds_read_u16 v65, v9 offset:9344
    ds_read_u16 v66, v9 offset:9472
    ds_read_u16 v67, v9 offset:9600
    ds_read_u16 v68, v9 offset:9728
    ds_read_u16 v69, v9 offset:9856
    ds_read_u16 v70, v9 offset:9984
    ds_read_u16 v71, v9 offset:10112
    s_waitcnt vmcnt(0) lgkmcnt(0)
    v_lshlrev_b32 v64, 16, v64
    v_lshlrev_b32 v65, 16, v65
    v_lshlrev_b32 v66, 16, v66
    v_lshlrev_b32 v67, 16, v67
    v_lshlrev_b32 v68, 16, v68
    v_lshlrev_b32 v69, 16, v69
    v_lshlrev_b32 v70, 16, v70
    v_lshlrev_b32 v71, 16, v71
    v_lshlrev_b32 v72, 16, v72
    v_lshlrev_b32 v73, 16, v73
    v_lshlrev_b32 v74, 16, v74
    v_lshlrev_b32 v75, 16, v75
    v_lshlrev_b32 v76, 16, v76
    v_lshlrev_b32 v77, 16, v77
    v_lshlrev_b32 v78, 16, v78
    v_lshlrev_b32 v79, 16, v79
    v_lshlrev_b32 v80, 16, v80
    v_lshlrev_b32 v81, 16, v81
    v_lshlrev_b32 v82, 16, v82
    v_lshlrev_b32 v83, 16, v83
    v_lshlrev_b32 v84, 16, v84
    v_lshlrev_b32 v85, 16, v85
    v_lshlrev_b32 v86, 16, v86
    v_lshlrev_b32 v87, 16, v87
    v_lshlrev_b32 v88, 16, v88
    v_lshlrev_b32 v89, 16, v89
    v_lshlrev_b32 v90, 16, v90
    v_lshlrev_b32 v91, 16, v91
    v_lshlrev_b32 v92, 16, v92
    v_lshlrev_b32 v93, 16, v93
    v_lshlrev_b32 v94, 16, v94
    v_lshlrev_b32 v95, 16, v95
    v_lshlrev_b32 v96, 16, v96
    v_lshlrev_b32 v97, 16, v97
    v_lshlrev_b32 v98, 16, v98
    v_lshlrev_b32 v99, 16, v99
    v_lshlrev_b32 v100, 16, v100
    v_lshlrev_b32 v101, 16, v101
    v_lshlrev_b32 v102, 16, v102
    v_lshlrev_b32 v103, 16, v103
    v_mov_b32 v110, 0
    v_readlane_b32 s27, v32, 0
    s_nop 1
    v_fmac_f32 v110, s27, v64
    v_readlane_b32 s27, v33, 0
    s_nop 1
    v_fmac_f32 v110, s27, v65
    v_readlane_b32 s27, v34, 0
    s_nop 1
    v_fmac_f32 v110, s27, v66
    v_readlane_b32 s27, v35, 0
    s_nop 1
    v_fmac_f32 v110, s27, v67
    v_readlane_b32 s27, v32, 16
    s_nop 1
    v_fmac_f32 v110, s27, v68
    v_readlane_b32 s27, v33, 16
    s_nop 1
    v_fmac_f32 v110, s27, v69
    v_readlane_b32 s27, v34, 16
    s_nop 1
    v_fmac_f32 v110, s27, v70
    v_readlane_b32 s27, v35, 16
    s_nop 1
    v_fmac_f32 v110, s27, v71
    v_readlane_b32 s27, v32, 32
    s_nop 1
    v_fmac_f32 v110, s27, v72
    v_readlane_b32 s27, v33, 32
    s_nop 1
    v_fmac_f32 v110, s27, v73
    v_readlane_b32 s27, v34, 32
    s_nop 1
    v_fmac_f32 v110, s27, v74
    v_readlane_b32 s27, v35, 32
    s_nop 1
    v_fmac_f32 v110, s27, v75
    v_readlane_b32 s27, v32, 48
    s_nop 1
    v_fmac_f32 v110, s27, v76
    v_readlane_b32 s27, v33, 48
    s_nop 1
    v_fmac_f32 v110, s27, v77
    v_readlane_b32 s27, v34, 48
    s_nop 1
    v_fmac_f32 v110, s27, v78
    v_readlane_b32 s27, v35, 48
    s_nop 1
    v_fmac_f32 v110, s27, v79
    v_readlane_b32 s27, v36, 0
    s_nop 1
    v_fmac_f32 v110, s27, v80
    v_readlane_b32 s27, v37, 0
    s_nop 1
    v_fmac_f32 v110, s27, v81
    v_readlane_b32 s27, v38, 0
    s_nop 1
    v_fmac_f32 v110, s27, v82
    v_readlane_b32 s27, v39, 0
    s_nop 1
    v_fmac_f32 v110, s27, v83
    v_readlane_b32 s27, v36, 16
    s_nop 1
    v_fmac_f32 v110, s27, v84
    v_readlane_b32 s27, v37, 16
    s_nop 1
    v_fmac_f32 v110, s27, v85
    v_readlane_b32 s27, v38, 16
    s_nop 1
    v_fmac_f32 v110, s27, v86
    v_readlane_b32 s27, v39, 16
    s_nop 1
    v_fmac_f32 v110, s27, v87
    v_readlane_b32 s27, v36, 32
    s_nop 1
    v_fmac_f32 v110, s27, v88
    v_readlane_b32 s27, v37, 32
    s_nop 1
    v_fmac_f32 v110, s27, v89
    v_readlane_b32 s27, v38, 32
    s_nop 1
    v_fmac_f32 v110, s27, v90
    v_readlane_b32 s27, v39, 32
    s_nop 1
    v_fmac_f32 v110, s27, v91
    v_readlane_b32 s27, v36, 48
    s_nop 1
    v_fmac_f32 v110, s27, v92
    v_readlane_b32 s27, v37, 48
    s_nop 1
    v_fmac_f32 v110, s27, v93
    v_readlane_b32 s27, v38, 48
    s_nop 1
    v_fmac_f32 v110, s27, v94
    v_readlane_b32 s27, v39, 48
    s_nop 1
    v_fmac_f32 v110, s27, v95
    v_readlane_b32 s27, v40, 0
    s_nop 1
    v_fmac_f32 v110, s27, v96
    v_readlane_b32 s27, v41, 0
    s_nop 1
    v_fmac_f32 v110, s27, v97
    v_readlane_b32 s27, v42, 0
    s_nop 1
    v_fmac_f32 v110, s27, v98
    v_readlane_b32 s27, v43, 0
    s_nop 1
    v_fmac_f32 v110, s27, v99
    v_readlane_b32 s27, v40, 16
    s_nop 1
    v_fmac_f32 v110, s27, v100
    v_readlane_b32 s27, v41, 16
    s_nop 1
    v_fmac_f32 v110, s27, v101
    v_readlane_b32 s27, v42, 16
    s_nop 1
    v_fmac_f32 v110, s27, v102
    v_readlane_b32 s27, v43, 16
    s_nop 1
    v_fmac_f32 v110, s27, v103
    v_cvt_pk_bf16_f32 v110, v110, v110
    ds_write_b16 v9, v110 offset:10240
    v_mov_b32 v110, 0
    v_readlane_b32 s27, v32, 1
    s_nop 1
    v_fmac_f32 v110, s27, v64
    v_readlane_b32 s27, v33, 1
    s_nop 1
    v_fmac_f32 v110, s27, v65
    v_readlane_b32 s27, v34, 1
    s_nop 1
    v_fmac_f32 v110, s27, v66
    v_readlane_b32 s27, v35, 1
    s_nop 1
    v_fmac_f32 v110, s27, v67
    v_readlane_b32 s27, v32, 17
    s_nop 1
    v_fmac_f32 v110, s27, v68
    v_readlane_b32 s27, v33, 17
    s_nop 1
    v_fmac_f32 v110, s27, v69
    v_readlane_b32 s27, v34, 17
    s_nop 1
    v_fmac_f32 v110, s27, v70
    v_readlane_b32 s27, v35, 17
    s_nop 1
    v_fmac_f32 v110, s27, v71
    v_readlane_b32 s27, v32, 33
    s_nop 1
    v_fmac_f32 v110, s27, v72
    v_readlane_b32 s27, v33, 33
    s_nop 1
    v_fmac_f32 v110, s27, v73
    v_readlane_b32 s27, v34, 33
    s_nop 1
    v_fmac_f32 v110, s27, v74
    v_readlane_b32 s27, v35, 33
    s_nop 1
    v_fmac_f32 v110, s27, v75
    v_readlane_b32 s27, v32, 49
    s_nop 1
    v_fmac_f32 v110, s27, v76
    v_readlane_b32 s27, v33, 49
    s_nop 1
    v_fmac_f32 v110, s27, v77
    v_readlane_b32 s27, v34, 49
    s_nop 1
    v_fmac_f32 v110, s27, v78
    v_readlane_b32 s27, v35, 49
    s_nop 1
    v_fmac_f32 v110, s27, v79
    v_readlane_b32 s27, v36, 1
    s_nop 1
    v_fmac_f32 v110, s27, v80
    v_readlane_b32 s27, v37, 1
    s_nop 1
    v_fmac_f32 v110, s27, v81
    v_readlane_b32 s27, v38, 1
    s_nop 1
    v_fmac_f32 v110, s27, v82
    v_readlane_b32 s27, v39, 1
    s_nop 1
    v_fmac_f32 v110, s27, v83
    v_readlane_b32 s27, v36, 17
    s_nop 1
    v_fmac_f32 v110, s27, v84
    v_readlane_b32 s27, v37, 17
    s_nop 1
    v_fmac_f32 v110, s27, v85
    v_readlane_b32 s27, v38, 17
    s_nop 1
    v_fmac_f32 v110, s27, v86
    v_readlane_b32 s27, v39, 17
    s_nop 1
    v_fmac_f32 v110, s27, v87
    v_readlane_b32 s27, v36, 33
    s_nop 1
    v_fmac_f32 v110, s27, v88
    v_readlane_b32 s27, v37, 33
    s_nop 1
    v_fmac_f32 v110, s27, v89
    v_readlane_b32 s27, v38, 33
    s_nop 1
    v_fmac_f32 v110, s27, v90
    v_readlane_b32 s27, v39, 33
    s_nop 1
    v_fmac_f32 v110, s27, v91
    v_readlane_b32 s27, v36, 49
    s_nop 1
    v_fmac_f32 v110, s27, v92
    v_readlane_b32 s27, v37, 49
    s_nop 1
    v_fmac_f32 v110, s27, v93
    v_readlane_b32 s27, v38, 49
    s_nop 1
    v_fmac_f32 v110, s27, v94
    v_readlane_b32 s27, v39, 49
    s_nop 1
    v_fmac_f32 v110, s27, v95
    v_readlane_b32 s27, v40, 1
    s_nop 1
    v_fmac_f32 v110, s27, v96
    v_readlane_b32 s27, v41, 1
    s_nop 1
    v_fmac_f32 v110, s27, v97
    v_readlane_b32 s27, v42, 1
    s_nop 1
    v_fmac_f32 v110, s27, v98
    v_readlane_b32 s27, v43, 1
    s_nop 1
    v_fmac_f32 v110, s27, v99
    v_readlane_b32 s27, v40, 17
    s_nop 1
    v_fmac_f32 v110, s27, v100
    v_readlane_b32 s27, v41, 17
    s_nop 1
    v_fmac_f32 v110, s27, v101
    v_readlane_b32 s27, v42, 17
    s_nop 1
    v_fmac_f32 v110, s27, v102
    v_readlane_b32 s27, v43, 17
    s_nop 1
    v_fmac_f32 v110, s27, v103
    v_cvt_pk_bf16_f32 v110, v110, v110
    ds_write_b16 v9, v110 offset:10368
    v_mov_b32 v110, 0
    v_readlane_b32 s27, v32, 2
    s_nop 1
    v_fmac_f32 v110, s27, v64
    v_readlane_b32 s27, v33, 2
    s_nop 1
    v_fmac_f32 v110, s27, v65
    v_readlane_b32 s27, v34, 2
    s_nop 1
    v_fmac_f32 v110, s27, v66
    v_readlane_b32 s27, v35, 2
    s_nop 1
    v_fmac_f32 v110, s27, v67
    v_readlane_b32 s27, v32, 18
    s_nop 1
    v_fmac_f32 v110, s27, v68
    v_readlane_b32 s27, v33, 18
    s_nop 1
    v_fmac_f32 v110, s27, v69
    v_readlane_b32 s27, v34, 18
    s_nop 1
    v_fmac_f32 v110, s27, v70
    v_readlane_b32 s27, v35, 18
    s_nop 1
    v_fmac_f32 v110, s27, v71
    v_readlane_b32 s27, v32, 34
    s_nop 1
    v_fmac_f32 v110, s27, v72
    v_readlane_b32 s27, v33, 34
    s_nop 1
    v_fmac_f32 v110, s27, v73
    v_readlane_b32 s27, v34, 34
    s_nop 1
    v_fmac_f32 v110, s27, v74
    v_readlane_b32 s27, v35, 34
    s_nop 1
    v_fmac_f32 v110, s27, v75
    v_readlane_b32 s27, v32, 50
    s_nop 1
    v_fmac_f32 v110, s27, v76
    v_readlane_b32 s27, v33, 50
    s_nop 1
    v_fmac_f32 v110, s27, v77
    v_readlane_b32 s27, v34, 50
    s_nop 1
    v_fmac_f32 v110, s27, v78
    v_readlane_b32 s27, v35, 50
    s_nop 1
    v_fmac_f32 v110, s27, v79
    v_readlane_b32 s27, v36, 2
    s_nop 1
    v_fmac_f32 v110, s27, v80
    v_readlane_b32 s27, v37, 2
    s_nop 1
    v_fmac_f32 v110, s27, v81
    v_readlane_b32 s27, v38, 2
    s_nop 1
    v_fmac_f32 v110, s27, v82
    v_readlane_b32 s27, v39, 2
    s_nop 1
    v_fmac_f32 v110, s27, v83
    v_readlane_b32 s27, v36, 18
    s_nop 1
    v_fmac_f32 v110, s27, v84
    v_readlane_b32 s27, v37, 18
    s_nop 1
    v_fmac_f32 v110, s27, v85
    v_readlane_b32 s27, v38, 18
    s_nop 1
    v_fmac_f32 v110, s27, v86
    v_readlane_b32 s27, v39, 18
    s_nop 1
    v_fmac_f32 v110, s27, v87
    v_readlane_b32 s27, v36, 34
    s_nop 1
    v_fmac_f32 v110, s27, v88
    v_readlane_b32 s27, v37, 34
    s_nop 1
    v_fmac_f32 v110, s27, v89
    v_readlane_b32 s27, v38, 34
    s_nop 1
    v_fmac_f32 v110, s27, v90
    v_readlane_b32 s27, v39, 34
    s_nop 1
    v_fmac_f32 v110, s27, v91
    v_readlane_b32 s27, v36, 50
    s_nop 1
    v_fmac_f32 v110, s27, v92
    v_readlane_b32 s27, v37, 50
    s_nop 1
    v_fmac_f32 v110, s27, v93
    v_readlane_b32 s27, v38, 50
    s_nop 1
    v_fmac_f32 v110, s27, v94
    v_readlane_b32 s27, v39, 50
    s_nop 1
    v_fmac_f32 v110, s27, v95
    v_readlane_b32 s27, v40, 2
    s_nop 1
    v_fmac_f32 v110, s27, v96
    v_readlane_b32 s27, v41, 2
    s_nop 1
    v_fmac_f32 v110, s27, v97
    v_readlane_b32 s27, v42, 2
    s_nop 1
    v_fmac_f32 v110, s27, v98
    v_readlane_b32 s27, v43, 2
    s_nop 1
    v_fmac_f32 v110, s27, v99
    v_readlane_b32 s27, v40, 18
    s_nop 1
    v_fmac_f32 v110, s27, v100
    v_readlane_b32 s27, v41, 18
    s_nop 1
    v_fmac_f32 v110, s27, v101
    v_readlane_b32 s27, v42, 18
    s_nop 1
    v_fmac_f32 v110, s27, v102
    v_readlane_b32 s27, v43, 18
    s_nop 1
    v_fmac_f32 v110, s27, v103
    v_cvt_pk_bf16_f32 v110, v110, v110
    ds_write_b16 v9, v110 offset:10496
    v_mov_b32 v110, 0
    v_readlane_b32 s27, v32, 3
    s_nop 1
    v_fmac_f32 v110, s27, v64
    v_readlane_b32 s27, v33, 3
    s_nop 1
    v_fmac_f32 v110, s27, v65
    v_readlane_b32 s27, v34, 3
    s_nop 1
    v_fmac_f32 v110, s27, v66
    v_readlane_b32 s27, v35, 3
    s_nop 1
    v_fmac_f32 v110, s27, v67
    v_readlane_b32 s27, v32, 19
    s_nop 1
    v_fmac_f32 v110, s27, v68
    v_readlane_b32 s27, v33, 19
    s_nop 1
    v_fmac_f32 v110, s27, v69
    v_readlane_b32 s27, v34, 19
    s_nop 1
    v_fmac_f32 v110, s27, v70
    v_readlane_b32 s27, v35, 19
    s_nop 1
    v_fmac_f32 v110, s27, v71
    v_readlane_b32 s27, v32, 35
    s_nop 1
    v_fmac_f32 v110, s27, v72
    v_readlane_b32 s27, v33, 35
    s_nop 1
    v_fmac_f32 v110, s27, v73
    v_readlane_b32 s27, v34, 35
    s_nop 1
    v_fmac_f32 v110, s27, v74
    v_readlane_b32 s27, v35, 35
    s_nop 1
    v_fmac_f32 v110, s27, v75
    v_readlane_b32 s27, v32, 51
    s_nop 1
    v_fmac_f32 v110, s27, v76
    v_readlane_b32 s27, v33, 51
    s_nop 1
    v_fmac_f32 v110, s27, v77
    v_readlane_b32 s27, v34, 51
    s_nop 1
    v_fmac_f32 v110, s27, v78
    v_readlane_b32 s27, v35, 51
    s_nop 1
    v_fmac_f32 v110, s27, v79
    v_readlane_b32 s27, v36, 3
    s_nop 1
    v_fmac_f32 v110, s27, v80
    v_readlane_b32 s27, v37, 3
    s_nop 1
    v_fmac_f32 v110, s27, v81
    v_readlane_b32 s27, v38, 3
    s_nop 1
    v_fmac_f32 v110, s27, v82
    v_readlane_b32 s27, v39, 3
    s_nop 1
    v_fmac_f32 v110, s27, v83
    v_readlane_b32 s27, v36, 19
    s_nop 1
    v_fmac_f32 v110, s27, v84
    v_readlane_b32 s27, v37, 19
    s_nop 1
    v_fmac_f32 v110, s27, v85
    v_readlane_b32 s27, v38, 19
    s_nop 1
    v_fmac_f32 v110, s27, v86
    v_readlane_b32 s27, v39, 19
    s_nop 1
    v_fmac_f32 v110, s27, v87
    v_readlane_b32 s27, v36, 35
    s_nop 1
    v_fmac_f32 v110, s27, v88
    v_readlane_b32 s27, v37, 35
    s_nop 1
    v_fmac_f32 v110, s27, v89
    v_readlane_b32 s27, v38, 35
    s_nop 1
    v_fmac_f32 v110, s27, v90
    v_readlane_b32 s27, v39, 35
    s_nop 1
    v_fmac_f32 v110, s27, v91
    v_readlane_b32 s27, v36, 51
    s_nop 1
    v_fmac_f32 v110, s27, v92
    v_readlane_b32 s27, v37, 51
    s_nop 1
    v_fmac_f32 v110, s27, v93
    v_readlane_b32 s27, v38, 51
    s_nop 1
    v_fmac_f32 v110, s27, v94
    v_readlane_b32 s27, v39, 51
    s_nop 1
    v_fmac_f32 v110, s27, v95
    v_readlane_b32 s27, v40, 3
    s_nop 1
    v_fmac_f32 v110, s27, v96
    v_readlane_b32 s27, v41, 3
    s_nop 1
    v_fmac_f32 v110, s27, v97
    v_readlane_b32 s27, v42, 3
    s_nop 1
    v_fmac_f32 v110, s27, v98
    v_readlane_b32 s27, v43, 3
    s_nop 1
    v_fmac_f32 v110, s27, v99
    v_readlane_b32 s27, v40, 19
    s_nop 1
    v_fmac_f32 v110, s27, v100
    v_readlane_b32 s27, v41, 19
    s_nop 1
    v_fmac_f32 v110, s27, v101
    v_readlane_b32 s27, v42, 19
    s_nop 1
    v_fmac_f32 v110, s27, v102
    v_readlane_b32 s27, v43, 19
    s_nop 1
    v_fmac_f32 v110, s27, v103
    v_cvt_pk_bf16_f32 v110, v110, v110
    ds_write_b16 v9, v110 offset:10624
    v_mov_b32 v110, 0
    v_readlane_b32 s27, v32, 4
    s_nop 1
    v_fmac_f32 v110, s27, v64
    v_readlane_b32 s27, v33, 4
    s_nop 1
    v_fmac_f32 v110, s27, v65
    v_readlane_b32 s27, v34, 4
    s_nop 1
    v_fmac_f32 v110, s27, v66
    v_readlane_b32 s27, v35, 4
    s_nop 1
    v_fmac_f32 v110, s27, v67
    v_readlane_b32 s27, v32, 20
    s_nop 1
    v_fmac_f32 v110, s27, v68
    v_readlane_b32 s27, v33, 20
    s_nop 1
    v_fmac_f32 v110, s27, v69
    v_readlane_b32 s27, v34, 20
    s_nop 1
    v_fmac_f32 v110, s27, v70
    v_readlane_b32 s27, v35, 20
    s_nop 1
    v_fmac_f32 v110, s27, v71
    v_readlane_b32 s27, v32, 36
    s_nop 1
    v_fmac_f32 v110, s27, v72
    v_readlane_b32 s27, v33, 36
    s_nop 1
    v_fmac_f32 v110, s27, v73
    v_readlane_b32 s27, v34, 36
    s_nop 1
    v_fmac_f32 v110, s27, v74
    v_readlane_b32 s27, v35, 36
    s_nop 1
    v_fmac_f32 v110, s27, v75
    v_readlane_b32 s27, v32, 52
    s_nop 1
    v_fmac_f32 v110, s27, v76
    v_readlane_b32 s27, v33, 52
    s_nop 1
    v_fmac_f32 v110, s27, v77
    v_readlane_b32 s27, v34, 52
    s_nop 1
    v_fmac_f32 v110, s27, v78
    v_readlane_b32 s27, v35, 52
    s_nop 1
    v_fmac_f32 v110, s27, v79
    v_readlane_b32 s27, v36, 4
    s_nop 1
    v_fmac_f32 v110, s27, v80
    v_readlane_b32 s27, v37, 4
    s_nop 1
    v_fmac_f32 v110, s27, v81
    v_readlane_b32 s27, v38, 4
    s_nop 1
    v_fmac_f32 v110, s27, v82
    v_readlane_b32 s27, v39, 4
    s_nop 1
    v_fmac_f32 v110, s27, v83
    v_readlane_b32 s27, v36, 20
    s_nop 1
    v_fmac_f32 v110, s27, v84
    v_readlane_b32 s27, v37, 20
    s_nop 1
    v_fmac_f32 v110, s27, v85
    v_readlane_b32 s27, v38, 20
    s_nop 1
    v_fmac_f32 v110, s27, v86
    v_readlane_b32 s27, v39, 20
    s_nop 1
    v_fmac_f32 v110, s27, v87
    v_readlane_b32 s27, v36, 36
    s_nop 1
    v_fmac_f32 v110, s27, v88
    v_readlane_b32 s27, v37, 36
    s_nop 1
    v_fmac_f32 v110, s27, v89
    v_readlane_b32 s27, v38, 36
    s_nop 1
    v_fmac_f32 v110, s27, v90
    v_readlane_b32 s27, v39, 36
    s_nop 1
    v_fmac_f32 v110, s27, v91
    v_readlane_b32 s27, v36, 52
    s_nop 1
    v_fmac_f32 v110, s27, v92
    v_readlane_b32 s27, v37, 52
    s_nop 1
    v_fmac_f32 v110, s27, v93
    v_readlane_b32 s27, v38, 52
    s_nop 1
    v_fmac_f32 v110, s27, v94
    v_readlane_b32 s27, v39, 52
    s_nop 1
    v_fmac_f32 v110, s27, v95
    v_readlane_b32 s27, v40, 4
    s_nop 1
    v_fmac_f32 v110, s27, v96
    v_readlane_b32 s27, v41, 4
    s_nop 1
    v_fmac_f32 v110, s27, v97
    v_readlane_b32 s27, v42, 4
    s_nop 1
    v_fmac_f32 v110, s27, v98
    v_readlane_b32 s27, v43, 4
    s_nop 1
    v_fmac_f32 v110, s27, v99
    v_readlane_b32 s27, v40, 20
    s_nop 1
    v_fmac_f32 v110, s27, v100
    v_readlane_b32 s27, v41, 20
    s_nop 1
    v_fmac_f32 v110, s27, v101
    v_readlane_b32 s27, v42, 20
    s_nop 1
    v_fmac_f32 v110, s27, v102
    v_readlane_b32 s27, v43, 20
    s_nop 1
    v_fmac_f32 v110, s27, v103
    v_cvt_pk_bf16_f32 v110, v110, v110
    ds_write_b16 v9, v110 offset:10752
    v_mov_b32 v110, 0
    v_readlane_b32 s27, v32, 5
    s_nop 1
    v_fmac_f32 v110, s27, v64
    v_readlane_b32 s27, v33, 5
    s_nop 1
    v_fmac_f32 v110, s27, v65
    v_readlane_b32 s27, v34, 5
    s_nop 1
    v_fmac_f32 v110, s27, v66
    v_readlane_b32 s27, v35, 5
    s_nop 1
    v_fmac_f32 v110, s27, v67
    v_readlane_b32 s27, v32, 21
    s_nop 1
    v_fmac_f32 v110, s27, v68
    v_readlane_b32 s27, v33, 21
    s_nop 1
    v_fmac_f32 v110, s27, v69
    v_readlane_b32 s27, v34, 21
    s_nop 1
    v_fmac_f32 v110, s27, v70
    v_readlane_b32 s27, v35, 21
    s_nop 1
    v_fmac_f32 v110, s27, v71
    v_readlane_b32 s27, v32, 37
    s_nop 1
    v_fmac_f32 v110, s27, v72
    v_readlane_b32 s27, v33, 37
    s_nop 1
    v_fmac_f32 v110, s27, v73
    v_readlane_b32 s27, v34, 37
    s_nop 1
    v_fmac_f32 v110, s27, v74
    v_readlane_b32 s27, v35, 37
    s_nop 1
    v_fmac_f32 v110, s27, v75
    v_readlane_b32 s27, v32, 53
    s_nop 1
    v_fmac_f32 v110, s27, v76
    v_readlane_b32 s27, v33, 53
    s_nop 1
    v_fmac_f32 v110, s27, v77
    v_readlane_b32 s27, v34, 53
    s_nop 1
    v_fmac_f32 v110, s27, v78
    v_readlane_b32 s27, v35, 53
    s_nop 1
    v_fmac_f32 v110, s27, v79
    v_readlane_b32 s27, v36, 5
    s_nop 1
    v_fmac_f32 v110, s27, v80
    v_readlane_b32 s27, v37, 5
    s_nop 1
    v_fmac_f32 v110, s27, v81
    v_readlane_b32 s27, v38, 5
    s_nop 1
    v_fmac_f32 v110, s27, v82
    v_readlane_b32 s27, v39, 5
    s_nop 1
    v_fmac_f32 v110, s27, v83
    v_readlane_b32 s27, v36, 21
    s_nop 1
    v_fmac_f32 v110, s27, v84
    v_readlane_b32 s27, v37, 21
    s_nop 1
    v_fmac_f32 v110, s27, v85
    v_readlane_b32 s27, v38, 21
    s_nop 1
    v_fmac_f32 v110, s27, v86
    v_readlane_b32 s27, v39, 21
    s_nop 1
    v_fmac_f32 v110, s27, v87
    v_readlane_b32 s27, v36, 37
    s_nop 1
    v_fmac_f32 v110, s27, v88
    v_readlane_b32 s27, v37, 37
    s_nop 1
    v_fmac_f32 v110, s27, v89
    v_readlane_b32 s27, v38, 37
    s_nop 1
    v_fmac_f32 v110, s27, v90
    v_readlane_b32 s27, v39, 37
    s_nop 1
    v_fmac_f32 v110, s27, v91
    v_readlane_b32 s27, v36, 53
    s_nop 1
    v_fmac_f32 v110, s27, v92
    v_readlane_b32 s27, v37, 53
    s_nop 1
    v_fmac_f32 v110, s27, v93
    v_readlane_b32 s27, v38, 53
    s_nop 1
    v_fmac_f32 v110, s27, v94
    v_readlane_b32 s27, v39, 53
    s_nop 1
    v_fmac_f32 v110, s27, v95
    v_readlane_b32 s27, v40, 5
    s_nop 1
    v_fmac_f32 v110, s27, v96
    v_readlane_b32 s27, v41, 5
    s_nop 1
    v_fmac_f32 v110, s27, v97
    v_readlane_b32 s27, v42, 5
    s_nop 1
    v_fmac_f32 v110, s27, v98
    v_readlane_b32 s27, v43, 5
    s_nop 1
    v_fmac_f32 v110, s27, v99
    v_readlane_b32 s27, v40, 21
    s_nop 1
    v_fmac_f32 v110, s27, v100
    v_readlane_b32 s27, v41, 21
    s_nop 1
    v_fmac_f32 v110, s27, v101
    v_readlane_b32 s27, v42, 21
    s_nop 1
    v_fmac_f32 v110, s27, v102
    v_readlane_b32 s27, v43, 21
    s_nop 1
    v_fmac_f32 v110, s27, v103
    v_cvt_pk_bf16_f32 v110, v110, v110
    ds_write_b16 v9, v110 offset:10880
    v_mov_b32 v110, 0
    v_readlane_b32 s27, v32, 6
    s_nop 1
    v_fmac_f32 v110, s27, v64
    v_readlane_b32 s27, v33, 6
    s_nop 1
    v_fmac_f32 v110, s27, v65
    v_readlane_b32 s27, v34, 6
    s_nop 1
    v_fmac_f32 v110, s27, v66
    v_readlane_b32 s27, v35, 6
    s_nop 1
    v_fmac_f32 v110, s27, v67
    v_readlane_b32 s27, v32, 22
    s_nop 1
    v_fmac_f32 v110, s27, v68
    v_readlane_b32 s27, v33, 22
    s_nop 1
    v_fmac_f32 v110, s27, v69
    v_readlane_b32 s27, v34, 22
    s_nop 1
    v_fmac_f32 v110, s27, v70
    v_readlane_b32 s27, v35, 22
    s_nop 1
    v_fmac_f32 v110, s27, v71
    v_readlane_b32 s27, v32, 38
    s_nop 1
    v_fmac_f32 v110, s27, v72
    v_readlane_b32 s27, v33, 38
    s_nop 1
    v_fmac_f32 v110, s27, v73
    v_readlane_b32 s27, v34, 38
    s_nop 1
    v_fmac_f32 v110, s27, v74
    v_readlane_b32 s27, v35, 38
    s_nop 1
    v_fmac_f32 v110, s27, v75
    v_readlane_b32 s27, v32, 54
    s_nop 1
    v_fmac_f32 v110, s27, v76
    v_readlane_b32 s27, v33, 54
    s_nop 1
    v_fmac_f32 v110, s27, v77
    v_readlane_b32 s27, v34, 54
    s_nop 1
    v_fmac_f32 v110, s27, v78
    v_readlane_b32 s27, v35, 54
    s_nop 1
    v_fmac_f32 v110, s27, v79
    v_readlane_b32 s27, v36, 6
    s_nop 1
    v_fmac_f32 v110, s27, v80
    v_readlane_b32 s27, v37, 6
    s_nop 1
    v_fmac_f32 v110, s27, v81
    v_readlane_b32 s27, v38, 6
    s_nop 1
    v_fmac_f32 v110, s27, v82
    v_readlane_b32 s27, v39, 6
    s_nop 1
    v_fmac_f32 v110, s27, v83
    v_readlane_b32 s27, v36, 22
    s_nop 1
    v_fmac_f32 v110, s27, v84
    v_readlane_b32 s27, v37, 22
    s_nop 1
    v_fmac_f32 v110, s27, v85
    v_readlane_b32 s27, v38, 22
    s_nop 1
    v_fmac_f32 v110, s27, v86
    v_readlane_b32 s27, v39, 22
    s_nop 1
    v_fmac_f32 v110, s27, v87
    v_readlane_b32 s27, v36, 38
    s_nop 1
    v_fmac_f32 v110, s27, v88
    v_readlane_b32 s27, v37, 38
    s_nop 1
    v_fmac_f32 v110, s27, v89
    v_readlane_b32 s27, v38, 38
    s_nop 1
    v_fmac_f32 v110, s27, v90
    v_readlane_b32 s27, v39, 38
    s_nop 1
    v_fmac_f32 v110, s27, v91
    v_readlane_b32 s27, v36, 54
    s_nop 1
    v_fmac_f32 v110, s27, v92
    v_readlane_b32 s27, v37, 54
    s_nop 1
    v_fmac_f32 v110, s27, v93
    v_readlane_b32 s27, v38, 54
    s_nop 1
    v_fmac_f32 v110, s27, v94
    v_readlane_b32 s27, v39, 54
    s_nop 1
    v_fmac_f32 v110, s27, v95
    v_readlane_b32 s27, v40, 6
    s_nop 1
    v_fmac_f32 v110, s27, v96
    v_readlane_b32 s27, v41, 6
    s_nop 1
    v_fmac_f32 v110, s27, v97
    v_readlane_b32 s27, v42, 6
    s_nop 1
    v_fmac_f32 v110, s27, v98
    v_readlane_b32 s27, v43, 6
    s_nop 1
    v_fmac_f32 v110, s27, v99
    v_readlane_b32 s27, v40, 22
    s_nop 1
    v_fmac_f32 v110, s27, v100
    v_readlane_b32 s27, v41, 22
    s_nop 1
    v_fmac_f32 v110, s27, v101
    v_readlane_b32 s27, v42, 22
    s_nop 1
    v_fmac_f32 v110, s27, v102
    v_readlane_b32 s27, v43, 22
    s_nop 1
    v_fmac_f32 v110, s27, v103
    v_cvt_pk_bf16_f32 v110, v110, v110
    ds_write_b16 v9, v110 offset:11008
    v_mov_b32 v110, 0
    v_readlane_b32 s27, v32, 7
    s_nop 1
    v_fmac_f32 v110, s27, v64
    v_readlane_b32 s27, v33, 7
    s_nop 1
    v_fmac_f32 v110, s27, v65
    v_readlane_b32 s27, v34, 7
    s_nop 1
    v_fmac_f32 v110, s27, v66
    v_readlane_b32 s27, v35, 7
    s_nop 1
    v_fmac_f32 v110, s27, v67
    v_readlane_b32 s27, v32, 23
    s_nop 1
    v_fmac_f32 v110, s27, v68
    v_readlane_b32 s27, v33, 23
    s_nop 1
    v_fmac_f32 v110, s27, v69
    v_readlane_b32 s27, v34, 23
    s_nop 1
    v_fmac_f32 v110, s27, v70
    v_readlane_b32 s27, v35, 23
    s_nop 1
    v_fmac_f32 v110, s27, v71
    v_readlane_b32 s27, v32, 39
    s_nop 1
    v_fmac_f32 v110, s27, v72
    v_readlane_b32 s27, v33, 39
    s_nop 1
    v_fmac_f32 v110, s27, v73
    v_readlane_b32 s27, v34, 39
    s_nop 1
    v_fmac_f32 v110, s27, v74
    v_readlane_b32 s27, v35, 39
    s_nop 1
    v_fmac_f32 v110, s27, v75
    v_readlane_b32 s27, v32, 55
    s_nop 1
    v_fmac_f32 v110, s27, v76
    v_readlane_b32 s27, v33, 55
    s_nop 1
    v_fmac_f32 v110, s27, v77
    v_readlane_b32 s27, v34, 55
    s_nop 1
    v_fmac_f32 v110, s27, v78
    v_readlane_b32 s27, v35, 55
    s_nop 1
    v_fmac_f32 v110, s27, v79
    v_readlane_b32 s27, v36, 7
    s_nop 1
    v_fmac_f32 v110, s27, v80
    v_readlane_b32 s27, v37, 7
    s_nop 1
    v_fmac_f32 v110, s27, v81
    v_readlane_b32 s27, v38, 7
    s_nop 1
    v_fmac_f32 v110, s27, v82
    v_readlane_b32 s27, v39, 7
    s_nop 1
    v_fmac_f32 v110, s27, v83
    v_readlane_b32 s27, v36, 23
    s_nop 1
    v_fmac_f32 v110, s27, v84
    v_readlane_b32 s27, v37, 23
    s_nop 1
    v_fmac_f32 v110, s27, v85
    v_readlane_b32 s27, v38, 23
    s_nop 1
    v_fmac_f32 v110, s27, v86
    v_readlane_b32 s27, v39, 23
    s_nop 1
    v_fmac_f32 v110, s27, v87
    v_readlane_b32 s27, v36, 39
    s_nop 1
    v_fmac_f32 v110, s27, v88
    v_readlane_b32 s27, v37, 39
    s_nop 1
    v_fmac_f32 v110, s27, v89
    v_readlane_b32 s27, v38, 39
    s_nop 1
    v_fmac_f32 v110, s27, v90
    v_readlane_b32 s27, v39, 39
    s_nop 1
    v_fmac_f32 v110, s27, v91
    v_readlane_b32 s27, v36, 55
    s_nop 1
    v_fmac_f32 v110, s27, v92
    v_readlane_b32 s27, v37, 55
    s_nop 1
    v_fmac_f32 v110, s27, v93
    v_readlane_b32 s27, v38, 55
    s_nop 1
    v_fmac_f32 v110, s27, v94
    v_readlane_b32 s27, v39, 55
    s_nop 1
    v_fmac_f32 v110, s27, v95
    v_readlane_b32 s27, v40, 7
    s_nop 1
    v_fmac_f32 v110, s27, v96
    v_readlane_b32 s27, v41, 7
    s_nop 1
    v_fmac_f32 v110, s27, v97
    v_readlane_b32 s27, v42, 7
    s_nop 1
    v_fmac_f32 v110, s27, v98
    v_readlane_b32 s27, v43, 7
    s_nop 1
    v_fmac_f32 v110, s27, v99
    v_readlane_b32 s27, v40, 23
    s_nop 1
    v_fmac_f32 v110, s27, v100
    v_readlane_b32 s27, v41, 23
    s_nop 1
    v_fmac_f32 v110, s27, v101
    v_readlane_b32 s27, v42, 23
    s_nop 1
    v_fmac_f32 v110, s27, v102
    v_readlane_b32 s27, v43, 23
    s_nop 1
    v_fmac_f32 v110, s27, v103
    v_cvt_pk_bf16_f32 v110, v110, v110
    ds_write_b16 v9, v110 offset:11136
    s_waitcnt lgkmcnt(0)
chb_kernel_w:
    s_barrier
    v_and_b32 v9, 7, v1
    v_lshlrev_b32 v9, 7, v9
    v_lshl_add_u32 v9, v2, 4, v9
    ds_read_b128 v[10:13], v9 offset:10240
    ds_read_b128 v[14:17], v9 offset:10304
    s_waitcnt lgkmcnt(0)
    v_mov_b32 v32, 0
    v_mov_b32 v33, 0
    v_mov_b32 v34, 0
    v_mov_b32 v35, 0
    s_nop 1
    v_mfma_f32_16x16x32_bf16 v[32:35], a[168:171], v[10:13], v[32:35]
    v_mfma_f32_16x16x32_bf16 v[32:35], a[172:175], v[14:17], v[32:35]
    v_mov_b32 v36, 0
    v_mov_b32 v37, 0
    v_mov_b32 v38, 0
    v_mov_b32 v39, 0
    s_nop 1
    v_mfma_f32_16x16x32_bf16 v[36:39], a[176:179], v[10:13], v[36:39]
    v_mfma_f32_16x16x32_bf16 v[36:39], a[180:183], v[14:17], v[36:39]
    v_mov_b32 v40, 0
    v_mov_b32 v41, 0
    v_mov_b32 v42, 0
    v_mov_b32 v43, 0
    s_nop 1
    v_mfma_f32_16x16x32_bf16 v[40:43], a[184:187], v[10:13], v[40:43]
    v_mfma_f32_16x16x32_bf16 v[40:43], a[188:191], v[14:17], v[40:43]
    v_mov_b32 v44, 0
    v_mov_b32 v45, 0
    v_mov_b32 v46, 0
    v_mov_b32 v47, 0
    s_nop 1
    v_mfma_f32_16x16x32_bf16 v[44:47], a[192:195], v[10:13], v[44:47]
    v_mfma_f32_16x16x32_bf16 v[44:47], a[196:199], v[14:17], v[44:47]
    v_mov_b32 v48, 0
    v_mov_b32 v49, 0
    v_mov_b32 v50, 0
    v_mov_b32 v51, 0
    s_nop 1
    v_mfma_f32_16x16x32_bf16 v[48:51], a[200:203], v[10:13], v[48:51]
    v_mfma_f32_16x16x32_bf16 v[48:51], a[204:207], v[14:17], v[48:51]
    v_mov_b32 v52, 0
    v_mov_b32 v53, 0
    v_mov_b32 v54, 0
    v_mov_b32 v55, 0
    s_nop 1
    v_mfma_f32_16x16x32_bf16 v[52:55], a[208:211], v[10:13], v[52:55]
    v_mfma_f32_16x16x32_bf16 v[52:55], a[212:215], v[14:17], v[52:55]
    v_mov_b32 v56, 0
    v_mov_b32 v57, 0
    v_mov_b32 v58, 0
    v_mov_b32 v59, 0
    s_nop 1
    v_mfma_f32_16x16x32_bf16 v[56:59], a[216:219], v[10:13], v[56:59]
    v_mfma_f32_16x16x32_bf16 v[56:59], a[220:223], v[14:17], v[56:59]
    s_nop 7
    s_nop 7
    s_and_b32 s28, s20, 1
    s_mul_i32 s28, s28, 917504
    s_add_u32 s28, s28, 108265472
    s_mul_i32 s29, s2, 224
    s_add_u32 s29, s29, s28
    v_cmp_gt_u32 vcc, 8, v1
    s_and_saveexec_b64 s[30:31], vcc
    s_mul_i32 s5, s3, 112
    v_lshl_add_u32 v5, v2, 2, s5
    v_add_u32 v5, 0, v5
    v_mul_u32_u24 v6, 9363, v5
    v_lshrrev_b32 v6, 16, v6
    v_mul_u32_u24 v7, 7, v6
    v_sub_u32 v7, v5, v7
    v_mul_u32_u24 v6, 14336, v6
    v_mul_u32_u24 v8, 28, v1
    v_lshl_add_u32 v6, v7, 2, v6
    v_add_u32 v6, v6, v8
    buffer_store_dword v32, v6, s[8:11], s29 offen sc1
    s_mul_i32 s5, s3, 112
    v_lshl_add_u32 v5, v2, 2, s5
    v_add_u32 v5, 1, v5
    v_mul_u32_u24 v6, 9363, v5
    v_lshrrev_b32 v6, 16, v6
    v_mul_u32_u24 v7, 7, v6
    v_sub_u32 v7, v5, v7
    v_mul_u32_u24 v6, 14336, v6
    v_mul_u32_u24 v8, 28, v1
    v_lshl_add_u32 v6, v7, 2, v6
    v_add_u32 v6, v6, v8
    buffer_store_dword v33, v6, s[8:11], s29 offen sc1
    s_mul_i32 s5, s3, 112
    v_lshl_add_u32 v5, v2, 2, s5
    v_add_u32 v5, 2, v5
    v_mul_u32_u24 v6, 9363, v5
    v_lshrrev_b32 v6, 16, v6
    v_mul_u32_u24 v7, 7, v6
    v_sub_u32 v7, v5, v7
    v_mul_u32_u24 v6, 14336, v6
    v_mul_u32_u24 v8, 28, v1
    v_lshl_add_u32 v6, v7, 2, v6
    v_add_u32 v6, v6, v8
    buffer_store_dword v34, v6, s[8:11], s29 offen sc1
    s_mul_i32 s5, s3, 112
    v_lshl_add_u32 v5, v2, 2, s5
    v_add_u32 v5, 3, v5
    v_mul_u32_u24 v6, 9363, v5
    v_lshrrev_b32 v6, 16, v6
    v_mul_u32_u24 v7, 7, v6
    v_sub_u32 v7, v5, v7
    v_mul_u32_u24 v6, 14336, v6
    v_mul_u32_u24 v8, 28, v1
    v_lshl_add_u32 v6, v7, 2, v6
    v_add_u32 v6, v6, v8
    buffer_store_dword v35, v6, s[8:11], s29 offen sc1
    s_mul_i32 s5, s3, 112
    v_lshl_add_u32 v5, v2, 2, s5
    v_add_u32 v5, 16, v5
    v_mul_u32_u24 v6, 9363, v5
    v_lshrrev_b32 v6, 16, v6
    v_mul_u32_u24 v7, 7, v6
    v_sub_u32 v7, v5, v7
    v_mul_u32_u24 v6, 14336, v6
    v_mul_u32_u24 v8, 28, v1
    v_lshl_add_u32 v6, v7, 2, v6
    v_add_u32 v6, v6, v8
    buffer_store_dword v36, v6, s[8:11], s29 offen sc1
    s_mul_i32 s5, s3, 112
    v_lshl_add_u32 v5, v2, 2, s5
    v_add_u32 v5, 17, v5
    v_mul_u32_u24 v6, 9363, v5
    v_lshrrev_b32 v6, 16, v6
    v_mul_u32_u24 v7, 7, v6
    v_sub_u32 v7, v5, v7
    v_mul_u32_u24 v6, 14336, v6
    v_mul_u32_u24 v8, 28, v1
    v_lshl_add_u32 v6, v7, 2, v6
    v_add_u32 v6, v6, v8
    buffer_store_dword v37, v6, s[8:11], s29 offen sc1
    s_mul_i32 s5, s3, 112
    v_lshl_add_u32 v5, v2, 2, s5
    v_add_u32 v5, 18, v5
    v_mul_u32_u24 v6, 9363, v5
    v_lshrrev_b32 v6, 16, v6
    v_mul_u32_u24 v7, 7, v6
    v_sub_u32 v7, v5, v7
    v_mul_u32_u24 v6, 14336, v6
    v_mul_u32_u24 v8, 28, v1
    v_lshl_add_u32 v6, v7, 2, v6
    v_add_u32 v6, v6, v8
    buffer_store_dword v38, v6, s[8:11], s29 offen sc1
    s_mul_i32 s5, s3, 112
    v_lshl_add_u32 v5, v2, 2, s5
    v_add_u32 v5, 19, v5
    v_mul_u32_u24 v6, 9363, v5
    v_lshrrev_b32 v6, 16, v6
    v_mul_u32_u24 v7, 7, v6
    v_sub_u32 v7, v5, v7
    v_mul_u32_u24 v6, 14336, v6
    v_mul_u32_u24 v8, 28, v1
    v_lshl_add_u32 v6, v7, 2, v6
    v_add_u32 v6, v6, v8
    buffer_store_dword v39, v6, s[8:11], s29 offen sc1
    s_mul_i32 s5, s3, 112
    v_lshl_add_u32 v5, v2, 2, s5
    v_add_u32 v5, 32, v5
    v_mul_u32_u24 v6, 9363, v5
    v_lshrrev_b32 v6, 16, v6
    v_mul_u32_u24 v7, 7, v6
    v_sub_u32 v7, v5, v7
    v_mul_u32_u24 v6, 14336, v6
    v_mul_u32_u24 v8, 28, v1
    v_lshl_add_u32 v6, v7, 2, v6
    v_add_u32 v6, v6, v8
    buffer_store_dword v40, v6, s[8:11], s29 offen sc1
    s_mul_i32 s5, s3, 112
    v_lshl_add_u32 v5, v2, 2, s5
    v_add_u32 v5, 33, v5
    v_mul_u32_u24 v6, 9363, v5
    v_lshrrev_b32 v6, 16, v6
    v_mul_u32_u24 v7, 7, v6
    v_sub_u32 v7, v5, v7
    v_mul_u32_u24 v6, 14336, v6
    v_mul_u32_u24 v8, 28, v1
    v_lshl_add_u32 v6, v7, 2, v6
    v_add_u32 v6, v6, v8
    buffer_store_dword v41, v6, s[8:11], s29 offen sc1
    s_mul_i32 s5, s3, 112
    v_lshl_add_u32 v5, v2, 2, s5
    v_add_u32 v5, 34, v5
    v_mul_u32_u24 v6, 9363, v5
    v_lshrrev_b32 v6, 16, v6
    v_mul_u32_u24 v7, 7, v6
    v_sub_u32 v7, v5, v7
    v_mul_u32_u24 v6, 14336, v6
    v_mul_u32_u24 v8, 28, v1
    v_lshl_add_u32 v6, v7, 2, v6
    v_add_u32 v6, v6, v8
    buffer_store_dword v42, v6, s[8:11], s29 offen sc1
    s_mul_i32 s5, s3, 112
    v_lshl_add_u32 v5, v2, 2, s5
    v_add_u32 v5, 35, v5
    v_mul_u32_u24 v6, 9363, v5
    v_lshrrev_b32 v6, 16, v6
    v_mul_u32_u24 v7, 7, v6
    v_sub_u32 v7, v5, v7
    v_mul_u32_u24 v6, 14336, v6
    v_mul_u32_u24 v8, 28, v1
    v_lshl_add_u32 v6, v7, 2, v6
    v_add_u32 v6, v6, v8
    buffer_store_dword v43, v6, s[8:11], s29 offen sc1
    s_mul_i32 s5, s3, 112
    v_lshl_add_u32 v5, v2, 2, s5
    v_add_u32 v5, 48, v5
    v_mul_u32_u24 v6, 9363, v5
    v_lshrrev_b32 v6, 16, v6
    v_mul_u32_u24 v7, 7, v6
    v_sub_u32 v7, v5, v7
    v_mul_u32_u24 v6, 14336, v6
    v_mul_u32_u24 v8, 28, v1
    v_lshl_add_u32 v6, v7, 2, v6
    v_add_u32 v6, v6, v8
    buffer_store_dword v44, v6, s[8:11], s29 offen sc1
    s_mul_i32 s5, s3, 112
    v_lshl_add_u32 v5, v2, 2, s5
    v_add_u32 v5, 49, v5
    v_mul_u32_u24 v6, 9363, v5
    v_lshrrev_b32 v6, 16, v6
    v_mul_u32_u24 v7, 7, v6
    v_sub_u32 v7, v5, v7
    v_mul_u32_u24 v6, 14336, v6
    v_mul_u32_u24 v8, 28, v1
    v_lshl_add_u32 v6, v7, 2, v6
    v_add_u32 v6, v6, v8
    buffer_store_dword v45, v6, s[8:11], s29 offen sc1
    s_mul_i32 s5, s3, 112
    v_lshl_add_u32 v5, v2, 2, s5
    v_add_u32 v5, 50, v5
    v_mul_u32_u24 v6, 9363, v5
    v_lshrrev_b32 v6, 16, v6
    v_mul_u32_u24 v7, 7, v6
    v_sub_u32 v7, v5, v7
    v_mul_u32_u24 v6, 14336, v6
    v_mul_u32_u24 v8, 28, v1
    v_lshl_add_u32 v6, v7, 2, v6
    v_add_u32 v6, v6, v8
    buffer_store_dword v46, v6, s[8:11], s29 offen sc1
    s_mul_i32 s5, s3, 112
    v_lshl_add_u32 v5, v2, 2, s5
    v_add_u32 v5, 51, v5
    v_mul_u32_u24 v6, 9363, v5
    v_lshrrev_b32 v6, 16, v6
    v_mul_u32_u24 v7, 7, v6
    v_sub_u32 v7, v5, v7
    v_mul_u32_u24 v6, 14336, v6
    v_mul_u32_u24 v8, 28, v1
    v_lshl_add_u32 v6, v7, 2, v6
    v_add_u32 v6, v6, v8
    buffer_store_dword v47, v6, s[8:11], s29 offen sc1
    s_mul_i32 s5, s3, 112
    v_lshl_add_u32 v5, v2, 2, s5
    v_add_u32 v5, 64, v5
    v_mul_u32_u24 v6, 9363, v5
    v_lshrrev_b32 v6, 16, v6
    v_mul_u32_u24 v7, 7, v6
    v_sub_u32 v7, v5, v7
    v_mul_u32_u24 v6, 14336, v6
    v_mul_u32_u24 v8, 28, v1
    v_lshl_add_u32 v6, v7, 2, v6
    v_add_u32 v6, v6, v8
    buffer_store_dword v48, v6, s[8:11], s29 offen sc1
    s_mul_i32 s5, s3, 112
    v_lshl_add_u32 v5, v2, 2, s5
    v_add_u32 v5, 65, v5
    v_mul_u32_u24 v6, 9363, v5
    v_lshrrev_b32 v6, 16, v6
    v_mul_u32_u24 v7, 7, v6
    v_sub_u32 v7, v5, v7
    v_mul_u32_u24 v6, 14336, v6
    v_mul_u32_u24 v8, 28, v1
    v_lshl_add_u32 v6, v7, 2, v6
    v_add_u32 v6, v6, v8
    buffer_store_dword v49, v6, s[8:11], s29 offen sc1
    s_mul_i32 s5, s3, 112
    v_lshl_add_u32 v5, v2, 2, s5
    v_add_u32 v5, 66, v5
    v_mul_u32_u24 v6, 9363, v5
    v_lshrrev_b32 v6, 16, v6
    v_mul_u32_u24 v7, 7, v6
    v_sub_u32 v7, v5, v7
    v_mul_u32_u24 v6, 14336, v6
    v_mul_u32_u24 v8, 28, v1
    v_lshl_add_u32 v6, v7, 2, v6
    v_add_u32 v6, v6, v8
    buffer_store_dword v50, v6, s[8:11], s29 offen sc1
    s_mul_i32 s5, s3, 112
    v_lshl_add_u32 v5, v2, 2, s5
    v_add_u32 v5, 67, v5
    v_mul_u32_u24 v6, 9363, v5
    v_lshrrev_b32 v6, 16, v6
    v_mul_u32_u24 v7, 7, v6
    v_sub_u32 v7, v5, v7
    v_mul_u32_u24 v6, 14336, v6
    v_mul_u32_u24 v8, 28, v1
    v_lshl_add_u32 v6, v7, 2, v6
    v_add_u32 v6, v6, v8
    buffer_store_dword v51, v6, s[8:11], s29 offen sc1
    s_mul_i32 s5, s3, 112
    v_lshl_add_u32 v5, v2, 2, s5
    v_add_u32 v5, 80, v5
    v_mul_u32_u24 v6, 9363, v5
    v_lshrrev_b32 v6, 16, v6
    v_mul_u32_u24 v7, 7, v6
    v_sub_u32 v7, v5, v7
    v_mul_u32_u24 v6, 14336, v6
    v_mul_u32_u24 v8, 28, v1
    v_lshl_add_u32 v6, v7, 2, v6
    v_add_u32 v6, v6, v8
    buffer_store_dword v52, v6, s[8:11], s29 offen sc1
    s_mul_i32 s5, s3, 112
    v_lshl_add_u32 v5, v2, 2, s5
    v_add_u32 v5, 81, v5
    v_mul_u32_u24 v6, 9363, v5
    v_lshrrev_b32 v6, 16, v6
    v_mul_u32_u24 v7, 7, v6
    v_sub_u32 v7, v5, v7
    v_mul_u32_u24 v6, 14336, v6
    v_mul_u32_u24 v8, 28, v1
    v_lshl_add_u32 v6, v7, 2, v6
    v_add_u32 v6, v6, v8
    buffer_store_dword v53, v6, s[8:11], s29 offen sc1
    s_mul_i32 s5, s3, 112
    v_lshl_add_u32 v5, v2, 2, s5
    v_add_u32 v5, 82, v5
    v_mul_u32_u24 v6, 9363, v5
    v_lshrrev_b32 v6, 16, v6
    v_mul_u32_u24 v7, 7, v6
    v_sub_u32 v7, v5, v7
    v_mul_u32_u24 v6, 14336, v6
    v_mul_u32_u24 v8, 28, v1
    v_lshl_add_u32 v6, v7, 2, v6
    v_add_u32 v6, v6, v8
    buffer_store_dword v54, v6, s[8:11], s29 offen sc1
    s_mul_i32 s5, s3, 112
    v_lshl_add_u32 v5, v2, 2, s5
    v_add_u32 v5, 83, v5
    v_mul_u32_u24 v6, 9363, v5
    v_lshrrev_b32 v6, 16, v6
    v_mul_u32_u24 v7, 7, v6
    v_sub_u32 v7, v5, v7
    v_mul_u32_u24 v6, 14336, v6
    v_mul_u32_u24 v8, 28, v1
    v_lshl_add_u32 v6, v7, 2, v6
    v_add_u32 v6, v6, v8
    buffer_store_dword v55, v6, s[8:11], s29 offen sc1
    s_mul_i32 s5, s3, 112
    v_lshl_add_u32 v5, v2, 2, s5
    v_add_u32 v5, 96, v5
    v_mul_u32_u24 v6, 9363, v5
    v_lshrrev_b32 v6, 16, v6
    v_mul_u32_u24 v7, 7, v6
    v_sub_u32 v7, v5, v7
    v_mul_u32_u24 v6, 14336, v6
    v_mul_u32_u24 v8, 28, v1
    v_lshl_add_u32 v6, v7, 2, v6
    v_add_u32 v6, v6, v8
    buffer_store_dword v56, v6, s[8:11], s29 offen sc1
    s_mul_i32 s5, s3, 112
    v_lshl_add_u32 v5, v2, 2, s5
    v_add_u32 v5, 97, v5
    v_mul_u32_u24 v6, 9363, v5
    v_lshrrev_b32 v6, 16, v6
    v_mul_u32_u24 v7, 7, v6
    v_sub_u32 v7, v5, v7
    v_mul_u32_u24 v6, 14336, v6
    v_mul_u32_u24 v8, 28, v1
    v_lshl_add_u32 v6, v7, 2, v6
    v_add_u32 v6, v6, v8
    buffer_store_dword v57, v6, s[8:11], s29 offen sc1
    s_mul_i32 s5, s3, 112
    v_lshl_add_u32 v5, v2, 2, s5
    v_add_u32 v5, 98, v5
    v_mul_u32_u24 v6, 9363, v5
    v_lshrrev_b32 v6, 16, v6
    v_mul_u32_u24 v7, 7, v6
    v_sub_u32 v7, v5, v7
    v_mul_u32_u24 v6, 14336, v6
    v_mul_u32_u24 v8, 28, v1
    v_lshl_add_u32 v6, v7, 2, v6
    v_add_u32 v6, v6, v8
    buffer_store_dword v58, v6, s[8:11], s29 offen sc1
    s_mul_i32 s5, s3, 112
    v_lshl_add_u32 v5, v2, 2, s5
    v_add_u32 v5, 99, v5
    v_mul_u32_u24 v6, 9363, v5
    v_lshrrev_b32 v6, 16, v6
    v_mul_u32_u24 v7, 7, v6
    v_sub_u32 v7, v5, v7
    v_mul_u32_u24 v6, 14336, v6
    v_mul_u32_u24 v8, 28, v1
    v_lshl_add_u32 v6, v7, 2, v6
    v_add_u32 v6, v6, v8
    buffer_store_dword v59, v6, s[8:11], s29 offen sc1
    s_mov_b64 exec, s[30:31]
    v_cmp_gt_u32 vcc, 224, v0
    s_and_saveexec_b64 s[30:31], vcc
    s_cbranch_execz chb_kernel_r2
    v_mul_u32_u24 v5, 1171, v0
    v_lshrrev_b32 v5, 16, v5
    v_mul_u32_u24 v6, 56, v5
    v_sub_u32 v6, v0, v6
    v_mul_u32_u24 v7, 3584, v5
    v_lshl_add_u32 v7, v6, 2, v7
    s_mul_i32 s29, s2, 14336
    s_add_u32 s29, s29, s28
chb_kernel_p2:
    v_mov_b32 v29, 0
    buffer_load_dword v64, v7, s[8:11], s29 offen offset:0 sc1
    buffer_load_dword v65, v7, s[8:11], s29 offen offset:224 sc1
    buffer_load_dword v66, v7, s[8:11], s29 offen offset:448 sc1
    buffer_load_dword v67, v7, s[8:11], s29 offen offset:672 sc1
    buffer_load_dword v68, v7, s[8:11], s29 offen offset:896 sc1
    buffer_load_dword v69, v7, s[8:11], s29 offen offset:1120 sc1
    buffer_load_dword v70, v7, s[8:11], s29 offen offset:1344 sc1
    buffer_load_dword v71, v7, s[8:11], s29 offen offset:1568 sc1
    buffer_load_dword v72, v7, s[8:11], s29 offen offset:1792 sc1
    buffer_load_dword v73, v7, s[8:11], s29 offen offset:2016 sc1
    buffer_load_dword v74, v7, s[8:11], s29 offen offset:2240 sc1
    buffer_load_dword v75, v7, s[8:11], s29 offen offset:2464 sc1
    buffer_load_dword v76, v7, s[8:11], s29 offen offset:2688 sc1
    buffer_load_dword v77, v7, s[8:11], s29 offen offset:2912 sc1
    buffer_load_dword v78, v7, s[8:11], s29 offen offset:3136 sc1
    buffer_load_dword v79, v7, s[8:11], s29 offen offset:3360 sc1
    s_waitcnt vmcnt(0)
    v_cmp_eq_u32 vcc, -1, v64
    s_nop 1
    v_addc_co_u32 v29, vcc, 0, v29, vcc
    v_cmp_eq_u32 vcc, -1, v65
    s_nop 1
    v_addc_co_u32 v29, vcc, 0, v29, vcc
    v_cmp_eq_u32 vcc, -1, v66
    s_nop 1
    v_addc_co_u32 v29, vcc, 0, v29, vcc
    v_cmp_eq_u32 vcc, -1, v67
    s_nop 1
    v_addc_co_u32 v29, vcc, 0, v29, vcc
    v_cmp_eq_u32 vcc, -1, v68
    s_nop 1
    v_addc_co_u32 v29, vcc, 0, v29, vcc
    v_cmp_eq_u32 vcc, -1, v69
    s_nop 1
    v_addc_co_u32 v29, vcc, 0, v29, vcc
    v_cmp_eq_u32 vcc, -1, v70
    s_nop 1
    v_addc_co_u32 v29, vcc, 0, v29, vcc
    v_cmp_eq_u32 vcc, -1, v71
    s_nop 1
    v_addc_co_u32 v29, vcc, 0, v29, vcc
    v_cmp_eq_u32 vcc, -1, v72
    s_nop 1
    v_addc_co_u32 v29, vcc, 0, v29, vcc
    v_cmp_eq_u32 vcc, -1, v73
    s_nop 1
    v_addc_co_u32 v29, vcc, 0, v29, vcc
    v_cmp_eq_u32 vcc, -1, v74
    s_nop 1
    v_addc_co_u32 v29, vcc, 0, v29, vcc
    v_cmp_eq_u32 vcc, -1, v75
    s_nop 1
    v_addc_co_u32 v29, vcc, 0, v29, vcc
    v_cmp_eq_u32 vcc, -1, v76
    s_nop 1
    v_addc_co_u32 v29, vcc, 0, v29, vcc
    v_cmp_eq_u32 vcc, -1, v77
    s_nop 1
    v_addc_co_u32 v29, vcc, 0, v29, vcc
    v_cmp_eq_u32 vcc, -1, v78
    s_nop 1
    v_addc_co_u32 v29, vcc, 0, v29, vcc
    v_cmp_eq_u32 vcc, -1, v79
    s_nop 1
    v_addc_co_u32 v29, vcc, 0, v29, vcc
    v_cmp_ne_u32 vcc, 0, v29
    s_nop 1
    s_cbranch_vccnz chb_kernel_p2
    v_mov_b32 v8, -1
    buffer_store_dword v8, v7, s[8:11], s29 offen offset:0 sc1
    buffer_store_dword v8, v7, s[8:11], s29 offen offset:224 sc1
    buffer_store_dword v8, v7, s[8:11], s29 offen offset:448 sc1
    buffer_store_dword v8, v7, s[8:11], s29 offen offset:672 sc1
    buffer_store_dword v8, v7, s[8:11], s29 offen offset:896 sc1
    buffer_store_dword v8, v7, s[8:11], s29 offen offset:1120 sc1
    buffer_store_dword v8, v7, s[8:11], s29 offen offset:1344 sc1
    buffer_store_dword v8, v7, s[8:11], s29 offen offset:1568 sc1
    buffer_store_dword v8, v7, s[8:11], s29 offen offset:1792 sc1
    buffer_store_dword v8, v7, s[8:11], s29 offen offset:2016 sc1
    buffer_store_dword v8, v7, s[8:11], s29 offen offset:2240 sc1
    buffer_store_dword v8, v7, s[8:11], s29 offen offset:2464 sc1
    buffer_store_dword v8, v7, s[8:11], s29 offen offset:2688 sc1
    buffer_store_dword v8, v7, s[8:11], s29 offen offset:2912 sc1
    buffer_store_dword v8, v7, s[8:11], s29 offen offset:3136 sc1
    buffer_store_dword v8, v7, s[8:11], s29 offen offset:3360 sc1
    v_add_f32 v64, v64, v65
    v_add_f32 v64, v64, v66
    v_add_f32 v64, v64, v67
    v_add_f32 v64, v64, v68
    v_add_f32 v64, v64, v69
    v_add_f32 v64, v64, v70
    v_add_f32 v64, v64, v71
    v_add_f32 v64, v64, v72
    v_add_f32 v64, v64, v73
    v_add_f32 v64, v64, v74
    v_add_f32 v64, v64, v75
    v_add_f32 v64, v64, v76
    v_add_f32 v64, v64, v77
    v_add_f32 v64, v64, v78
    v_add_f32 v64, v64, v79
    v_lshlrev_b32 v9, 2, v0
    ds_write_b32 v9, v64 offset:11264
chb_kernel_r2:
    s_mov_b64 exec, s[30:31]
    s_waitcnt vmcnt(0) lgkmcnt(0)
    s_barrier
    s_add_u32 s24, s23, s2
    s_lshl_b32 s24, s24, 7
    s_add_u32 s24, s24, 110100480
    v_cmp_gt_u32 vcc, 56, v0
    s_and_saveexec_b64 s[30:31], vcc
    s_cbranch_execz chb_kernel_r3
    v_lshlrev_b32 v9, 2, v0
    ds_read_b32 v10, v9 offset:11264
    ds_read_b32 v11, v9 offset:11488
    ds_read_b32 v12, v9 offset:11712
    ds_read_b32 v13, v9 offset:11936
    s_waitcnt lgkmcnt(0)
    v_add_f32 v10, v10, v11
    v_add_f32 v12, v12, v13
    v_add_f32 v10, v10, v12
    v_cvt_pk_bf16_f32 v10, v10, v10
    v_lshlrev_b32 v9, 1, v0
    buffer_store_short v10, v9, s[8:11], s24 offen sc1
chb_kernel_r3:
    s_mov_b64 exec, s[30:31]
    s_lshl_b32 s25, s23, 7
    s_add_u32 s25, s25, 110100480
    v_lshrrev_b32 v5, 2, v0
    v_and_b32 v6, 3, v0
    v_lshlrev_b32 v7, 7, v5
    v_mul_u32_u24 v8, 28, v6
    v_add_u32 v7, v7, v8
chb_kernel_p3:
    v_mov_b32 v29, 0
    buffer_load_ushort v64, v7, s[8:11], s25 offen offset:0 sc1
    buffer_load_ushort v65, v7, s[8:11], s25 offen offset:2 sc1
    buffer_load_ushort v66, v7, s[8:11], s25 offen offset:4 sc1
    buffer_load_ushort v67, v7, s[8:11], s25 offen offset:6 sc1
    buffer_load_ushort v68, v7, s[8:11], s25 offen offset:8 sc1
    buffer_load_ushort v69, v7, s[8:11], s25 offen offset:10 sc1
    buffer_load_ushort v70, v7, s[8:11], s25 offen offset:12 sc1
    buffer_load_ushort v71, v7, s[8:11], s25 offen offset:14 sc1
    buffer_load_ushort v72, v7, s[8:11], s25 offen offset:16 sc1
    buffer_load_ushort v73, v7, s[8:11], s25 offen offset:18 sc1
    buffer_load_ushort v74, v7, s[8:11], s25 offen offset:20 sc1
    buffer_load_ushort v75, v7, s[8:11], s25 offen offset:22 sc1
    buffer_load_ushort v76, v7, s[8:11], s25 offen offset:24 sc1
    buffer_load_ushort v77, v7, s[8:11], s25 offen offset:26 sc1
    s_waitcnt vmcnt(0)
    v_cmp_eq_u32 vcc, 0xffff, v64
    s_nop 1
    v_addc_co_u32 v29, vcc, 0, v29, vcc
    v_cmp_eq_u32 vcc, 0xffff, v65
    s_nop 1
    v_addc_co_u32 v29, vcc, 0, v29, vcc
    v_cmp_eq_u32 vcc, 0xffff, v66
    s_nop 1
    v_addc_co_u32 v29, vcc, 0, v29, vcc
    v_cmp_eq_u32 vcc, 0xffff, v67
    s_nop 1
    v_addc_co_u32 v29, vcc, 0, v29, vcc
    v_cmp_eq_u32 vcc, 0xffff, v68
    s_nop 1
    v_addc_co_u32 v29, vcc, 0, v29, vcc
    v_cmp_eq_u32 vcc, 0xffff, v69
    s_nop 1
    v_addc_co_u32 v29, vcc, 0, v29, vcc
    v_cmp_eq_u32 vcc, 0xffff, v70
    s_nop 1
    v_addc_co_u32 v29, vcc, 0, v29, vcc
    v_cmp_eq_u32 vcc, 0xffff, v71
    s_nop 1
    v_addc_co_u32 v29, vcc, 0, v29, vcc
    v_cmp_eq_u32 vcc, 0xffff, v72
    s_nop 1
    v_addc_co_u32 v29, vcc, 0, v29, vcc
    v_cmp_eq_u32 vcc, 0xffff, v73
    s_nop 1
    v_addc_co_u32 v29, vcc, 0, v29, vcc
    v_cmp_eq_u32 vcc, 0xffff, v74
    s_nop 1
    v_addc_co_u32 v29, vcc, 0, v29, vcc
    v_cmp_eq_u32 vcc, 0xffff, v75
    s_nop 1
    v_addc_co_u32 v29, vcc, 0, v29, vcc
    v_cmp_eq_u32 vcc, 0xffff, v76
    s_nop 1
    v_addc_co_u32 v29, vcc, 0, v29, vcc
    v_cmp_eq_u32 vcc, 0xffff, v77
    s_nop 1
    v_addc_co_u32 v29, vcc, 0, v29, vcc
    v_cmp_ne_u32 vcc, 0, v29
    s_nop 1
    s_cbranch_vccnz chb_kernel_p3
    v_mul_u32_u24 v8, 1792, v6
    v_mul_u32_u24 v9, 14, v5
    v_add_u32 v8, v8, v9
    ds_write_b16 v8, v64 offset:0
    ds_write_b16 v8, v65 offset:2
    ds_write_b16 v8, v66 offset:4
    ds_write_b16 v8, v67 offset:6
    ds_write_b16 v8, v68 offset:8
    ds_write_b16 v8, v69 offset:10
    ds_write_b16 v8, v70 offset:12
    ds_write_b16 v8, v71 offset:896
    ds_write_b16 v8, v72 offset:898
    ds_write_b16 v8, v73 offset:900
    ds_write_b16 v8, v74 offset:902
    ds_write_b16 v8, v75 offset:904
    ds_write_b16 v8, v76 offset:906
    ds_write_b16 v8, v77 offset:908
    s_waitcnt lgkmcnt(0)
    s_barrier
    s_add_u32 s20, s20, 1
    s_cmp_lt_u32 s20, 64
    s_cbranch_scc1 chb_kernel_step
chb_kernel_end:
    s_endpgm
.globl att_kernel
.p2align 8
.type att_kernel,@function
att_kernel:
    s_cmp_ge_u32 s2, 256
    s_cbranch_scc1 att_kernel_end
    s_load_dwordx2 s[8:9], s[0:1], 120
    s_waitcnt lgkmcnt(0)
    s_mov_b32 s10, 111149056
    s_mov_b32 s11, 0x00020000
    v_lshrrev_b32 v1, 6, v0
    s_nop 0
    v_readfirstlane_b32 s3, v1
    s_lshl_b32 s4, s2, 2
    s_add_u32 s3, s3, s4
    s_lshr_b32 s5, s3, 4
    s_and_b32 s6, s3, 15
    v_and_b32 v63, 63, v0
    v_and_b32 v1, 15, v0
    v_bfe_u32 v2, v0, 4, 2
    s_lshl_b32 s7, s6, 9
    s_lshl_b32 s16, s5, 5
    v_add_u32 v3, s16, v1
    v_mul_u32_u24 v3, 24576, v3
    v_lshl_add_u32 v3, v2, 4, v3
    v_add_u32 v3, s7, v3
    v_add_u32 v3, 20185088, v3
    v_add_u32 v4, s16, v1
    v_subrev_u32 v4, 8, v4
    v_mul_u32_u24 v4, 24576, v4
    v_add_u32 v4, 20193280, v4
    v_add_u32 v6, 0x60000, v4
    v_min_u32 v8, 7, v1
    v_add_u32 v7, s16, v8
    v_add_u32 v7, 24, v7
    v_mul_u32_u24 v7, 24576, v7
    v_add_u32 v7, 20193280, v7
    s_lshl_b32 s17, s5, 17
    v_lshl_add_u32 v5, v1, 14, s17
    v_add_u32 v5, 70516736, v5
    v_cmp_gt_u32 vcc, 8, v1
    s_nop 1
    v_cndmask_b32 v4, v4, v5, vcc
    v_lshl_add_u32 v4, v2, 4, v4
    v_add_u32 v4, s7, v4
    v_lshl_add_u32 v6, v2, 4, v6
    v_add_u32 v6, s7, v6
    v_lshl_add_u32 v7, v2, 4, v7
    v_add_u32 v7, s7, v7
    v_mov_b32 v32, 0
    v_mov_b32 v33, 0
    v_mov_b32 v34, 0
    v_mov_b32 v35, 0
    v_mov_b32 v36, 0
    v_mov_b32 v37, 0
    v_mov_b32 v38, 0
    v_mov_b32 v39, 0
    v_mov_b32 v40, 0
    v_mov_b32 v41, 0
    v_mov_b32 v42, 0
    v_mov_b32 v43, 0
    v_mov_b32 v44, 0
    v_mov_b32 v45, 0
    v_mov_b32 v46, 0
    v_mov_b32 v47, 0
    v_mov_b32 v48, 0
    v_mov_b32 v49, 0
    v_mov_b32 v50, 0
    v_mov_b32 v51, 0
    v_mov_b32 v52, 0
    v_mov_b32 v53, 0
    v_mov_b32 v54, 0
    v_mov_b32 v55, 0
    buffer_load_dwordx4 v[10:13], v4, s[8:11], 0 offen offset:0
    buffer_load_dwordx4 v[14:17], v6, s[8:11], 0 offen offset:0
    buffer_load_dwordx4 v[18:21], v7, s[8:11], 0 offen offset:0
    buffer_load_dwordx4 v[24:27], v3, s[8:11], 0 offen offset:0
    v_add_u32 v9, 0x60000, v3
    buffer_load_dwordx4 v[28:31], v9, s[8:11], 0 offen offset:0
    s_waitcnt vmcnt(0)
    v_mfma_f32_16x16x32_bf16 v[32:35], v[10:13], v[24:27], v[32:35]
    v_mfma_f32_16x16x32_bf16 v[36:39], v[10:13], v[28:31], v[36:39]
    v_mfma_f32_16x16x32_bf16 v[40:43], v[14:17], v[24:27], v[40:43]
    v_mfma_f32_16x16x32_bf16 v[44:47], v[14:17], v[28:31], v[44:47]
    v_mfma_f32_16x16x32_bf16 v[48:51], v[18:21], v[24:27], v[48:51]
    v_mfma_f32_16x16x32_bf16 v[52:55], v[18:21], v[28:31], v[52:55]
    buffer_load_dwordx4 v[10:13], v4, s[8:11], 0 offen offset:64
    buffer_load_dwordx4 v[14:17], v6, s[8:11], 0 offen offset:64
    buffer_load_dwordx4 v[18:21], v7, s[8:11], 0 offen offset:64
    buffer_load_dwordx4 v[24:27], v3, s[8:11], 0 offen offset:64
    v_add_u32 v9, 0x60000, v3
    buffer_load_dwordx4 v[28:31], v9, s[8:11], 0 offen offset:64
    s_waitcnt vmcnt(0)
    v_mfma_f32_16x16x32_bf16 v[32:35], v[10:13], v[24:27], v[32:35]
    v_mfma_f32_16x16x32_bf16 v[36:39], v[10:13], v[28:31], v[36:39]
    v_mfma_f32_16x16x32_bf16 v[40:43], v[14:17], v[24:27], v[40:43]
    v_mfma_f32_16x16x32_bf16 v[44:47], v[14:17], v[28:31], v[44:47]
    v_mfma_f32_16x16x32_bf16 v[48:51], v[18:21], v[24:27], v[48:51]
    v_mfma_f32_16x16x32_bf16 v[52:55], v[18:21], v[28:31], v[52:55]
    buffer_load_dwordx4 v[10:13], v4, s[8:11], 0 offen offset:128
    buffer_load_dwordx4 v[14:17], v6, s[8:11], 0 offen offset:128
    buffer_load_dwordx4 v[18:21], v7, s[8:11], 0 offen offset:128
    buffer_load_dwordx4 v[24:27], v3, s[8:11], 0 offen offset:128
    v_add_u32 v9, 0x60000, v3
    buffer_load_dwordx4 v[28:31], v9, s[8:11], 0 offen offset:128
    s_waitcnt vmcnt(0)
    v_mfma_f32_16x16x32_bf16 v[32:35], v[10:13], v[24:27], v[32:35]
    v_mfma_f32_16x16x32_bf16 v[36:39], v[10:13], v[28:31], v[36:39]
    v_mfma_f32_16x16x32_bf16 v[40:43], v[14:17], v[24:27], v[40:43]
    v_mfma_f32_16x16x32_bf16 v[44:47], v[14:17], v[28:31], v[44:47]
    v_mfma_f32_16x16x32_bf16 v[48:51], v[18:21], v[24:27], v[48:51]
    v_mfma_f32_16x16x32_bf16 v[52:55], v[18:21], v[28:31], v[52:55]
    buffer_load_dwordx4 v[10:13], v4, s[8:11], 0 offen offset:192
    buffer_load_dwordx4 v[14:17], v6, s[8:11], 0 offen offset:192
    buffer_load_dwordx4 v[18:21], v7, s[8:11], 0 offen offset:192
    buffer_load_dwordx4 v[24:27], v3, s[8:11], 0 offen offset:192
    v_add_u32 v9, 0x60000, v3
    buffer_load_dwordx4 v[28:31], v9, s[8:11], 0 offen offset:192
    s_waitcnt vmcnt(0)
    v_mfma_f32_16x16x32_bf16 v[32:35], v[10:13], v[24:27], v[32:35]
    v_mfma_f32_16x16x32_bf16 v[36:39], v[10:13], v[28:31], v[36:39]
    v_mfma_f32_16x16x32_bf16 v[40:43], v[14:17], v[24:27], v[40:43]
    v_mfma_f32_16x16x32_bf16 v[44:47], v[14:17], v[28:31], v[44:47]
    v_mfma_f32_16x16x32_bf16 v[48:51], v[18:21], v[24:27], v[48:51]
    v_mfma_f32_16x16x32_bf16 v[52:55], v[18:21], v[28:31], v[52:55]
    buffer_load_dwordx4 v[10:13], v4, s[8:11], 0 offen offset:256
    buffer_load_dwordx4 v[14:17], v6, s[8:11], 0 offen offset:256
    buffer_load_dwordx4 v[18:21], v7, s[8:11], 0 offen offset:256
    buffer_load_dwordx4 v[24:27], v3, s[8:11], 0 offen offset:256
    v_add_u32 v9, 0x60000, v3
    buffer_load_dwordx4 v[28:31], v9, s[8:11], 0 offen offset:256
    s_waitcnt vmcnt(0)
    v_mfma_f32_16x16x32_bf16 v[32:35], v[10:13], v[24:27], v[32:35]
    v_mfma_f32_16x16x32_bf16 v[36:39], v[10:13], v[28:31], v[36:39]
    v_mfma_f32_16x16x32_bf16 v[40:43], v[14:17], v[24:27], v[40:43]
    v_mfma_f32_16x16x32_bf16 v[44:47], v[14:17], v[28:31], v[44:47]
    v_mfma_f32_16x16x32_bf16 v[48:51], v[18:21], v[24:27], v[48:51]
    v_mfma_f32_16x16x32_bf16 v[52:55], v[18:21], v[28:31], v[52:55]
    buffer_load_dwordx4 v[10:13], v4, s[8:11], 0 offen offset:320
    buffer_load_dwordx4 v[14:17], v6, s[8:11], 0 offen offset:320
    buffer_load_dwordx4 v[18:21], v7, s[8:11], 0 offen offset:320
    buffer_load_dwordx4 v[24:27], v3, s[8:11], 0 offen offset:320
    v_add_u32 v9, 0x60000, v3
    buffer_load_dwordx4 v[28:31], v9, s[8:11], 0 offen offset:320
    s_waitcnt vmcnt(0)
    v_mfma_f32_16x16x32_bf16 v[32:35], v[10:13], v[24:27], v[32:35]
    v_mfma_f32_16x16x32_bf16 v[36:39], v[10:13], v[28:31], v[36:39]
    v_mfma_f32_16x16x32_bf16 v[40:43], v[14:17], v[24:27], v[40:43]
    v_mfma_f32_16x16x32_bf16 v[44:47], v[14:17], v[28:31], v[44:47]
    v_mfma_f32_16x16x32_bf16 v[48:51], v[18:21], v[24:27], v[48:51]
    v_mfma_f32_16x16x32_bf16 v[52:55], v[18:21], v[28:31], v[52:55]
    buffer_load_dwordx4 v[10:13], v4, s[8:11], 0 offen offset:384
    buffer_load_dwordx4 v[14:17], v6, s[8:11], 0 offen offset:384
    buffer_load_dwordx4 v[18:21], v7, s[8:11], 0 offen offset:384
    buffer_load_dwordx4 v[24:27], v3, s[8:11], 0 offen offset:384
    v_add_u32 v9, 0x60000, v3
    buffer_load_dwordx4 v[28:31], v9, s[8:11], 0 offen offset:384
    s_waitcnt vmcnt(0)
    v_mfma_f32_16x16x32_bf16 v[32:35], v[10:13], v[24:27], v[32:35]
    v_mfma_f32_16x16x32_bf16 v[36:39], v[10:13], v[28:31], v[36:39]
    v_mfma_f32_16x16x32_bf16 v[40:43], v[14:17], v[24:27], v[40:43]
    v_mfma_f32_16x16x32_bf16 v[44:47], v[14:17], v[28:31], v[44:47]
    v_mfma_f32_16x16x32_bf16 v[48:51], v[18:21], v[24:27], v[48:51]
    v_mfma_f32_16x16x32_bf16 v[52:55], v[18:21], v[28:31], v[52:55]
    buffer_load_dwordx4 v[10:13], v4, s[8:11], 0 offen offset:448
    buffer_load_dwordx4 v[14:17], v6, s[8:11], 0 offen offset:448
    buffer_load_dwordx4 v[18:21], v7, s[8:11], 0 offen offset:448
    buffer_load_dwordx4 v[24:27], v3, s[8:11], 0 offen offset:448
    v_add_u32 v9, 0x60000, v3
    buffer_load_dwordx4 v[28:31], v9, s[8:11], 0 offen offset:448
    s_waitcnt vmcnt(0)
    v_mfma_f32_16x16x32_bf16 v[32:35], v[10:13], v[24:27], v[32:35]
    v_mfma_f32_16x16x32_bf16 v[36:39], v[10:13], v[28:31], v[36:39]
    v_mfma_f32_16x16x32_bf16 v[40:43], v[14:17], v[24:27], v[40:43]
    v_mfma_f32_16x16x32_bf16 v[44:47], v[14:17], v[28:31], v[44:47]
    v_mfma_f32_16x16x32_bf16 v[48:51], v[18:21], v[24:27], v[48:51]
    v_mfma_f32_16x16x32_bf16 v[52:55], v[18:21], v[28:31], v[52:55]
    s_nop 7
    s_nop 7
    v_xor_b32 v60, 16, v63
    v_lshlrev_b32 v60, 2, v60
    v_xor_b32 v61, 32, v63
    v_lshlrev_b32 v61, 2, v61
    v_lshlrev_b32 v62, 2, v2
    v_cvt_pk_bf16_f32 v32, v32, v32
    v_lshlrev_b32 v32, 16, v32
    v_mul_f32 v32, 0x3d800000, v32
    v_add_u32 v9, 56, v62
    v_add_u32 v243, 64, v1
    v_cmp_le_u32 vcc, v9, v243
    s_nop 1
    v_mov_b32 v242, 0xce6e6b28
    v_cndmask_b32 v32, v242, v32, vcc
    v_cvt_pk_bf16_f32 v33, v33, v33
    v_lshlrev_b32 v33, 16, v33
    v_mul_f32 v33, 0x3d800000, v33
    v_add_u32 v9, 57, v62
    v_add_u32 v243, 64, v1
    v_cmp_le_u32 vcc, v9, v243
    s_nop 1
    v_mov_b32 v242, 0xce6e6b28
    v_cndmask_b32 v33, v242, v33, vcc
    v_cvt_pk_bf16_f32 v34, v34, v34
    v_lshlrev_b32 v34, 16, v34
    v_mul_f32 v34, 0x3d800000, v34
    v_add_u32 v9, 58, v62
    v_add_u32 v243, 64, v1
    v_cmp_le_u32 vcc, v9, v243
    s_nop 1
    v_mov_b32 v242, 0xce6e6b28
    v_cndmask_b32 v34, v242, v34, vcc
    v_cvt_pk_bf16_f32 v35, v35, v35
    v_lshlrev_b32 v35, 16, v35
    v_mul_f32 v35, 0x3d800000, v35
    v_add_u32 v9, 59, v62
    v_add_u32 v243, 64, v1
    v_cmp_le_u32 vcc, v9, v243
    s_nop 1
    v_mov_b32 v242, 0xce6e6b28
    v_cndmask_b32 v35, v242, v35, vcc
    v_cvt_pk_bf16_f32 v40, v40, v40
    v_lshlrev_b32 v40, 16, v40
    v_mul_f32 v40, 0x3d800000, v40
    v_add_u32 v9, 72, v62
    v_add_u32 v243, 64, v1
    v_cmp_le_u32 vcc, v9, v243
    s_nop 1
    v_mov_b32 v242, 0xce6e6b28
    v_cndmask_b32 v40, v242, v40, vcc
    v_cvt_pk_bf16_f32 v41, v41, v41
    v_lshlrev_b32 v41, 16, v41
    v_mul_f32 v41, 0x3d800000, v41
    v_add_u32 v9, 73, v62
    v_add_u32 v243, 64, v1
    v_cmp_le_u32 vcc, v9, v243
    s_nop 1
    v_mov_b32 v242, 0xce6e6b28
    v_cndmask_b32 v41, v242, v41, vcc
    v_cvt_pk_bf16_f32 v42, v42, v42
    v_lshlrev_b32 v42, 16, v42
    v_mul_f32 v42, 0x3d800000, v42
    v_add_u32 v9, 74, v62
    v_add_u32 v243, 64, v1
    v_cmp_le_u32 vcc, v9, v243
    s_nop 1
    v_mov_b32 v242, 0xce6e6b28
    v_cndmask_b32 v42, v242, v42, vcc
    v_cvt_pk_bf16_f32 v43, v43, v43
    v_lshlrev_b32 v43, 16, v43
    v_mul_f32 v43, 0x3d800000, v43
    v_add_u32 v9, 75, v62
    v_add_u32 v243, 64, v1
    v_cmp_le_u32 vcc, v9, v243
    s_nop 1
    v_mov_b32 v242, 0xce6e6b28
    v_cndmask_b32 v43, v242, v43, vcc
    v_cvt_pk_bf16_f32 v48, v48, v48
    v_lshlrev_b32 v48, 16, v48
    v_mul_f32 v48, 0x3d800000, v48
    v_add_u32 v9, 88, v62
    v_add_u32 v243, 64, v1
    v_cmp_le_u32 vcc, v9, v243
    s_nop 1
    v_mov_b32 v242, 0xce6e6b28
    v_cndmask_b32 v48, v242, v48, vcc
    v_cvt_pk_bf16_f32 v49, v49, v49
    v_lshlrev_b32 v49, 16, v49
    v_mul_f32 v49, 0x3d800000, v49
    v_add_u32 v9, 89, v62
    v_add_u32 v243, 64, v1
    v_cmp_le_u32 vcc, v9, v243
    s_nop 1
    v_mov_b32 v242, 0xce6e6b28
    v_cndmask_b32 v49, v242, v49, vcc
    v_cvt_pk_bf16_f32 v50, v50, v50
    v_lshlrev_b32 v50, 16, v50
    v_mul_f32 v50, 0x3d800000, v50
    v_add_u32 v9, 90, v62
    v_add_u32 v243, 64, v1
    v_cmp_le_u32 vcc, v9, v243
    s_nop 1
    v_mov_b32 v242, 0xce6e6b28
    v_cndmask_b32 v50, v242, v50, vcc
    v_cvt_pk_bf16_f32 v51, v51, v51
    v_lshlrev_b32 v51, 16, v51
    v_mul_f32 v51, 0x3d800000, v51
    v_add_u32 v9, 91, v62
    v_add_u32 v243, 64, v1
    v_cmp_le_u32 vcc, v9, v243
    s_nop 1
    v_mov_b32 v242, 0xce6e6b28
    v_cndmask_b32 v51, v242, v51, vcc
    v_mov_b32 v241, v32
    v_max_f32 v241, v241, v33
    v_max_f32 v241, v241, v34
    v_max_f32 v241, v241, v35
    v_max_f32 v241, v241, v40
    v_max_f32 v241, v241, v41
    v_max_f32 v241, v241, v42
    v_max_f32 v241, v241, v43
    v_max_f32 v241, v241, v48
    v_max_f32 v241, v241, v49
    v_max_f32 v241, v241, v50
    v_max_f32 v241, v241, v51
    ds_bpermute_b32 v9, v60, v241
    s_waitcnt lgkmcnt(0)
    v_max_f32 v241, v241, v9
    ds_bpermute_b32 v9, v61, v241
    s_waitcnt lgkmcnt(0)
    v_max_f32 v241, v241, v9
    v_mov_b32 v240, 0
    v_sub_f32 v32, v32, v241
    v_mul_f32 v32, 0x3fb8aa3b, v32
    v_exp_f32 v32, v32
    s_nop 0
    v_add_f32 v240, v240, v32
    v_sub_f32 v33, v33, v241
    v_mul_f32 v33, 0x3fb8aa3b, v33
    v_exp_f32 v33, v33
    s_nop 0
    v_add_f32 v240, v240, v33
    v_sub_f32 v34, v34, v241
    v_mul_f32 v34, 0x3fb8aa3b, v34
    v_exp_f32 v34, v34
    s_nop 0
    v_add_f32 v240, v240, v34
    v_sub_f32 v35, v35, v241
    v_mul_f32 v35, 0x3fb8aa3b, v35
    v_exp_f32 v35, v35
    s_nop 0
    v_add_f32 v240, v240, v35
    v_sub_f32 v40, v40, v241
    v_mul_f32 v40, 0x3fb8aa3b, v40
    v_exp_f32 v40, v40
    s_nop 0
    v_add_f32 v240, v240, v40
    v_sub_f32 v41, v41, v241
    v_mul_f32 v41, 0x3fb8aa3b, v41
    v_exp_f32 v41, v41
    s_nop 0
    v_add_f32 v240, v240, v41
    v_sub_f32 v42, v42, v241
    v_mul_f32 v42, 0x3fb8aa3b, v42
    v_exp_f32 v42, v42
    s_nop 0
    v_add_f32 v240, v240, v42
    v_sub_f32 v43, v43, v241
    v_mul_f32 v43, 0x3fb8aa3b, v43
    v_exp_f32 v43, v43
    s_nop 0
    v_add_f32 v240, v240, v43
    v_sub_f32 v48, v48, v241
    v_mul_f32 v48, 0x3fb8aa3b, v48
    v_exp_f32 v48, v48
    s_nop 0
    v_add_f32 v240, v240, v48
    v_sub_f32 v49, v49, v241
    v_mul_f32 v49, 0x3fb8aa3b, v49
    v_exp_f32 v49, v49
    s_nop 0
    v_add_f32 v240, v240, v49
    v_sub_f32 v50, v50, v241
    v_mul_f32 v50, 0x3fb8aa3b, v50
    v_exp_f32 v50, v50
    s_nop 0
    v_add_f32 v240, v240, v50
    v_sub_f32 v51, v51, v241
    v_mul_f32 v51, 0x3fb8aa3b, v51
    v_exp_f32 v51, v51
    s_nop 0
    v_add_f32 v240, v240, v51
    ds_bpermute_b32 v9, v60, v240
    s_waitcnt lgkmcnt(0)
    v_add_f32 v240, v240, v9
    ds_bpermute_b32 v9, v61, v240
    s_waitcnt lgkmcnt(0)
    v_add_f32 v240, v240, v9
    v_rcp_f32 v240, v240
    s_nop 0
    v_mul_f32 v32, v32, v240
    v_cvt_pk_bf16_f32 v32, v32, v32
    v_lshlrev_b32 v32, 16, v32
    v_mul_f32 v33, v33, v240
    v_cvt_pk_bf16_f32 v33, v33, v33
    v_lshlrev_b32 v33, 16, v33
    v_mul_f32 v34, v34, v240
    v_cvt_pk_bf16_f32 v34, v34, v34
    v_lshlrev_b32 v34, 16, v34
    v_mul_f32 v35, v35, v240
    v_cvt_pk_bf16_f32 v35, v35, v35
    v_lshlrev_b32 v35, 16, v35
    v_mul_f32 v40, v40, v240
    v_cvt_pk_bf16_f32 v40, v40, v40
    v_lshlrev_b32 v40, 16, v40
    v_mul_f32 v41, v41, v240
    v_cvt_pk_bf16_f32 v41, v41, v41
    v_lshlrev_b32 v41, 16, v41
    v_mul_f32 v42, v42, v240
    v_cvt_pk_bf16_f32 v42, v42, v42
    v_lshlrev_b32 v42, 16, v42
    v_mul_f32 v43, v43, v240
    v_cvt_pk_bf16_f32 v43, v43, v43
    v_lshlrev_b32 v43, 16, v43
    v_mul_f32 v48, v48, v240
    v_cvt_pk_bf16_f32 v48, v48, v48
    v_lshlrev_b32 v48, 16, v48
    v_mul_f32 v49, v49, v240
    v_cvt_pk_bf16_f32 v49, v49, v49
    v_lshlrev_b32 v49, 16, v49
    v_mul_f32 v50, v50, v240
    v_cvt_pk_bf16_f32 v50, v50, v50
    v_lshlrev_b32 v50, 16, v50
    v_mul_f32 v51, v51, v240
    v_cvt_pk_bf16_f32 v51, v51, v51
    v_lshlrev_b32 v51, 16, v51
    v_cvt_pk_bf16_f32 v36, v36, v36
    v_lshlrev_b32 v36, 16, v36
    v_mul_f32 v36, 0x3d800000, v36
    v_add_u32 v9, 40, v62
    v_add_u32 v243, 64, v1
    v_cmp_le_u32 vcc, v9, v243
    s_nop 1
    v_mov_b32 v242, 0xce6e6b28
    v_cndmask_b32 v36, v242, v36, vcc
    v_cvt_pk_bf16_f32 v37, v37, v37
    v_lshlrev_b32 v37, 16, v37
    v_mul_f32 v37, 0x3d800000, v37
    v_add_u32 v9, 41, v62
    v_add_u32 v243, 64, v1
    v_cmp_le_u32 vcc, v9, v243
    s_nop 1
    v_mov_b32 v242, 0xce6e6b28
    v_cndmask_b32 v37, v242, v37, vcc
    v_cvt_pk_bf16_f32 v38, v38, v38
    v_lshlrev_b32 v38, 16, v38
    v_mul_f32 v38, 0x3d800000, v38
    v_add_u32 v9, 42, v62
    v_add_u32 v243, 64, v1
    v_cmp_le_u32 vcc, v9, v243
    s_nop 1
    v_mov_b32 v242, 0xce6e6b28
    v_cndmask_b32 v38, v242, v38, vcc
    v_cvt_pk_bf16_f32 v39, v39, v39
    v_lshlrev_b32 v39, 16, v39
    v_mul_f32 v39, 0x3d800000, v39
    v_add_u32 v9, 43, v62
    v_add_u32 v243, 64, v1
    v_cmp_le_u32 vcc, v9, v243
    s_nop 1
    v_mov_b32 v242, 0xce6e6b28
    v_cndmask_b32 v39, v242, v39, vcc
    v_cvt_pk_bf16_f32 v44, v44, v44
    v_lshlrev_b32 v44, 16, v44
    v_mul_f32 v44, 0x3d800000, v44
    v_add_u32 v9, 56, v62
    v_add_u32 v243, 64, v1
    v_cmp_le_u32 vcc, v9, v243
    s_nop 1
    v_mov_b32 v242, 0xce6e6b28
    v_cndmask_b32 v44, v242, v44, vcc
    v_cvt_pk_bf16_f32 v45, v45, v45
    v_lshlrev_b32 v45, 16, v45
    v_mul_f32 v45, 0x3d800000, v45
    v_add_u32 v9, 57, v62
    v_add_u32 v243, 64, v1
    v_cmp_le_u32 vcc, v9, v243
    s_nop 1
    v_mov_b32 v242, 0xce6e6b28
    v_cndmask_b32 v45, v242, v45, vcc
    v_cvt_pk_bf16_f32 v46, v46, v46
    v_lshlrev_b32 v46, 16, v46
    v_mul_f32 v46, 0x3d800000, v46
    v_add_u32 v9, 58, v62
    v_add_u32 v243, 64, v1
    v_cmp_le_u32 vcc, v9, v243
    s_nop 1
    v_mov_b32 v242, 0xce6e6b28
    v_cndmask_b32 v46, v242, v46, vcc
    v_cvt_pk_bf16_f32 v47, v47, v47
    v_lshlrev_b32 v47, 16, v47
    v_mul_f32 v47, 0x3d800000, v47
    v_add_u32 v9, 59, v62
    v_add_u32 v243, 64, v1
    v_cmp_le_u32 vcc, v9, v243
    s_nop 1
    v_mov_b32 v242, 0xce6e6b28
    v_cndmask_b32 v47, v242, v47, vcc
    v_cvt_pk_bf16_f32 v52, v52, v52
    v_lshlrev_b32 v52, 16, v52
    v_mul_f32 v52, 0x3d800000, v52
    v_add_u32 v9, 72, v62
    v_add_u32 v243, 64, v1
    v_cmp_le_u32 vcc, v9, v243
    s_nop 1
    v_mov_b32 v242, 0xce6e6b28
    v_cndmask_b32 v52, v242, v52, vcc
    v_cvt_pk_bf16_f32 v53, v53, v53
    v_lshlrev_b32 v53, 16, v53
    v_mul_f32 v53, 0x3d800000, v53
    v_add_u32 v9, 73, v62
    v_add_u32 v243, 64, v1
    v_cmp_le_u32 vcc, v9, v243
    s_nop 1
    v_mov_b32 v242, 0xce6e6b28
    v_cndmask_b32 v53, v242, v53, vcc
    v_cvt_pk_bf16_f32 v54, v54, v54
    v_lshlrev_b32 v54, 16, v54
    v_mul_f32 v54, 0x3d800000, v54
    v_add_u32 v9, 74, v62
    v_add_u32 v243, 64, v1
    v_cmp_le_u32 vcc, v9, v243
    s_nop 1
    v_mov_b32 v242, 0xce6e6b28
    v_cndmask_b32 v54, v242, v54, vcc
    v_cvt_pk_bf16_f32 v55, v55, v55
    v_lshlrev_b32 v55, 16, v55
    v_mul_f32 v55, 0x3d800000, v55
    v_add_u32 v9, 75, v62
    v_add_u32 v243, 64, v1
    v_cmp_le_u32 vcc, v9, v243
    s_nop 1
    v_mov_b32 v242, 0xce6e6b28
    v_cndmask_b32 v55, v242, v55, vcc
    v_mov_b32 v241, v36
    v_max_f32 v241, v241, v37
    v_max_f32 v241, v241, v38
    v_max_f32 v241, v241, v39
    v_max_f32 v241, v241, v44
    v_max_f32 v241, v241, v45
    v_max_f32 v241, v241, v46
    v_max_f32 v241, v241, v47
    v_max_f32 v241, v241, v52
    v_max_f32 v241, v241, v53
    v_max_f32 v241, v241, v54
    v_max_f32 v241, v241, v55
    ds_bpermute_b32 v9, v60, v241
    s_waitcnt lgkmcnt(0)
    v_max_f32 v241, v241, v9
    ds_bpermute_b32 v9, v61, v241
    s_waitcnt lgkmcnt(0)
    v_max_f32 v241, v241, v9
    v_mov_b32 v240, 0
    v_sub_f32 v36, v36, v241
    v_mul_f32 v36, 0x3fb8aa3b, v36
    v_exp_f32 v36, v36
    s_nop 0
    v_add_f32 v240, v240, v36
    v_sub_f32 v37, v37, v241
    v_mul_f32 v37, 0x3fb8aa3b, v37
    v_exp_f32 v37, v37
    s_nop 0
    v_add_f32 v240, v240, v37
    v_sub_f32 v38, v38, v241
    v_mul_f32 v38, 0x3fb8aa3b, v38
    v_exp_f32 v38, v38
    s_nop 0
    v_add_f32 v240, v240, v38
    v_sub_f32 v39, v39, v241
    v_mul_f32 v39, 0x3fb8aa3b, v39
    v_exp_f32 v39, v39
    s_nop 0
    v_add_f32 v240, v240, v39
    v_sub_f32 v44, v44, v241
    v_mul_f32 v44, 0x3fb8aa3b, v44
    v_exp_f32 v44, v44
    s_nop 0
    v_add_f32 v240, v240, v44
    v_sub_f32 v45, v45, v241
    v_mul_f32 v45, 0x3fb8aa3b, v45
    v_exp_f32 v45, v45
    s_nop 0
    v_add_f32 v240, v240, v45
    v_sub_f32 v46, v46, v241
    v_mul_f32 v46, 0x3fb8aa3b, v46
    v_exp_f32 v46, v46
    s_nop 0
    v_add_f32 v240, v240, v46
    v_sub_f32 v47, v47, v241
    v_mul_f32 v47, 0x3fb8aa3b, v47
    v_exp_f32 v47, v47
    s_nop 0
    v_add_f32 v240, v240, v47
    v_sub_f32 v52, v52, v241
    v_mul_f32 v52, 0x3fb8aa3b, v52
    v_exp_f32 v52, v52
    s_nop 0
    v_add_f32 v240, v240, v52
    v_sub_f32 v53, v53, v241
    v_mul_f32 v53, 0x3fb8aa3b, v53
    v_exp_f32 v53, v53
    s_nop 0
    v_add_f32 v240, v240, v53
    v_sub_f32 v54, v54, v241
    v_mul_f32 v54, 0x3fb8aa3b, v54
    v_exp_f32 v54, v54
    s_nop 0
    v_add_f32 v240, v240, v54
    v_sub_f32 v55, v55, v241
    v_mul_f32 v55, 0x3fb8aa3b, v55
    v_exp_f32 v55, v55
    s_nop 0
    v_add_f32 v240, v240, v55
    ds_bpermute_b32 v9, v60, v240
    s_waitcnt lgkmcnt(0)
    v_add_f32 v240, v240, v9
    ds_bpermute_b32 v9, v61, v240
    s_waitcnt lgkmcnt(0)
    v_add_f32 v240, v240, v9
    v_rcp_f32 v240, v240
    s_nop 0
    v_mul_f32 v36, v36, v240
    v_cvt_pk_bf16_f32 v36, v36, v36
    v_lshlrev_b32 v36, 16, v36
    v_mul_f32 v37, v37, v240
    v_cvt_pk_bf16_f32 v37, v37, v37
    v_lshlrev_b32 v37, 16, v37
    v_mul_f32 v38, v38, v240
    v_cvt_pk_bf16_f32 v38, v38, v38
    v_lshlrev_b32 v38, 16, v38
    v_mul_f32 v39, v39, v240
    v_cvt_pk_bf16_f32 v39, v39, v39
    v_lshlrev_b32 v39, 16, v39
    v_mul_f32 v44, v44, v240
    v_cvt_pk_bf16_f32 v44, v44, v44
    v_lshlrev_b32 v44, 16, v44
    v_mul_f32 v45, v45, v240
    v_cvt_pk_bf16_f32 v45, v45, v45
    v_lshlrev_b32 v45, 16, v45
    v_mul_f32 v46, v46, v240
    v_cvt_pk_bf16_f32 v46, v46, v46
    v_lshlrev_b32 v46, 16, v46
    v_mul_f32 v47, v47, v240
    v_cvt_pk_bf16_f32 v47, v47, v47
    v_lshlrev_b32 v47, 16, v47
    v_mul_f32 v52, v52, v240
    v_cvt_pk_bf16_f32 v52, v52, v52
    v_lshlrev_b32 v52, 16, v52
    v_mul_f32 v53, v53, v240
    v_cvt_pk_bf16_f32 v53, v53, v53
    v_lshlrev_b32 v53, 16, v53
    v_mul_f32 v54, v54, v240
    v_cvt_pk_bf16_f32 v54, v54, v54
    v_lshlrev_b32 v54, 16, v54
    v_mul_f32 v55, v55, v240
    v_cvt_pk_bf16_f32 v55, v55, v55
    v_lshlrev_b32 v55, 16, v55
    v_lshlrev_b32 v3, 3, v63
    v_add_u32 v3, s7, v3
    s_mul_i32 s18, s16, 24576
    s_add_u32 s18, s18, 20004864
    s_add_u32 s19, s17, 70524928
    v_add_u32 v4, s18, v3
    v_add_u32 v5, s19, v3
    v_add_u32 v9, 0, v5
    buffer_load_dwordx2 v[6:7], v9, s[8:11], 0 offen
    s_waitcnt vmcnt(0)
    v_lshlrev_b32 v64, 16, v6
    v_and_b32 v65, 0xffff0000, v6
    v_lshlrev_b32 v66, 16, v7
    v_and_b32 v67, 0xffff0000, v7
    v_add_u32 v9, 16384, v5
    buffer_load_dwordx2 v[6:7], v9, s[8:11], 0 offen
    s_waitcnt vmcnt(0)
    v_lshlrev_b32 v68, 16, v6
    v_and_b32 v69, 0xffff0000, v6
    v_lshlrev_b32 v70, 16, v7
    v_and_b32 v71, 0xffff0000, v7
    v_add_u32 v9, 32768, v5
    buffer_load_dwordx2 v[6:7], v9, s[8:11], 0 offen
    s_waitcnt vmcnt(0)
    v_lshlrev_b32 v72, 16, v6
    v_and_b32 v73, 0xffff0000, v6
    v_lshlrev_b32 v74, 16, v7
    v_and_b32 v75, 0xffff0000, v7
    v_add_u32 v9, 49152, v5
    buffer_load_dwordx2 v[6:7], v9, s[8:11], 0 offen
    s_waitcnt vmcnt(0)
    v_lshlrev_b32 v76, 16, v6
    v_and_b32 v77, 0xffff0000, v6
    v_lshlrev_b32 v78, 16, v7
    v_and_b32 v79, 0xffff0000, v7
    v_add_u32 v9, 65536, v5
    buffer_load_dwordx2 v[6:7], v9, s[8:11], 0 offen
    s_waitcnt vmcnt(0)
    v_lshlrev_b32 v80, 16, v6
    v_and_b32 v81, 0xffff0000, v6
    v_lshlrev_b32 v82, 16, v7
    v_and_b32 v83, 0xffff0000, v7
    v_add_u32 v9, 81920, v5
    buffer_load_dwordx2 v[6:7], v9, s[8:11], 0 offen
    s_waitcnt vmcnt(0)
    v_lshlrev_b32 v84, 16, v6
    v_and_b32 v85, 0xffff0000, v6
    v_lshlrev_b32 v86, 16, v7
    v_and_b32 v87, 0xffff0000, v7
    v_add_u32 v9, 98304, v5
    buffer_load_dwordx2 v[6:7], v9, s[8:11], 0 offen
    s_waitcnt vmcnt(0)
    v_lshlrev_b32 v88, 16, v6
    v_and_b32 v89, 0xffff0000, v6
    v_lshlrev_b32 v90, 16, v7
    v_and_b32 v91, 0xffff0000, v7
    v_add_u32 v9, 114688, v5
    buffer_load_dwordx2 v[6:7], v9, s[8:11], 0 offen
    s_waitcnt vmcnt(0)
    v_lshlrev_b32 v92, 16, v6
    v_and_b32 v93, 0xffff0000, v6
    v_lshlrev_b32 v94, 16, v7
    v_and_b32 v95, 0xffff0000, v7
    v_add_u32 v9, 196608, v4
    buffer_load_dwordx2 v[6:7], v9, s[8:11], 0 offen
    s_waitcnt vmcnt(0)
    v_lshlrev_b32 v96, 16, v6
    v_and_b32 v97, 0xffff0000, v6
    v_lshlrev_b32 v98, 16, v7
    v_and_b32 v99, 0xffff0000, v7
    v_add_u32 v9, 221184, v4
    buffer_load_dwordx2 v[6:7], v9, s[8:11], 0 offen
    s_waitcnt vmcnt(0)
    v_lshlrev_b32 v100, 16, v6
    v_and_b32 v101, 0xffff0000, v6
    v_lshlrev_b32 v102, 16, v7
    v_and_b32 v103, 0xffff0000, v7
    v_add_u32 v9, 245760, v4
    buffer_load_dwordx2 v[6:7], v9, s[8:11], 0 offen
    s_waitcnt vmcnt(0)
    v_lshlrev_b32 v104, 16, v6
    v_and_b32 v105, 0xffff0000, v6
    v_lshlrev_b32 v106, 16, v7
    v_and_b32 v107, 0xffff0000, v7
    v_add_u32 v9, 270336, v4
    buffer_load_dwordx2 v[6:7], v9, s[8:11], 0 offen
    s_waitcnt vmcnt(0)
    v_lshlrev_b32 v108, 16, v6
    v_and_b32 v109, 0xffff0000, v6
    v_lshlrev_b32 v110, 16, v7
    v_and_b32 v111, 0xffff0000, v7
    v_add_u32 v9, 294912, v4
    buffer_load_dwordx2 v[6:7], v9, s[8:11], 0 offen
    s_waitcnt vmcnt(0)
    v_lshlrev_b32 v112, 16, v6
    v_and_b32 v113, 0xffff0000, v6
    v_lshlrev_b32 v114, 16, v7
    v_and_b32 v115, 0xffff0000, v7
    v_add_u32 v9, 319488, v4
    buffer_load_dwordx2 v[6:7], v9, s[8:11], 0 offen
    s_waitcnt vmcnt(0)
    v_lshlrev_b32 v116, 16, v6
    v_and_b32 v117, 0xffff0000, v6
    v_lshlrev_b32 v118, 16, v7
    v_and_b32 v119, 0xffff0000, v7
    v_add_u32 v9, 344064, v4
    buffer_load_dwordx2 v[6:7], v9, s[8:11], 0 offen
    s_waitcnt vmcnt(0)
    v_lshlrev_b32 v120, 16, v6
    v_and_b32 v121, 0xffff0000, v6
    v_lshlrev_b32 v122, 16, v7
    v_and_b32 v123, 0xffff0000, v7
    v_add_u32 v9, 368640, v4
    buffer_load_dwordx2 v[6:7], v9, s[8:11], 0 offen
    s_waitcnt vmcnt(0)
    v_lshlrev_b32 v124, 16, v6
    v_and_b32 v125, 0xffff0000, v6
    v_lshlrev_b32 v126, 16, v7
    v_and_b32 v127, 0xffff0000, v7
    v_add_u32 v9, 393216, v4
    buffer_load_dwordx2 v[6:7], v9, s[8:11], 0 offen
    s_waitcnt vmcnt(0)
    v_lshlrev_b32 v128, 16, v6
    v_and_b32 v129, 0xffff0000, v6
    v_lshlrev_b32 v130, 16, v7
    v_and_b32 v131, 0xffff0000, v7
    v_add_u32 v9, 417792, v4
    buffer_load_dwordx2 v[6:7], v9, s[8:11], 0 offen
    s_waitcnt vmcnt(0)
    v_lshlrev_b32 v132, 16, v6
    v_and_b32 v133, 0xffff0000, v6
    v_lshlrev_b32 v134, 16, v7
    v_and_b32 v135, 0xffff0000, v7
    v_add_u32 v9, 442368, v4
    buffer_load_dwordx2 v[6:7], v9, s[8:11], 0 offen
    s_waitcnt vmcnt(0)
    v_lshlrev_b32 v136, 16, v6
    v_and_b32 v137, 0xffff0000, v6
    v_lshlrev_b32 v138, 16, v7
    v_and_b32 v139, 0xffff0000, v7
    v_add_u32 v9, 466944, v4
    buffer_load_dwordx2 v[6:7], v9, s[8:11], 0 offen
    s_waitcnt vmcnt(0)
    v_lshlrev_b32 v140, 16, v6
    v_and_b32 v141, 0xffff0000, v6
    v_lshlrev_b32 v142, 16, v7
    v_and_b32 v143, 0xffff0000, v7
    v_add_u32 v9, 491520, v4
    buffer_load_dwordx2 v[6:7], v9, s[8:11], 0 offen
    s_waitcnt vmcnt(0)
    v_lshlrev_b32 v144, 16, v6
    v_and_b32 v145, 0xffff0000, v6
    v_lshlrev_b32 v146, 16, v7
    v_and_b32 v147, 0xffff0000, v7
    v_add_u32 v9, 516096, v4
    buffer_load_dwordx2 v[6:7], v9, s[8:11], 0 offen
    s_waitcnt vmcnt(0)
    v_lshlrev_b32 v148, 16, v6
    v_and_b32 v149, 0xffff0000, v6
    v_lshlrev_b32 v150, 16, v7
    v_and_b32 v151, 0xffff0000, v7
    v_add_u32 v9, 540672, v4
    buffer_load_dwordx2 v[6:7], v9, s[8:11], 0 offen
    s_waitcnt vmcnt(0)
    v_lshlrev_b32 v152, 16, v6
    v_and_b32 v153, 0xffff0000, v6
    v_lshlrev_b32 v154, 16, v7
    v_and_b32 v155, 0xffff0000, v7
    v_add_u32 v9, 565248, v4
    buffer_load_dwordx2 v[6:7], v9, s[8:11], 0 offen
    s_waitcnt vmcnt(0)
    v_lshlrev_b32 v156, 16, v6
    v_and_b32 v157, 0xffff0000, v6
    v_lshlrev_b32 v158, 16, v7
    v_and_b32 v159, 0xffff0000, v7
    v_add_u32 v9, 589824, v4
    buffer_load_dwordx2 v[6:7], v9, s[8:11], 0 offen
    s_waitcnt vmcnt(0)
    v_lshlrev_b32 v160, 16, v6
    v_and_b32 v161, 0xffff0000, v6
    v_lshlrev_b32 v162, 16, v7
    v_and_b32 v163, 0xffff0000, v7
    v_add_u32 v9, 614400, v4
    buffer_load_dwordx2 v[6:7], v9, s[8:11], 0 offen
    s_waitcnt vmcnt(0)
    v_lshlrev_b32 v164, 16, v6
    v_and_b32 v165, 0xffff0000, v6
    v_lshlrev_b32 v166, 16, v7
    v_and_b32 v167, 0xffff0000, v7
    v_add_u32 v9, 638976, v4
    buffer_load_dwordx2 v[6:7], v9, s[8:11], 0 offen
    s_waitcnt vmcnt(0)
    v_lshlrev_b32 v168, 16, v6
    v_and_b32 v169, 0xffff0000, v6
    v_lshlrev_b32 v170, 16, v7
    v_and_b32 v171, 0xffff0000, v7
    v_add_u32 v9, 663552, v4
    buffer_load_dwordx2 v[6:7], v9, s[8:11], 0 offen
    s_waitcnt vmcnt(0)
    v_lshlrev_b32 v172, 16, v6
    v_and_b32 v173, 0xffff0000, v6
    v_lshlrev_b32 v174, 16, v7
    v_and_b32 v175, 0xffff0000, v7
    v_add_u32 v9, 688128, v4
    buffer_load_dwordx2 v[6:7], v9, s[8:11], 0 offen
    s_waitcnt vmcnt(0)
    v_lshlrev_b32 v176, 16, v6
    v_and_b32 v177, 0xffff0000, v6
    v_lshlrev_b32 v178, 16, v7
    v_and_b32 v179, 0xffff0000, v7
    v_add_u32 v9, 712704, v4
    buffer_load_dwordx2 v[6:7], v9, s[8:11], 0 offen
    s_waitcnt vmcnt(0)
    v_lshlrev_b32 v180, 16, v6
    v_and_b32 v181, 0xffff0000, v6
    v_lshlrev_b32 v182, 16, v7
    v_and_b32 v183, 0xffff0000, v7
    v_add_u32 v9, 737280, v4
    buffer_load_dwordx2 v[6:7], v9, s[8:11], 0 offen
    s_waitcnt vmcnt(0)
    v_lshlrev_b32 v184, 16, v6
    v_and_b32 v185, 0xffff0000, v6
    v_lshlrev_b32 v186, 16, v7
    v_and_b32 v187, 0xffff0000, v7
    v_add_u32 v9, 761856, v4
    buffer_load_dwordx2 v[6:7], v9, s[8:11], 0 offen
    s_waitcnt vmcnt(0)
    v_lshlrev_b32 v188, 16, v6
    v_and_b32 v189, 0xffff0000, v6
    v_lshlrev_b32 v190, 16, v7
    v_and_b32 v191, 0xffff0000, v7
    v_add_u32 v9, 786432, v4
    buffer_load_dwordx2 v[6:7], v9, s[8:11], 0 offen
    s_waitcnt vmcnt(0)
    v_lshlrev_b32 v192, 16, v6
    v_and_b32 v193, 0xffff0000, v6
    v_lshlrev_b32 v194, 16, v7
    v_and_b32 v195, 0xffff0000, v7
    v_add_u32 v9, 811008, v4
    buffer_load_dwordx2 v[6:7], v9, s[8:11], 0 offen
    s_waitcnt vmcnt(0)
    v_lshlrev_b32 v196, 16, v6
    v_and_b32 v197, 0xffff0000, v6
    v_lshlrev_b32 v198, 16, v7
    v_and_b32 v199, 0xffff0000, v7
    v_add_u32 v9, 835584, v4
    buffer_load_dwordx2 v[6:7], v9, s[8:11], 0 offen
    s_waitcnt vmcnt(0)
    v_lshlrev_b32 v200, 16, v6
    v_and_b32 v201, 0xffff0000, v6
    v_lshlrev_b32 v202, 16, v7
    v_and_b32 v203, 0xffff0000, v7
    v_add_u32 v9, 860160, v4
    buffer_load_dwordx2 v[6:7], v9, s[8:11], 0 offen
    s_waitcnt vmcnt(0)
    v_lshlrev_b32 v204, 16, v6
    v_and_b32 v205, 0xffff0000, v6
    v_lshlrev_b32 v206, 16, v7
    v_and_b32 v207, 0xffff0000, v7
    v_add_u32 v9, 884736, v4
    buffer_load_dwordx2 v[6:7], v9, s[8:11], 0 offen
    s_waitcnt vmcnt(0)
    v_lshlrev_b32 v208, 16, v6
    v_and_b32 v209, 0xffff0000, v6
    v_lshlrev_b32 v210, 16, v7
    v_and_b32 v211, 0xffff0000, v7
    v_add_u32 v9, 909312, v4
    buffer_load_dwordx2 v[6:7], v9, s[8:11], 0 offen
    s_waitcnt vmcnt(0)
    v_lshlrev_b32 v212, 16, v6
    v_and_b32 v213, 0xffff0000, v6
    v_lshlrev_b32 v214, 16, v7
    v_and_b32 v215, 0xffff0000, v7
    v_add_u32 v9, 933888, v4
    buffer_load_dwordx2 v[6:7], v9, s[8:11], 0 offen
    s_waitcnt vmcnt(0)
    v_lshlrev_b32 v216, 16, v6
    v_and_b32 v217, 0xffff0000, v6
    v_lshlrev_b32 v218, 16, v7
    v_and_b32 v219, 0xffff0000, v7
    v_add_u32 v9, 958464, v4
    buffer_load_dwordx2 v[6:7], v9, s[8:11], 0 offen
    s_waitcnt vmcnt(0)
    v_lshlrev_b32 v220, 16, v6
    v_and_b32 v221, 0xffff0000, v6
    v_lshlrev_b32 v222, 16, v7
    v_and_b32 v223, 0xffff0000, v7
    s_mul_i32 s18, s16, 8192
    s_add_u32 s18, s18, 78905344
    v_add_u32 v3, s18, v3
    v_mov_b32 v224, 0
    v_mov_b32 v225, 0
    v_mov_b32 v226, 0
    v_mov_b32 v227, 0
    v_readlane_b32 s20, v32, 0
    s_nop 1
    v_fmac_f32 v224, s20, v64
    v_fmac_f32 v225, s20, v65
    v_fmac_f32 v226, s20, v66
    v_fmac_f32 v227, s20, v67
    v_readlane_b32 s20, v33, 0
    s_nop 1
    v_fmac_f32 v224, s20, v68
    v_fmac_f32 v225, s20, v69
    v_fmac_f32 v226, s20, v70
    v_fmac_f32 v227, s20, v71
    v_readlane_b32 s20, v34, 0
    s_nop 1
    v_fmac_f32 v224, s20, v72
    v_fmac_f32 v225, s20, v73
    v_fmac_f32 v226, s20, v74
    v_fmac_f32 v227, s20, v75
    v_readlane_b32 s20, v35, 0
    s_nop 1
    v_fmac_f32 v224, s20, v76
    v_fmac_f32 v225, s20, v77
    v_fmac_f32 v226, s20, v78
    v_fmac_f32 v227, s20, v79
    v_readlane_b32 s20, v32, 16
    s_nop 1
    v_fmac_f32 v224, s20, v80
    v_fmac_f32 v225, s20, v81
    v_fmac_f32 v226, s20, v82
    v_fmac_f32 v227, s20, v83
    v_readlane_b32 s20, v33, 16
    s_nop 1
    v_fmac_f32 v224, s20, v84
    v_fmac_f32 v225, s20, v85
    v_fmac_f32 v226, s20, v86
    v_fmac_f32 v227, s20, v87
    v_readlane_b32 s20, v34, 16
    s_nop 1
    v_fmac_f32 v224, s20, v88
    v_fmac_f32 v225, s20, v89
    v_fmac_f32 v226, s20, v90
    v_fmac_f32 v227, s20, v91
    v_readlane_b32 s20, v35, 16
    s_nop 1
    v_fmac_f32 v224, s20, v92
    v_fmac_f32 v225, s20, v93
    v_fmac_f32 v226, s20, v94
    v_fmac_f32 v227, s20, v95
    v_readlane_b32 s20, v32, 32
    s_nop 1
    v_fmac_f32 v224, s20, v96
    v_fmac_f32 v225, s20, v97
    v_fmac_f32 v226, s20, v98
    v_fmac_f32 v227, s20, v99
    v_cvt_pk_bf16_f32 v6, v224, v225
    v_cvt_pk_bf16_f32 v7, v226, v227
    v_add_u32 v9, 0, v3
    buffer_store_dwordx2 v[6:7], v9, s[8:11], 0 offen
    s_nop 1
    v_mov_b32 v224, 0
    v_mov_b32 v225, 0
    v_mov_b32 v226, 0
    v_mov_b32 v227, 0
    v_readlane_b32 s20, v32, 1
    s_nop 1
    v_fmac_f32 v224, s20, v64
    v_fmac_f32 v225, s20, v65
    v_fmac_f32 v226, s20, v66
    v_fmac_f32 v227, s20, v67
    v_readlane_b32 s20, v33, 1
    s_nop 1
    v_fmac_f32 v224, s20, v68
    v_fmac_f32 v225, s20, v69
    v_fmac_f32 v226, s20, v70
    v_fmac_f32 v227, s20, v71
    v_readlane_b32 s20, v34, 1
    s_nop 1
    v_fmac_f32 v224, s20, v72
    v_fmac_f32 v225, s20, v73
    v_fmac_f32 v226, s20, v74
    v_fmac_f32 v227, s20, v75
    v_readlane_b32 s20, v35, 1
    s_nop 1
    v_fmac_f32 v224, s20, v76
    v_fmac_f32 v225, s20, v77
    v_fmac_f32 v226, s20, v78
    v_fmac_f32 v227, s20, v79
    v_readlane_b32 s20, v32, 17
    s_nop 1
    v_fmac_f32 v224, s20, v80
    v_fmac_f32 v225, s20, v81
    v_fmac_f32 v226, s20, v82
    v_fmac_f32 v227, s20, v83
    v_readlane_b32 s20, v33, 17
    s_nop 1
    v_fmac_f32 v224, s20, v84
    v_fmac_f32 v225, s20, v85
    v_fmac_f32 v226, s20, v86
    v_fmac_f32 v227, s20, v87
    v_readlane_b32 s20, v34, 17
    s_nop 1
    v_fmac_f32 v224, s20, v88
    v_fmac_f32 v225, s20, v89
    v_fmac_f32 v226, s20, v90
    v_fmac_f32 v227, s20, v91
    v_readlane_b32 s20, v35, 17
    s_nop 1
    v_fmac_f32 v224, s20, v92
    v_fmac_f32 v225, s20, v93
    v_fmac_f32 v226, s20, v94
    v_fmac_f32 v227, s20, v95
    v_readlane_b32 s20, v32, 33
    s_nop 1
    v_fmac_f32 v224, s20, v96
    v_fmac_f32 v225, s20, v97
    v_fmac_f32 v226, s20, v98
    v_fmac_f32 v227, s20, v99
    v_readlane_b32 s20, v33, 33
    s_nop 1
    v_fmac_f32 v224, s20, v100
    v_fmac_f32 v225, s20, v101
    v_fmac_f32 v226, s20, v102
    v_fmac_f32 v227, s20, v103
    v_cvt_pk_bf16_f32 v6, v224, v225
    v_cvt_pk_bf16_f32 v7, v226, v227
    v_add_u32 v9, 8192, v3
    buffer_store_dwordx2 v[6:7], v9, s[8:11], 0 offen
    s_nop 1
    v_mov_b32 v224, 0
    v_mov_b32 v225, 0
    v_mov_b32 v226, 0
    v_mov_b32 v227, 0
    v_readlane_b32 s20, v32, 2
    s_nop 1
    v_fmac_f32 v224, s20, v64
    v_fmac_f32 v225, s20, v65
    v_fmac_f32 v226, s20, v66
    v_fmac_f32 v227, s20, v67
    v_readlane_b32 s20, v33, 2
    s_nop 1
    v_fmac_f32 v224, s20, v68
    v_fmac_f32 v225, s20, v69
    v_fmac_f32 v226, s20, v70
    v_fmac_f32 v227, s20, v71
    v_readlane_b32 s20, v34, 2
    s_nop 1
    v_fmac_f32 v224, s20, v72
    v_fmac_f32 v225, s20, v73
    v_fmac_f32 v226, s20, v74
    v_fmac_f32 v227, s20, v75
    v_readlane_b32 s20, v35, 2
    s_nop 1
    v_fmac_f32 v224, s20, v76
    v_fmac_f32 v225, s20, v77
    v_fmac_f32 v226, s20, v78
    v_fmac_f32 v227, s20, v79
    v_readlane_b32 s20, v32, 18
    s_nop 1
    v_fmac_f32 v224, s20, v80
    v_fmac_f32 v225, s20, v81
    v_fmac_f32 v226, s20, v82
    v_fmac_f32 v227, s20, v83
    v_readlane_b32 s20, v33, 18
    s_nop 1
    v_fmac_f32 v224, s20, v84
    v_fmac_f32 v225, s20, v85
    v_fmac_f32 v226, s20, v86
    v_fmac_f32 v227, s20, v87
    v_readlane_b32 s20, v34, 18
    s_nop 1
    v_fmac_f32 v224, s20, v88
    v_fmac_f32 v225, s20, v89
    v_fmac_f32 v226, s20, v90
    v_fmac_f32 v227, s20, v91
    v_readlane_b32 s20, v35, 18
    s_nop 1
    v_fmac_f32 v224, s20, v92
    v_fmac_f32 v225, s20, v93
    v_fmac_f32 v226, s20, v94
    v_fmac_f32 v227, s20, v95
    v_readlane_b32 s20, v32, 34
    s_nop 1
    v_fmac_f32 v224, s20, v96
    v_fmac_f32 v225, s20, v97
    v_fmac_f32 v226, s20, v98
    v_fmac_f32 v227, s20, v99
    v_readlane_b32 s20, v33, 34
    s_nop 1
    v_fmac_f32 v224, s20, v100
    v_fmac_f32 v225, s20, v101
    v_fmac_f32 v226, s20, v102
    v_fmac_f32 v227, s20, v103
    v_readlane_b32 s20, v34, 34
    s_nop 1
    v_fmac_f32 v224, s20, v104
    v_fmac_f32 v225, s20, v105
    v_fmac_f32 v226, s20, v106
    v_fmac_f32 v227, s20, v107
    v_cvt_pk_bf16_f32 v6, v224, v225
    v_cvt_pk_bf16_f32 v7, v226, v227
    v_add_u32 v9, 16384, v3
    buffer_store_dwordx2 v[6:7], v9, s[8:11], 0 offen
    s_nop 1
    v_mov_b32 v224, 0
    v_mov_b32 v225, 0
    v_mov_b32 v226, 0
    v_mov_b32 v227, 0
    v_readlane_b32 s20, v32, 3
    s_nop 1
    v_fmac_f32 v224, s20, v64
    v_fmac_f32 v225, s20, v65
    v_fmac_f32 v226, s20, v66
    v_fmac_f32 v227, s20, v67
    v_readlane_b32 s20, v33, 3
    s_nop 1
    v_fmac_f32 v224, s20, v68
    v_fmac_f32 v225, s20, v69
    v_fmac_f32 v226, s20, v70
    v_fmac_f32 v227, s20, v71
    v_readlane_b32 s20, v34, 3
    s_nop 1
    v_fmac_f32 v224, s20, v72
    v_fmac_f32 v225, s20, v73
    v_fmac_f32 v226, s20, v74
    v_fmac_f32 v227, s20, v75
    v_readlane_b32 s20, v35, 3
    s_nop 1
    v_fmac_f32 v224, s20, v76
    v_fmac_f32 v225, s20, v77
    v_fmac_f32 v226, s20, v78
    v_fmac_f32 v227, s20, v79
    v_readlane_b32 s20, v32, 19
    s_nop 1
    v_fmac_f32 v224, s20, v80
    v_fmac_f32 v225, s20, v81
    v_fmac_f32 v226, s20, v82
    v_fmac_f32 v227, s20, v83
    v_readlane_b32 s20, v33, 19
    s_nop 1
    v_fmac_f32 v224, s20, v84
    v_fmac_f32 v225, s20, v85
    v_fmac_f32 v226, s20, v86
    v_fmac_f32 v227, s20, v87
    v_readlane_b32 s20, v34, 19
    s_nop 1
    v_fmac_f32 v224, s20, v88
    v_fmac_f32 v225, s20, v89
    v_fmac_f32 v226, s20, v90
    v_fmac_f32 v227, s20, v91
    v_readlane_b32 s20, v35, 19
    s_nop 1
    v_fmac_f32 v224, s20, v92
    v_fmac_f32 v225, s20, v93
    v_fmac_f32 v226, s20, v94
    v_fmac_f32 v227, s20, v95
    v_readlane_b32 s20, v32, 35
    s_nop 1
    v_fmac_f32 v224, s20, v96
    v_fmac_f32 v225, s20, v97
    v_fmac_f32 v226, s20, v98
    v_fmac_f32 v227, s20, v99
    v_readlane_b32 s20, v33, 35
    s_nop 1
    v_fmac_f32 v224, s20, v100
    v_fmac_f32 v225, s20, v101
    v_fmac_f32 v226, s20, v102
    v_fmac_f32 v227, s20, v103
    v_readlane_b32 s20, v34, 35
    s_nop 1
    v_fmac_f32 v224, s20, v104
    v_fmac_f32 v225, s20, v105
    v_fmac_f32 v226, s20, v106
    v_fmac_f32 v227, s20, v107
    v_readlane_b32 s20, v35, 35
    s_nop 1
    v_fmac_f32 v224, s20, v108
    v_fmac_f32 v225, s20, v109
    v_fmac_f32 v226, s20, v110
    v_fmac_f32 v227, s20, v111
    v_cvt_pk_bf16_f32 v6, v224, v225
    v_cvt_pk_bf16_f32 v7, v226, v227
    v_add_u32 v9, 24576, v3
    buffer_store_dwordx2 v[6:7], v9, s[8:11], 0 offen
    s_nop 1
    v_mov_b32 v224, 0
    v_mov_b32 v225, 0
    v_mov_b32 v226, 0
    v_mov_b32 v227, 0
    v_readlane_b32 s20, v32, 4
    s_nop 1
    v_fmac_f32 v224, s20, v64
    v_fmac_f32 v225, s20, v65
    v_fmac_f32 v226, s20, v66
    v_fmac_f32 v227, s20, v67
    v_readlane_b32 s20, v33, 4
    s_nop 1
    v_fmac_f32 v224, s20, v68
    v_fmac_f32 v225, s20, v69
    v_fmac_f32 v226, s20, v70
    v_fmac_f32 v227, s20, v71
    v_readlane_b32 s20, v34, 4
    s_nop 1
    v_fmac_f32 v224, s20, v72
    v_fmac_f32 v225, s20, v73
    v_fmac_f32 v226, s20, v74
    v_fmac_f32 v227, s20, v75
    v_readlane_b32 s20, v35, 4
    s_nop 1
    v_fmac_f32 v224, s20, v76
    v_fmac_f32 v225, s20, v77
    v_fmac_f32 v226, s20, v78
    v_fmac_f32 v227, s20, v79
    v_readlane_b32 s20, v32, 20
    s_nop 1
    v_fmac_f32 v224, s20, v80
    v_fmac_f32 v225, s20, v81
    v_fmac_f32 v226, s20, v82
    v_fmac_f32 v227, s20, v83
    v_readlane_b32 s20, v33, 20
    s_nop 1
    v_fmac_f32 v224, s20, v84
    v_fmac_f32 v225, s20, v85
    v_fmac_f32 v226, s20, v86
    v_fmac_f32 v227, s20, v87
    v_readlane_b32 s20, v34, 20
    s_nop 1
    v_fmac_f32 v224, s20, v88
    v_fmac_f32 v225, s20, v89
    v_fmac_f32 v226, s20, v90
    v_fmac_f32 v227, s20, v91
    v_readlane_b32 s20, v35, 20
    s_nop 1
    v_fmac_f32 v224, s20, v92
    v_fmac_f32 v225, s20, v93
    v_fmac_f32 v226, s20, v94
    v_fmac_f32 v227, s20, v95
    v_readlane_b32 s20, v32, 36
    s_nop 1
    v_fmac_f32 v224, s20, v96
    v_fmac_f32 v225, s20, v97
    v_fmac_f32 v226, s20, v98
    v_fmac_f32 v227, s20, v99
    v_readlane_b32 s20, v33, 36
    s_nop 1
    v_fmac_f32 v224, s20, v100
    v_fmac_f32 v225, s20, v101
    v_fmac_f32 v226, s20, v102
    v_fmac_f32 v227, s20, v103
    v_readlane_b32 s20, v34, 36
    s_nop 1
    v_fmac_f32 v224, s20, v104
    v_fmac_f32 v225, s20, v105
    v_fmac_f32 v226, s20, v106
    v_fmac_f32 v227, s20, v107
    v_readlane_b32 s20, v35, 36
    s_nop 1
    v_fmac_f32 v224, s20, v108
    v_fmac_f32 v225, s20, v109
    v_fmac_f32 v226, s20, v110
    v_fmac_f32 v227, s20, v111
    v_readlane_b32 s20, v32, 52
    s_nop 1
    v_fmac_f32 v224, s20, v112
    v_fmac_f32 v225, s20, v113
    v_fmac_f32 v226, s20, v114
    v_fmac_f32 v227, s20, v115
    v_cvt_pk_bf16_f32 v6, v224, v225
    v_cvt_pk_bf16_f32 v7, v226, v227
    v_add_u32 v9, 32768, v3
    buffer_store_dwordx2 v[6:7], v9, s[8:11], 0 offen
    s_nop 1
    v_mov_b32 v224, 0
    v_mov_b32 v225, 0
    v_mov_b32 v226, 0
    v_mov_b32 v227, 0
    v_readlane_b32 s20, v32, 5
    s_nop 1
    v_fmac_f32 v224, s20, v64
    v_fmac_f32 v225, s20, v65
    v_fmac_f32 v226, s20, v66
    v_fmac_f32 v227, s20, v67
    v_readlane_b32 s20, v33, 5
    s_nop 1
    v_fmac_f32 v224, s20, v68
    v_fmac_f32 v225, s20, v69
    v_fmac_f32 v226, s20, v70
    v_fmac_f32 v227, s20, v71
    v_readlane_b32 s20, v34, 5
    s_nop 1
    v_fmac_f32 v224, s20, v72
    v_fmac_f32 v225, s20, v73
    v_fmac_f32 v226, s20, v74
    v_fmac_f32 v227, s20, v75
    v_readlane_b32 s20, v35, 5
    s_nop 1
    v_fmac_f32 v224, s20, v76
    v_fmac_f32 v225, s20, v77
    v_fmac_f32 v226, s20, v78
    v_fmac_f32 v227, s20, v79
    v_readlane_b32 s20, v32, 21
    s_nop 1
    v_fmac_f32 v224, s20, v80
    v_fmac_f32 v225, s20, v81
    v_fmac_f32 v226, s20, v82
    v_fmac_f32 v227, s20, v83
    v_readlane_b32 s20, v33, 21
    s_nop 1
    v_fmac_f32 v224, s20, v84
    v_fmac_f32 v225, s20, v85
    v_fmac_f32 v226, s20, v86
    v_fmac_f32 v227, s20, v87
    v_readlane_b32 s20, v34, 21
    s_nop 1
    v_fmac_f32 v224, s20, v88
    v_fmac_f32 v225, s20, v89
    v_fmac_f32 v226, s20, v90
    v_fmac_f32 v227, s20, v91
    v_readlane_b32 s20, v35, 21
    s_nop 1
    v_fmac_f32 v224, s20, v92
    v_fmac_f32 v225, s20, v93
    v_fmac_f32 v226, s20, v94
    v_fmac_f32 v227, s20, v95
    v_readlane_b32 s20, v32, 37
    s_nop 1
    v_fmac_f32 v224, s20, v96
    v_fmac_f32 v225, s20, v97
    v_fmac_f32 v226, s20, v98
    v_fmac_f32 v227, s20, v99
    v_readlane_b32 s20, v33, 37
    s_nop 1
    v_fmac_f32 v224, s20, v100
    v_fmac_f32 v225, s20, v101
    v_fmac_f32 v226, s20, v102
    v_fmac_f32 v227, s20, v103
    v_readlane_b32 s20, v34, 37
    s_nop 1
    v_fmac_f32 v224, s20, v104
    v_fmac_f32 v225, s20, v105
    v_fmac_f32 v226, s20, v106
    v_fmac_f32 v227, s20, v107
    v_readlane_b32 s20, v35, 37
    s_nop 1
    v_fmac_f32 v224, s20, v108
    v_fmac_f32 v225, s20, v109
    v_fmac_f32 v226, s20, v110
    v_fmac_f32 v227, s20, v111
    v_readlane_b32 s20, v32, 53
    s_nop 1
    v_fmac_f32 v224, s20, v112
    v_fmac_f32 v225, s20, v113
    v_fmac_f32 v226, s20, v114
    v_fmac_f32 v227, s20, v115
    v_readlane_b32 s20, v33, 53
    s_nop 1
    v_fmac_f32 v224, s20, v116
    v_fmac_f32 v225, s20, v117
    v_fmac_f32 v226, s20, v118
    v_fmac_f32 v227, s20, v119
    v_cvt_pk_bf16_f32 v6, v224, v225
    v_cvt_pk_bf16_f32 v7, v226, v227
    v_add_u32 v9, 40960, v3
    buffer_store_dwordx2 v[6:7], v9, s[8:11], 0 offen
    s_nop 1
    v_mov_b32 v224, 0
    v_mov_b32 v225, 0
    v_mov_b32 v226, 0
    v_mov_b32 v227, 0
    v_readlane_b32 s20, v32, 6
    s_nop 1
    v_fmac_f32 v224, s20, v64
    v_fmac_f32 v225, s20, v65
    v_fmac_f32 v226, s20, v66
    v_fmac_f32 v227, s20, v67
    v_readlane_b32 s20, v33, 6
    s_nop 1
    v_fmac_f32 v224, s20, v68
    v_fmac_f32 v225, s20, v69
    v_fmac_f32 v226, s20, v70
    v_fmac_f32 v227, s20, v71
    v_readlane_b32 s20, v34, 6
    s_nop 1
    v_fmac_f32 v224, s20, v72
    v_fmac_f32 v225, s20, v73
    v_fmac_f32 v226, s20, v74
    v_fmac_f32 v227, s20, v75
    v_readlane_b32 s20, v35, 6
    s_nop 1
    v_fmac_f32 v224, s20, v76
    v_fmac_f32 v225, s20, v77
    v_fmac_f32 v226, s20, v78
    v_fmac_f32 v227, s20, v79
    v_readlane_b32 s20, v32, 22
    s_nop 1
    v_fmac_f32 v224, s20, v80
    v_fmac_f32 v225, s20, v81
    v_fmac_f32 v226, s20, v82
    v_fmac_f32 v227, s20, v83
    v_readlane_b32 s20, v33, 22
    s_nop 1
    v_fmac_f32 v224, s20, v84
    v_fmac_f32 v225, s20, v85
    v_fmac_f32 v226, s20, v86
    v_fmac_f32 v227, s20, v87
    v_readlane_b32 s20, v34, 22
    s_nop 1
    v_fmac_f32 v224, s20, v88
    v_fmac_f32 v225, s20, v89
    v_fmac_f32 v226, s20, v90
    v_fmac_f32 v227, s20, v91
    v_readlane_b32 s20, v35, 22
    s_nop 1
    v_fmac_f32 v224, s20, v92
    v_fmac_f32 v225, s20, v93
    v_fmac_f32 v226, s20, v94
    v_fmac_f32 v227, s20, v95
    v_readlane_b32 s20, v32, 38
    s_nop 1
    v_fmac_f32 v224, s20, v96
    v_fmac_f32 v225, s20, v97
    v_fmac_f32 v226, s20, v98
    v_fmac_f32 v227, s20, v99
    v_readlane_b32 s20, v33, 38
    s_nop 1
    v_fmac_f32 v224, s20, v100
    v_fmac_f32 v225, s20, v101
    v_fmac_f32 v226, s20, v102
    v_fmac_f32 v227, s20, v103
    v_readlane_b32 s20, v34, 38
    s_nop 1
    v_fmac_f32 v224, s20, v104
    v_fmac_f32 v225, s20, v105
    v_fmac_f32 v226, s20, v106
    v_fmac_f32 v227, s20, v107
    v_readlane_b32 s20, v35, 38
    s_nop 1
    v_fmac_f32 v224, s20, v108
    v_fmac_f32 v225, s20, v109
    v_fmac_f32 v226, s20, v110
    v_fmac_f32 v227, s20, v111
    v_readlane_b32 s20, v32, 54
    s_nop 1
    v_fmac_f32 v224, s20, v112
    v_fmac_f32 v225, s20, v113
    v_fmac_f32 v226, s20, v114
    v_fmac_f32 v227, s20, v115
    v_readlane_b32 s20, v33, 54
    s_nop 1
    v_fmac_f32 v224, s20, v116
    v_fmac_f32 v225, s20, v117
    v_fmac_f32 v226, s20, v118
    v_fmac_f32 v227, s20, v119
    v_readlane_b32 s20, v34, 54
    s_nop 1
    v_fmac_f32 v224, s20, v120
    v_fmac_f32 v225, s20, v121
    v_fmac_f32 v226, s20, v122
    v_fmac_f32 v227, s20, v123
    v_cvt_pk_bf16_f32 v6, v224, v225
    v_cvt_pk_bf16_f32 v7, v226, v227
    v_add_u32 v9, 49152, v3
    buffer_store_dwordx2 v[6:7], v9, s[8:11], 0 offen
    s_nop 1
    v_mov_b32 v224, 0
    v_mov_b32 v225, 0
    v_mov_b32 v226, 0
    v_mov_b32 v227, 0
    v_readlane_b32 s20, v32, 7
    s_nop 1
    v_fmac_f32 v224, s20, v64
    v_fmac_f32 v225, s20, v65
    v_fmac_f32 v226, s20, v66
    v_fmac_f32 v227, s20, v67
    v_readlane_b32 s20, v33, 7
    s_nop 1
    v_fmac_f32 v224, s20, v68
    v_fmac_f32 v225, s20, v69
    v_fmac_f32 v226, s20, v70
    v_fmac_f32 v227, s20, v71
    v_readlane_b32 s20, v34, 7
    s_nop 1
    v_fmac_f32 v224, s20, v72
    v_fmac_f32 v225, s20, v73
    v_fmac_f32 v226, s20, v74
    v_fmac_f32 v227, s20, v75
    v_readlane_b32 s20, v35, 7
    s_nop 1
    v_fmac_f32 v224, s20, v76
    v_fmac_f32 v225, s20, v77
    v_fmac_f32 v226, s20, v78
    v_fmac_f32 v227, s20, v79
    v_readlane_b32 s20, v32, 23
    s_nop 1
    v_fmac_f32 v224, s20, v80
    v_fmac_f32 v225, s20, v81
    v_fmac_f32 v226, s20, v82
    v_fmac_f32 v227, s20, v83
    v_readlane_b32 s20, v33, 23
    s_nop 1
    v_fmac_f32 v224, s20, v84
    v_fmac_f32 v225, s20, v85
    v_fmac_f32 v226, s20, v86
    v_fmac_f32 v227, s20, v87
    v_readlane_b32 s20, v34, 23
    s_nop 1
    v_fmac_f32 v224, s20, v88
    v_fmac_f32 v225, s20, v89
    v_fmac_f32 v226, s20, v90
    v_fmac_f32 v227, s20, v91
    v_readlane_b32 s20, v35, 23
    s_nop 1
    v_fmac_f32 v224, s20, v92
    v_fmac_f32 v225, s20, v93
    v_fmac_f32 v226, s20, v94
    v_fmac_f32 v227, s20, v95
    v_readlane_b32 s20, v32, 39
    s_nop 1
    v_fmac_f32 v224, s20, v96
    v_fmac_f32 v225, s20, v97
    v_fmac_f32 v226, s20, v98
    v_fmac_f32 v227, s20, v99
    v_readlane_b32 s20, v33, 39
    s_nop 1
    v_fmac_f32 v224, s20, v100
    v_fmac_f32 v225, s20, v101
    v_fmac_f32 v226, s20, v102
    v_fmac_f32 v227, s20, v103
    v_readlane_b32 s20, v34, 39
    s_nop 1
    v_fmac_f32 v224, s20, v104
    v_fmac_f32 v225, s20, v105
    v_fmac_f32 v226, s20, v106
    v_fmac_f32 v227, s20, v107
    v_readlane_b32 s20, v35, 39
    s_nop 1
    v_fmac_f32 v224, s20, v108
    v_fmac_f32 v225, s20, v109
    v_fmac_f32 v226, s20, v110
    v_fmac_f32 v227, s20, v111
    v_readlane_b32 s20, v32, 55
    s_nop 1
    v_fmac_f32 v224, s20, v112
    v_fmac_f32 v225, s20, v113
    v_fmac_f32 v226, s20, v114
    v_fmac_f32 v227, s20, v115
    v_readlane_b32 s20, v33, 55
    s_nop 1
    v_fmac_f32 v224, s20, v116
    v_fmac_f32 v225, s20, v117
    v_fmac_f32 v226, s20, v118
    v_fmac_f32 v227, s20, v119
    v_readlane_b32 s20, v34, 55
    s_nop 1
    v_fmac_f32 v224, s20, v120
    v_fmac_f32 v225, s20, v121
    v_fmac_f32 v226, s20, v122
    v_fmac_f32 v227, s20, v123
    v_readlane_b32 s20, v35, 55
    s_nop 1
    v_fmac_f32 v224, s20, v124
    v_fmac_f32 v225, s20, v125
    v_fmac_f32 v226, s20, v126
    v_fmac_f32 v227, s20, v127
    v_cvt_pk_bf16_f32 v6, v224, v225
    v_cvt_pk_bf16_f32 v7, v226, v227
    v_add_u32 v9, 57344, v3
    buffer_store_dwordx2 v[6:7], v9, s[8:11], 0 offen
    s_nop 1
    v_mov_b32 v224, 0
    v_mov_b32 v225, 0
    v_mov_b32 v226, 0
    v_mov_b32 v227, 0
    v_readlane_b32 s20, v32, 8
    s_nop 1
    v_fmac_f32 v224, s20, v64
    v_fmac_f32 v225, s20, v65
    v_fmac_f32 v226, s20, v66
    v_fmac_f32 v227, s20, v67
    v_readlane_b32 s20, v33, 8
    s_nop 1
    v_fmac_f32 v224, s20, v68
    v_fmac_f32 v225, s20, v69
    v_fmac_f32 v226, s20, v70
    v_fmac_f32 v227, s20, v71
    v_readlane_b32 s20, v34, 8
    s_nop 1
    v_fmac_f32 v224, s20, v72
    v_fmac_f32 v225, s20, v73
    v_fmac_f32 v226, s20, v74
    v_fmac_f32 v227, s20, v75
    v_readlane_b32 s20, v35, 8
    s_nop 1
    v_fmac_f32 v224, s20, v76
    v_fmac_f32 v225, s20, v77
    v_fmac_f32 v226, s20, v78
    v_fmac_f32 v227, s20, v79
    v_readlane_b32 s20, v32, 24
    s_nop 1
    v_fmac_f32 v224, s20, v80
    v_fmac_f32 v225, s20, v81
    v_fmac_f32 v226, s20, v82
    v_fmac_f32 v227, s20, v83
    v_readlane_b32 s20, v33, 24
    s_nop 1
    v_fmac_f32 v224, s20, v84
    v_fmac_f32 v225, s20, v85
    v_fmac_f32 v226, s20, v86
    v_fmac_f32 v227, s20, v87
    v_readlane_b32 s20, v34, 24
    s_nop 1
    v_fmac_f32 v224, s20, v88
    v_fmac_f32 v225, s20, v89
    v_fmac_f32 v226, s20, v90
    v_fmac_f32 v227, s20, v91
    v_readlane_b32 s20, v35, 24
    s_nop 1
    v_fmac_f32 v224, s20, v92
    v_fmac_f32 v225, s20, v93
    v_fmac_f32 v226, s20, v94
    v_fmac_f32 v227, s20, v95
    v_readlane_b32 s20, v32, 40
    s_nop 1
    v_fmac_f32 v224, s20, v96
    v_fmac_f32 v225, s20, v97
    v_fmac_f32 v226, s20, v98
    v_fmac_f32 v227, s20, v99
    v_readlane_b32 s20, v33, 40
    s_nop 1
    v_fmac_f32 v224, s20, v100
    v_fmac_f32 v225, s20, v101
    v_fmac_f32 v226, s20, v102
    v_fmac_f32 v227, s20, v103
    v_readlane_b32 s20, v34, 40
    s_nop 1
    v_fmac_f32 v224, s20, v104
    v_fmac_f32 v225, s20, v105
    v_fmac_f32 v226, s20, v106
    v_fmac_f32 v227, s20, v107
    v_readlane_b32 s20, v35, 40
    s_nop 1
    v_fmac_f32 v224, s20, v108
    v_fmac_f32 v225, s20, v109
    v_fmac_f32 v226, s20, v110
    v_fmac_f32 v227, s20, v111
    v_readlane_b32 s20, v32, 56
    s_nop 1
    v_fmac_f32 v224, s20, v112
    v_fmac_f32 v225, s20, v113
    v_fmac_f32 v226, s20, v114
    v_fmac_f32 v227, s20, v115
    v_readlane_b32 s20, v33, 56
    s_nop 1
    v_fmac_f32 v224, s20, v116
    v_fmac_f32 v225, s20, v117
    v_fmac_f32 v226, s20, v118
    v_fmac_f32 v227, s20, v119
    v_readlane_b32 s20, v34, 56
    s_nop 1
    v_fmac_f32 v224, s20, v120
    v_fmac_f32 v225, s20, v121
    v_fmac_f32 v226, s20, v122
    v_fmac_f32 v227, s20, v123
    v_readlane_b32 s20, v35, 56
    s_nop 1
    v_fmac_f32 v224, s20, v124
    v_fmac_f32 v225, s20, v125
    v_fmac_f32 v226, s20, v126
    v_fmac_f32 v227, s20, v127
    v_readlane_b32 s20, v40, 8
    s_nop 1
    v_fmac_f32 v224, s20, v128
    v_fmac_f32 v225, s20, v129
    v_fmac_f32 v226, s20, v130
    v_fmac_f32 v227, s20, v131
    v_cvt_pk_bf16_f32 v6, v224, v225
    v_cvt_pk_bf16_f32 v7, v226, v227
    v_add_u32 v9, 65536, v3
    buffer_store_dwordx2 v[6:7], v9, s[8:11], 0 offen
    s_nop 1
    v_mov_b32 v224, 0
    v_mov_b32 v225, 0
    v_mov_b32 v226, 0
    v_mov_b32 v227, 0
    v_readlane_b32 s20, v32, 9
    s_nop 1
    v_fmac_f32 v224, s20, v64
    v_fmac_f32 v225, s20, v65
    v_fmac_f32 v226, s20, v66
    v_fmac_f32 v227, s20, v67
    v_readlane_b32 s20, v33, 9
    s_nop 1
    v_fmac_f32 v224, s20, v68
    v_fmac_f32 v225, s20, v69
    v_fmac_f32 v226, s20, v70
    v_fmac_f32 v227, s20, v71
    v_readlane_b32 s20, v34, 9
    s_nop 1
    v_fmac_f32 v224, s20, v72
    v_fmac_f32 v225, s20, v73
    v_fmac_f32 v226, s20, v74
    v_fmac_f32 v227, s20, v75
    v_readlane_b32 s20, v35, 9
    s_nop 1
    v_fmac_f32 v224, s20, v76
    v_fmac_f32 v225, s20, v77
    v_fmac_f32 v226, s20, v78
    v_fmac_f32 v227, s20, v79
    v_readlane_b32 s20, v32, 25
    s_nop 1
    v_fmac_f32 v224, s20, v80
    v_fmac_f32 v225, s20, v81
    v_fmac_f32 v226, s20, v82
    v_fmac_f32 v227, s20, v83
    v_readlane_b32 s20, v33, 25
    s_nop 1
    v_fmac_f32 v224, s20, v84
    v_fmac_f32 v225, s20, v85
    v_fmac_f32 v226, s20, v86
    v_fmac_f32 v227, s20, v87
    v_readlane_b32 s20, v34, 25
    s_nop 1
    v_fmac_f32 v224, s20, v88
    v_fmac_f32 v225, s20, v89
    v_fmac_f32 v226, s20, v90
    v_fmac_f32 v227, s20, v91
    v_readlane_b32 s20, v35, 25
    s_nop 1
    v_fmac_f32 v224, s20, v92
    v_fmac_f32 v225, s20, v93
    v_fmac_f32 v226, s20, v94
    v_fmac_f32 v227, s20, v95
    v_readlane_b32 s20, v32, 41
    s_nop 1
    v_fmac_f32 v224, s20, v96
    v_fmac_f32 v225, s20, v97
    v_fmac_f32 v226, s20, v98
    v_fmac_f32 v227, s20, v99
    v_readlane_b32 s20, v33, 41
    s_nop 1
    v_fmac_f32 v224, s20, v100
    v_fmac_f32 v225, s20, v101
    v_fmac_f32 v226, s20, v102
    v_fmac_f32 v227, s20, v103
    v_readlane_b32 s20, v34, 41
    s_nop 1
    v_fmac_f32 v224, s20, v104
    v_fmac_f32 v225, s20, v105
    v_fmac_f32 v226, s20, v106
    v_fmac_f32 v227, s20, v107
    v_readlane_b32 s20, v35, 41
    s_nop 1
    v_fmac_f32 v224, s20, v108
    v_fmac_f32 v225, s20, v109
    v_fmac_f32 v226, s20, v110
    v_fmac_f32 v227, s20, v111
    v_readlane_b32 s20, v32, 57
    s_nop 1
    v_fmac_f32 v224, s20, v112
    v_fmac_f32 v225, s20, v113
    v_fmac_f32 v226, s20, v114
    v_fmac_f32 v227, s20, v115
    v_readlane_b32 s20, v33, 57
    s_nop 1
    v_fmac_f32 v224, s20, v116
    v_fmac_f32 v225, s20, v117
    v_fmac_f32 v226, s20, v118
    v_fmac_f32 v227, s20, v119
    v_readlane_b32 s20, v34, 57
    s_nop 1
    v_fmac_f32 v224, s20, v120
    v_fmac_f32 v225, s20, v121
    v_fmac_f32 v226, s20, v122
    v_fmac_f32 v227, s20, v123
    v_readlane_b32 s20, v35, 57
    s_nop 1
    v_fmac_f32 v224, s20, v124
    v_fmac_f32 v225, s20, v125
    v_fmac_f32 v226, s20, v126
    v_fmac_f32 v227, s20, v127
    v_readlane_b32 s20, v40, 9
    s_nop 1
    v_fmac_f32 v224, s20, v128
    v_fmac_f32 v225, s20, v129
    v_fmac_f32 v226, s20, v130
    v_fmac_f32 v227, s20, v131
    v_readlane_b32 s20, v41, 9
    s_nop 1
    v_fmac_f32 v224, s20, v132
    v_fmac_f32 v225, s20, v133
    v_fmac_f32 v226, s20, v134
    v_fmac_f32 v227, s20, v135
    v_cvt_pk_bf16_f32 v6, v224, v225
    v_cvt_pk_bf16_f32 v7, v226, v227
    v_add_u32 v9, 73728, v3
    buffer_store_dwordx2 v[6:7], v9, s[8:11], 0 offen
    s_nop 1
    v_mov_b32 v224, 0
    v_mov_b32 v225, 0
    v_mov_b32 v226, 0
    v_mov_b32 v227, 0
    v_readlane_b32 s20, v32, 10
    s_nop 1
    v_fmac_f32 v224, s20, v64
    v_fmac_f32 v225, s20, v65
    v_fmac_f32 v226, s20, v66
    v_fmac_f32 v227, s20, v67
    v_readlane_b32 s20, v33, 10
    s_nop 1
    v_fmac_f32 v224, s20, v68
    v_fmac_f32 v225, s20, v69
    v_fmac_f32 v226, s20, v70
    v_fmac_f32 v227, s20, v71
    v_readlane_b32 s20, v34, 10
    s_nop 1
    v_fmac_f32 v224, s20, v72
    v_fmac_f32 v225, s20, v73
    v_fmac_f32 v226, s20, v74
    v_fmac_f32 v227, s20, v75
    v_readlane_b32 s20, v35, 10
    s_nop 1
    v_fmac_f32 v224, s20, v76
    v_fmac_f32 v225, s20, v77
    v_fmac_f32 v226, s20, v78
    v_fmac_f32 v227, s20, v79
    v_readlane_b32 s20, v32, 26
    s_nop 1
    v_fmac_f32 v224, s20, v80
    v_fmac_f32 v225, s20, v81
    v_fmac_f32 v226, s20, v82
    v_fmac_f32 v227, s20, v83
    v_readlane_b32 s20, v33, 26
    s_nop 1
    v_fmac_f32 v224, s20, v84
    v_fmac_f32 v225, s20, v85
    v_fmac_f32 v226, s20, v86
    v_fmac_f32 v227, s20, v87
    v_readlane_b32 s20, v34, 26
    s_nop 1
    v_fmac_f32 v224, s20, v88
    v_fmac_f32 v225, s20, v89
    v_fmac_f32 v226, s20, v90
    v_fmac_f32 v227, s20, v91
    v_readlane_b32 s20, v35, 26
    s_nop 1
    v_fmac_f32 v224, s20, v92
    v_fmac_f32 v225, s20, v93
    v_fmac_f32 v226, s20, v94
    v_fmac_f32 v227, s20, v95
    v_readlane_b32 s20, v32, 42
    s_nop 1
    v_fmac_f32 v224, s20, v96
    v_fmac_f32 v225, s20, v97
    v_fmac_f32 v226, s20, v98
    v_fmac_f32 v227, s20, v99
    v_readlane_b32 s20, v33, 42
    s_nop 1
    v_fmac_f32 v224, s20, v100
    v_fmac_f32 v225, s20, v101
    v_fmac_f32 v226, s20, v102
    v_fmac_f32 v227, s20, v103
    v_readlane_b32 s20, v34, 42
    s_nop 1
    v_fmac_f32 v224, s20, v104
    v_fmac_f32 v225, s20, v105
    v_fmac_f32 v226, s20, v106
    v_fmac_f32 v227, s20, v107
    v_readlane_b32 s20, v35, 42
    s_nop 1
    v_fmac_f32 v224, s20, v108
    v_fmac_f32 v225, s20, v109
    v_fmac_f32 v226, s20, v110
    v_fmac_f32 v227, s20, v111
    v_readlane_b32 s20, v32, 58
    s_nop 1
    v_fmac_f32 v224, s20, v112
    v_fmac_f32 v225, s20, v113
    v_fmac_f32 v226, s20, v114
    v_fmac_f32 v227, s20, v115
    v_readlane_b32 s20, v33, 58
    s_nop 1
    v_fmac_f32 v224, s20, v116
    v_fmac_f32 v225, s20, v117
    v_fmac_f32 v226, s20, v118
    v_fmac_f32 v227, s20, v119
    v_readlane_b32 s20, v34, 58
    s_nop 1
    v_fmac_f32 v224, s20, v120
    v_fmac_f32 v225, s20, v121
    v_fmac_f32 v226, s20, v122
    v_fmac_f32 v227, s20, v123
    v_readlane_b32 s20, v35, 58
    s_nop 1
    v_fmac_f32 v224, s20, v124
    v_fmac_f32 v225, s20, v125
    v_fmac_f32 v226, s20, v126
    v_fmac_f32 v227, s20, v127
    v_readlane_b32 s20, v40, 10
    s_nop 1
    v_fmac_f32 v224, s20, v128
    v_fmac_f32 v225, s20, v129
    v_fmac_f32 v226, s20, v130
    v_fmac_f32 v227, s20, v131
    v_readlane_b32 s20, v41, 10
    s_nop 1
    v_fmac_f32 v224, s20, v132
    v_fmac_f32 v225, s20, v133
    v_fmac_f32 v226, s20, v134
    v_fmac_f32 v227, s20, v135
    v_readlane_b32 s20, v42, 10
    s_nop 1
    v_fmac_f32 v224, s20, v136
    v_fmac_f32 v225, s20, v137
    v_fmac_f32 v226, s20, v138
    v_fmac_f32 v227, s20, v139
    v_cvt_pk_bf16_f32 v6, v224, v225
    v_cvt_pk_bf16_f32 v7, v226, v227
    v_add_u32 v9, 81920, v3
    buffer_store_dwordx2 v[6:7], v9, s[8:11], 0 offen
    s_nop 1
    v_mov_b32 v224, 0
    v_mov_b32 v225, 0
    v_mov_b32 v226, 0
    v_mov_b32 v227, 0
    v_readlane_b32 s20, v32, 11
    s_nop 1
    v_fmac_f32 v224, s20, v64
    v_fmac_f32 v225, s20, v65
    v_fmac_f32 v226, s20, v66
    v_fmac_f32 v227, s20, v67
    v_readlane_b32 s20, v33, 11
    s_nop 1
    v_fmac_f32 v224, s20, v68
    v_fmac_f32 v225, s20, v69
    v_fmac_f32 v226, s20, v70
    v_fmac_f32 v227, s20, v71
    v_readlane_b32 s20, v34, 11
    s_nop 1
    v_fmac_f32 v224, s20, v72
    v_fmac_f32 v225, s20, v73
    v_fmac_f32 v226, s20, v74
    v_fmac_f32 v227, s20, v75
    v_readlane_b32 s20, v35, 11
    s_nop 1
    v_fmac_f32 v224, s20, v76
    v_fmac_f32 v225, s20, v77
    v_fmac_f32 v226, s20, v78
    v_fmac_f32 v227, s20, v79
    v_readlane_b32 s20, v32, 27
    s_nop 1
    v_fmac_f32 v224, s20, v80
    v_fmac_f32 v225, s20, v81
    v_fmac_f32 v226, s20, v82
    v_fmac_f32 v227, s20, v83
    v_readlane_b32 s20, v33, 27
    s_nop 1
    v_fmac_f32 v224, s20, v84
    v_fmac_f32 v225, s20, v85
    v_fmac_f32 v226, s20, v86
    v_fmac_f32 v227, s20, v87
    v_readlane_b32 s20, v34, 27
    s_nop 1
    v_fmac_f32 v224, s20, v88
    v_fmac_f32 v225, s20, v89
    v_fmac_f32 v226, s20, v90
    v_fmac_f32 v227, s20, v91
    v_readlane_b32 s20, v35, 27
    s_nop 1
    v_fmac_f32 v224, s20, v92
    v_fmac_f32 v225, s20, v93
    v_fmac_f32 v226, s20, v94
    v_fmac_f32 v227, s20, v95
    v_readlane_b32 s20, v32, 43
    s_nop 1
    v_fmac_f32 v224, s20, v96
    v_fmac_f32 v225, s20, v97
    v_fmac_f32 v226, s20, v98
    v_fmac_f32 v227, s20, v99
    v_readlane_b32 s20, v33, 43
    s_nop 1
    v_fmac_f32 v224, s20, v100
    v_fmac_f32 v225, s20, v101
    v_fmac_f32 v226, s20, v102
    v_fmac_f32 v227, s20, v103
    v_readlane_b32 s20, v34, 43
    s_nop 1
    v_fmac_f32 v224, s20, v104
    v_fmac_f32 v225, s20, v105
    v_fmac_f32 v226, s20, v106
    v_fmac_f32 v227, s20, v107
    v_readlane_b32 s20, v35, 43
    s_nop 1
    v_fmac_f32 v224, s20, v108
    v_fmac_f32 v225, s20, v109
    v_fmac_f32 v226, s20, v110
    v_fmac_f32 v227, s20, v111
    v_readlane_b32 s20, v32, 59
    s_nop 1
    v_fmac_f32 v224, s20, v112
    v_fmac_f32 v225, s20, v113
    v_fmac_f32 v226, s20, v114
    v_fmac_f32 v227, s20, v115
    v_readlane_b32 s20, v33, 59
    s_nop 1
    v_fmac_f32 v224, s20, v116
    v_fmac_f32 v225, s20, v117
    v_fmac_f32 v226, s20, v118
    v_fmac_f32 v227, s20, v119
    v_readlane_b32 s20, v34, 59
    s_nop 1
    v_fmac_f32 v224, s20, v120
    v_fmac_f32 v225, s20, v121
    v_fmac_f32 v226, s20, v122
    v_fmac_f32 v227, s20, v123
    v_readlane_b32 s20, v35, 59
    s_nop 1
    v_fmac_f32 v224, s20, v124
    v_fmac_f32 v225, s20, v125
    v_fmac_f32 v226, s20, v126
    v_fmac_f32 v227, s20, v127
    v_readlane_b32 s20, v40, 11
    s_nop 1
    v_fmac_f32 v224, s20, v128
    v_fmac_f32 v225, s20, v129
    v_fmac_f32 v226, s20, v130
    v_fmac_f32 v227, s20, v131
    v_readlane_b32 s20, v41, 11
    s_nop 1
    v_fmac_f32 v224, s20, v132
    v_fmac_f32 v225, s20, v133
    v_fmac_f32 v226, s20, v134
    v_fmac_f32 v227, s20, v135
    v_readlane_b32 s20, v42, 11
    s_nop 1
    v_fmac_f32 v224, s20, v136
    v_fmac_f32 v225, s20, v137
    v_fmac_f32 v226, s20, v138
    v_fmac_f32 v227, s20, v139
    v_readlane_b32 s20, v43, 11
    s_nop 1
    v_fmac_f32 v224, s20, v140
    v_fmac_f32 v225, s20, v141
    v_fmac_f32 v226, s20, v142
    v_fmac_f32 v227, s20, v143
    v_cvt_pk_bf16_f32 v6, v224, v225
    v_cvt_pk_bf16_f32 v7, v226, v227
    v_add_u32 v9, 90112, v3
    buffer_store_dwordx2 v[6:7], v9, s[8:11], 0 offen
    s_nop 1
    v_mov_b32 v224, 0
    v_mov_b32 v225, 0
    v_mov_b32 v226, 0
    v_mov_b32 v227, 0
    v_readlane_b32 s20, v32, 12
    s_nop 1
    v_fmac_f32 v224, s20, v64
    v_fmac_f32 v225, s20, v65
    v_fmac_f32 v226, s20, v66
    v_fmac_f32 v227, s20, v67
    v_readlane_b32 s20, v33, 12
    s_nop 1
    v_fmac_f32 v224, s20, v68
    v_fmac_f32 v225, s20, v69
    v_fmac_f32 v226, s20, v70
    v_fmac_f32 v227, s20, v71
    v_readlane_b32 s20, v34, 12
    s_nop 1
    v_fmac_f32 v224, s20, v72
    v_fmac_f32 v225, s20, v73
    v_fmac_f32 v226, s20, v74
    v_fmac_f32 v227, s20, v75
    v_readlane_b32 s20, v35, 12
    s_nop 1
    v_fmac_f32 v224, s20, v76
    v_fmac_f32 v225, s20, v77
    v_fmac_f32 v226, s20, v78
    v_fmac_f32 v227, s20, v79
    v_readlane_b32 s20, v32, 28
    s_nop 1
    v_fmac_f32 v224, s20, v80
    v_fmac_f32 v225, s20, v81
    v_fmac_f32 v226, s20, v82
    v_fmac_f32 v227, s20, v83
    v_readlane_b32 s20, v33, 28
    s_nop 1
    v_fmac_f32 v224, s20, v84
    v_fmac_f32 v225, s20, v85
    v_fmac_f32 v226, s20, v86
    v_fmac_f32 v227, s20, v87
    v_readlane_b32 s20, v34, 28
    s_nop 1
    v_fmac_f32 v224, s20, v88
    v_fmac_f32 v225, s20, v89
    v_fmac_f32 v226, s20, v90
    v_fmac_f32 v227, s20, v91
    v_readlane_b32 s20, v35, 28
    s_nop 1
    v_fmac_f32 v224, s20, v92
    v_fmac_f32 v225, s20, v93
    v_fmac_f32 v226, s20, v94
    v_fmac_f32 v227, s20, v95
    v_readlane_b32 s20, v32, 44
    s_nop 1
    v_fmac_f32 v224, s20, v96
    v_fmac_f32 v225, s20, v97
    v_fmac_f32 v226, s20, v98
    v_fmac_f32 v227, s20, v99
    v_readlane_b32 s20, v33, 44
    s_nop 1
    v_fmac_f32 v224, s20, v100
    v_fmac_f32 v225, s20, v101
    v_fmac_f32 v226, s20, v102
    v_fmac_f32 v227, s20, v103
    v_readlane_b32 s20, v34, 44
    s_nop 1
    v_fmac_f32 v224, s20, v104
    v_fmac_f32 v225, s20, v105
    v_fmac_f32 v226, s20, v106
    v_fmac_f32 v227, s20, v107
    v_readlane_b32 s20, v35, 44
    s_nop 1
    v_fmac_f32 v224, s20, v108
    v_fmac_f32 v225, s20, v109
    v_fmac_f32 v226, s20, v110
    v_fmac_f32 v227, s20, v111
    v_readlane_b32 s20, v32, 60
    s_nop 1
    v_fmac_f32 v224, s20, v112
    v_fmac_f32 v225, s20, v113
    v_fmac_f32 v226, s20, v114
    v_fmac_f32 v227, s20, v115
    v_readlane_b32 s20, v33, 60
    s_nop 1
    v_fmac_f32 v224, s20, v116
    v_fmac_f32 v225, s20, v117
    v_fmac_f32 v226, s20, v118
    v_fmac_f32 v227, s20, v119
    v_readlane_b32 s20, v34, 60
    s_nop 1
    v_fmac_f32 v224, s20, v120
    v_fmac_f32 v225, s20, v121
    v_fmac_f32 v226, s20, v122
    v_fmac_f32 v227, s20, v123
    v_readlane_b32 s20, v35, 60
    s_nop 1
    v_fmac_f32 v224, s20, v124
    v_fmac_f32 v225, s20, v125
    v_fmac_f32 v226, s20, v126
    v_fmac_f32 v227, s20, v127
    v_readlane_b32 s20, v40, 12
    s_nop 1
    v_fmac_f32 v224, s20, v128
    v_fmac_f32 v225, s20, v129
    v_fmac_f32 v226, s20, v130
    v_fmac_f32 v227, s20, v131
    v_readlane_b32 s20, v41, 12
    s_nop 1
    v_fmac_f32 v224, s20, v132
    v_fmac_f32 v225, s20, v133
    v_fmac_f32 v226, s20, v134
    v_fmac_f32 v227, s20, v135
    v_readlane_b32 s20, v42, 12
    s_nop 1
    v_fmac_f32 v224, s20, v136
    v_fmac_f32 v225, s20, v137
    v_fmac_f32 v226, s20, v138
    v_fmac_f32 v227, s20, v139
    v_readlane_b32 s20, v43, 12
    s_nop 1
    v_fmac_f32 v224, s20, v140
    v_fmac_f32 v225, s20, v141
    v_fmac_f32 v226, s20, v142
    v_fmac_f32 v227, s20, v143
    v_readlane_b32 s20, v40, 28
    s_nop 1
    v_fmac_f32 v224, s20, v144
    v_fmac_f32 v225, s20, v145
    v_fmac_f32 v226, s20, v146
    v_fmac_f32 v227, s20, v147
    v_cvt_pk_bf16_f32 v6, v224, v225
    v_cvt_pk_bf16_f32 v7, v226, v227
    v_add_u32 v9, 98304, v3
    buffer_store_dwordx2 v[6:7], v9, s[8:11], 0 offen
    s_nop 1
    v_mov_b32 v224, 0
    v_mov_b32 v225, 0
    v_mov_b32 v226, 0
    v_mov_b32 v227, 0
    v_readlane_b32 s20, v32, 13
    s_nop 1
    v_fmac_f32 v224, s20, v64
    v_fmac_f32 v225, s20, v65
    v_fmac_f32 v226, s20, v66
    v_fmac_f32 v227, s20, v67
    v_readlane_b32 s20, v33, 13
    s_nop 1
    v_fmac_f32 v224, s20, v68
    v_fmac_f32 v225, s20, v69
    v_fmac_f32 v226, s20, v70
    v_fmac_f32 v227, s20, v71
    v_readlane_b32 s20, v34, 13
    s_nop 1
    v_fmac_f32 v224, s20, v72
    v_fmac_f32 v225, s20, v73
    v_fmac_f32 v226, s20, v74
    v_fmac_f32 v227, s20, v75
    v_readlane_b32 s20, v35, 13
    s_nop 1
    v_fmac_f32 v224, s20, v76
    v_fmac_f32 v225, s20, v77
    v_fmac_f32 v226, s20, v78
    v_fmac_f32 v227, s20, v79
    v_readlane_b32 s20, v32, 29
    s_nop 1
    v_fmac_f32 v224, s20, v80
    v_fmac_f32 v225, s20, v81
    v_fmac_f32 v226, s20, v82
    v_fmac_f32 v227, s20, v83
    v_readlane_b32 s20, v33, 29
    s_nop 1
    v_fmac_f32 v224, s20, v84
    v_fmac_f32 v225, s20, v85
    v_fmac_f32 v226, s20, v86
    v_fmac_f32 v227, s20, v87
    v_readlane_b32 s20, v34, 29
    s_nop 1
    v_fmac_f32 v224, s20, v88
    v_fmac_f32 v225, s20, v89
    v_fmac_f32 v226, s20, v90
    v_fmac_f32 v227, s20, v91
    v_readlane_b32 s20, v35, 29
    s_nop 1
    v_fmac_f32 v224, s20, v92
    v_fmac_f32 v225, s20, v93
    v_fmac_f32 v226, s20, v94
    v_fmac_f32 v227, s20, v95
    v_readlane_b32 s20, v32, 45
    s_nop 1
    v_fmac_f32 v224, s20, v96
    v_fmac_f32 v225, s20, v97
    v_fmac_f32 v226, s20, v98
    v_fmac_f32 v227, s20, v99
    v_readlane_b32 s20, v33, 45
    s_nop 1
    v_fmac_f32 v224, s20, v100
    v_fmac_f32 v225, s20, v101
    v_fmac_f32 v226, s20, v102
    v_fmac_f32 v227, s20, v103
    v_readlane_b32 s20, v34, 45
    s_nop 1
    v_fmac_f32 v224, s20, v104
    v_fmac_f32 v225, s20, v105
    v_fmac_f32 v226, s20, v106
    v_fmac_f32 v227, s20, v107
    v_readlane_b32 s20, v35, 45
    s_nop 1
    v_fmac_f32 v224, s20, v108
    v_fmac_f32 v225, s20, v109
    v_fmac_f32 v226, s20, v110
    v_fmac_f32 v227, s20, v111
    v_readlane_b32 s20, v32, 61
    s_nop 1
    v_fmac_f32 v224, s20, v112
    v_fmac_f32 v225, s20, v113
    v_fmac_f32 v226, s20, v114
    v_fmac_f32 v227, s20, v115
    v_readlane_b32 s20, v33, 61
    s_nop 1
    v_fmac_f32 v224, s20, v116
    v_fmac_f32 v225, s20, v117
    v_fmac_f32 v226, s20, v118
    v_fmac_f32 v227, s20, v119
    v_readlane_b32 s20, v34, 61
    s_nop 1
    v_fmac_f32 v224, s20, v120
    v_fmac_f32 v225, s20, v121
    v_fmac_f32 v226, s20, v122
    v_fmac_f32 v227, s20, v123
    v_readlane_b32 s20, v35, 61
    s_nop 1
    v_fmac_f32 v224, s20, v124
    v_fmac_f32 v225, s20, v125
    v_fmac_f32 v226, s20, v126
    v_fmac_f32 v227, s20, v127
    v_readlane_b32 s20, v40, 13
    s_nop 1
    v_fmac_f32 v224, s20, v128
    v_fmac_f32 v225, s20, v129
    v_fmac_f32 v226, s20, v130
    v_fmac_f32 v227, s20, v131
    v_readlane_b32 s20, v41, 13
    s_nop 1
    v_fmac_f32 v224, s20, v132
    v_fmac_f32 v225, s20, v133
    v_fmac_f32 v226, s20, v134
    v_fmac_f32 v227, s20, v135
    v_readlane_b32 s20, v42, 13
    s_nop 1
    v_fmac_f32 v224, s20, v136
    v_fmac_f32 v225, s20, v137
    v_fmac_f32 v226, s20, v138
    v_fmac_f32 v227, s20, v139
    v_readlane_b32 s20, v43, 13
    s_nop 1
    v_fmac_f32 v224, s20, v140
    v_fmac_f32 v225, s20, v141
    v_fmac_f32 v226, s20, v142
    v_fmac_f32 v227, s20, v143
    v_readlane_b32 s20, v40, 29
    s_nop 1
    v_fmac_f32 v224, s20, v144
    v_fmac_f32 v225, s20, v145
    v_fmac_f32 v226, s20, v146
    v_fmac_f32 v227, s20, v147
    v_readlane_b32 s20, v41, 29
    s_nop 1
    v_fmac_f32 v224, s20, v148
    v_fmac_f32 v225, s20, v149
    v_fmac_f32 v226, s20, v150
    v_fmac_f32 v227, s20, v151
    v_cvt_pk_bf16_f32 v6, v224, v225
    v_cvt_pk_bf16_f32 v7, v226, v227
    v_add_u32 v9, 106496, v3
    buffer_store_dwordx2 v[6:7], v9, s[8:11], 0 offen
    s_nop 1
    v_mov_b32 v224, 0
    v_mov_b32 v225, 0
    v_mov_b32 v226, 0
    v_mov_b32 v227, 0
    v_readlane_b32 s20, v32, 14
    s_nop 1
    v_fmac_f32 v224, s20, v64
    v_fmac_f32 v225, s20, v65
    v_fmac_f32 v226, s20, v66
    v_fmac_f32 v227, s20, v67
    v_readlane_b32 s20, v33, 14
    s_nop 1
    v_fmac_f32 v224, s20, v68
    v_fmac_f32 v225, s20, v69
    v_fmac_f32 v226, s20, v70
    v_fmac_f32 v227, s20, v71
    v_readlane_b32 s20, v34, 14
    s_nop 1
    v_fmac_f32 v224, s20, v72
    v_fmac_f32 v225, s20, v73
    v_fmac_f32 v226, s20, v74
    v_fmac_f32 v227, s20, v75
    v_readlane_b32 s20, v35, 14
    s_nop 1
    v_fmac_f32 v224, s20, v76
    v_fmac_f32 v225, s20, v77
    v_fmac_f32 v226, s20, v78
    v_fmac_f32 v227, s20, v79
    v_readlane_b32 s20, v32, 30
    s_nop 1
    v_fmac_f32 v224, s20, v80
    v_fmac_f32 v225, s20, v81
    v_fmac_f32 v226, s20, v82
    v_fmac_f32 v227, s20, v83
    v_readlane_b32 s20, v33, 30
    s_nop 1
    v_fmac_f32 v224, s20, v84
    v_fmac_f32 v225, s20, v85
    v_fmac_f32 v226, s20, v86
    v_fmac_f32 v227, s20, v87
    v_readlane_b32 s20, v34, 30
    s_nop 1
    v_fmac_f32 v224, s20, v88
    v_fmac_f32 v225, s20, v89
    v_fmac_f32 v226, s20, v90
    v_fmac_f32 v227, s20, v91
    v_readlane_b32 s20, v35, 30
    s_nop 1
    v_fmac_f32 v224, s20, v92
    v_fmac_f32 v225, s20, v93
    v_fmac_f32 v226, s20, v94
    v_fmac_f32 v227, s20, v95
    v_readlane_b32 s20, v32, 46
    s_nop 1
    v_fmac_f32 v224, s20, v96
    v_fmac_f32 v225, s20, v97
    v_fmac_f32 v226, s20, v98
    v_fmac_f32 v227, s20, v99
    v_readlane_b32 s20, v33, 46
    s_nop 1
    v_fmac_f32 v224, s20, v100
    v_fmac_f32 v225, s20, v101
    v_fmac_f32 v226, s20, v102
    v_fmac_f32 v227, s20, v103
    v_readlane_b32 s20, v34, 46
    s_nop 1
    v_fmac_f32 v224, s20, v104
    v_fmac_f32 v225, s20, v105
    v_fmac_f32 v226, s20, v106
    v_fmac_f32 v227, s20, v107
    v_readlane_b32 s20, v35, 46
    s_nop 1
    v_fmac_f32 v224, s20, v108
    v_fmac_f32 v225, s20, v109
    v_fmac_f32 v226, s20, v110
    v_fmac_f32 v227, s20, v111
    v_readlane_b32 s20, v32, 62
    s_nop 1
    v_fmac_f32 v224, s20, v112
    v_fmac_f32 v225, s20, v113
    v_fmac_f32 v226, s20, v114
    v_fmac_f32 v227, s20, v115
    v_readlane_b32 s20, v33, 62
    s_nop 1
    v_fmac_f32 v224, s20, v116
    v_fmac_f32 v225, s20, v117
    v_fmac_f32 v226, s20, v118
    v_fmac_f32 v227, s20, v119
    v_readlane_b32 s20, v34, 62
    s_nop 1
    v_fmac_f32 v224, s20, v120
    v_fmac_f32 v225, s20, v121
    v_fmac_f32 v226, s20, v122
    v_fmac_f32 v227, s20, v123
    v_readlane_b32 s20, v35, 62
    s_nop 1
    v_fmac_f32 v224, s20, v124
    v_fmac_f32 v225, s20, v125
    v_fmac_f32 v226, s20, v126
    v_fmac_f32 v227, s20, v127
    v_readlane_b32 s20, v40, 14
    s_nop 1
    v_fmac_f32 v224, s20, v128
    v_fmac_f32 v225, s20, v129
    v_fmac_f32 v226, s20, v130
    v_fmac_f32 v227, s20, v131
    v_readlane_b32 s20, v41, 14
    s_nop 1
    v_fmac_f32 v224, s20, v132
    v_fmac_f32 v225, s20, v133
    v_fmac_f32 v226, s20, v134
    v_fmac_f32 v227, s20, v135
    v_readlane_b32 s20, v42, 14
    s_nop 1
    v_fmac_f32 v224, s20, v136
    v_fmac_f32 v225, s20, v137
    v_fmac_f32 v226, s20, v138
    v_fmac_f32 v227, s20, v139
    v_readlane_b32 s20, v43, 14
    s_nop 1
    v_fmac_f32 v224, s20, v140
    v_fmac_f32 v225, s20, v141
    v_fmac_f32 v226, s20, v142
    v_fmac_f32 v227, s20, v143
    v_readlane_b32 s20, v40, 30
    s_nop 1
    v_fmac_f32 v224, s20, v144
    v_fmac_f32 v225, s20, v145
    v_fmac_f32 v226, s20, v146
    v_fmac_f32 v227, s20, v147
    v_readlane_b32 s20, v41, 30
    s_nop 1
    v_fmac_f32 v224, s20, v148
    v_fmac_f32 v225, s20, v149
    v_fmac_f32 v226, s20, v150
    v_fmac_f32 v227, s20, v151
    v_readlane_b32 s20, v42, 30
    s_nop 1
    v_fmac_f32 v224, s20, v152
    v_fmac_f32 v225, s20, v153
    v_fmac_f32 v226, s20, v154
    v_fmac_f32 v227, s20, v155
    v_cvt_pk_bf16_f32 v6, v224, v225
    v_cvt_pk_bf16_f32 v7, v226, v227
    v_add_u32 v9, 114688, v3
    buffer_store_dwordx2 v[6:7], v9, s[8:11], 0 offen
    s_nop 1
    v_mov_b32 v224, 0
    v_mov_b32 v225, 0
    v_mov_b32 v226, 0
    v_mov_b32 v227, 0
    v_readlane_b32 s20, v32, 15
    s_nop 1
    v_fmac_f32 v224, s20, v64
    v_fmac_f32 v225, s20, v65
    v_fmac_f32 v226, s20, v66
    v_fmac_f32 v227, s20, v67
    v_readlane_b32 s20, v33, 15
    s_nop 1
    v_fmac_f32 v224, s20, v68
    v_fmac_f32 v225, s20, v69
    v_fmac_f32 v226, s20, v70
    v_fmac_f32 v227, s20, v71
    v_readlane_b32 s20, v34, 15
    s_nop 1
    v_fmac_f32 v224, s20, v72
    v_fmac_f32 v225, s20, v73
    v_fmac_f32 v226, s20, v74
    v_fmac_f32 v227, s20, v75
    v_readlane_b32 s20, v35, 15
    s_nop 1
    v_fmac_f32 v224, s20, v76
    v_fmac_f32 v225, s20, v77
    v_fmac_f32 v226, s20, v78
    v_fmac_f32 v227, s20, v79
    v_readlane_b32 s20, v32, 31
    s_nop 1
    v_fmac_f32 v224, s20, v80
    v_fmac_f32 v225, s20, v81
    v_fmac_f32 v226, s20, v82
    v_fmac_f32 v227, s20, v83
    v_readlane_b32 s20, v33, 31
    s_nop 1
    v_fmac_f32 v224, s20, v84
    v_fmac_f32 v225, s20, v85
    v_fmac_f32 v226, s20, v86
    v_fmac_f32 v227, s20, v87
    v_readlane_b32 s20, v34, 31
    s_nop 1
    v_fmac_f32 v224, s20, v88
    v_fmac_f32 v225, s20, v89
    v_fmac_f32 v226, s20, v90
    v_fmac_f32 v227, s20, v91
    v_readlane_b32 s20, v35, 31
    s_nop 1
    v_fmac_f32 v224, s20, v92
    v_fmac_f32 v225, s20, v93
    v_fmac_f32 v226, s20, v94
    v_fmac_f32 v227, s20, v95
    v_readlane_b32 s20, v32, 47
    s_nop 1
    v_fmac_f32 v224, s20, v96
    v_fmac_f32 v225, s20, v97
    v_fmac_f32 v226, s20, v98
    v_fmac_f32 v227, s20, v99
    v_readlane_b32 s20, v33, 47
    s_nop 1
    v_fmac_f32 v224, s20, v100
    v_fmac_f32 v225, s20, v101
    v_fmac_f32 v226, s20, v102
    v_fmac_f32 v227, s20, v103
    v_readlane_b32 s20, v34, 47
    s_nop 1
    v_fmac_f32 v224, s20, v104
    v_fmac_f32 v225, s20, v105
    v_fmac_f32 v226, s20, v106
    v_fmac_f32 v227, s20, v107
    v_readlane_b32 s20, v35, 47
    s_nop 1
    v_fmac_f32 v224, s20, v108
    v_fmac_f32 v225, s20, v109
    v_fmac_f32 v226, s20, v110
    v_fmac_f32 v227, s20, v111
    v_readlane_b32 s20, v32, 63
    s_nop 1
    v_fmac_f32 v224, s20, v112
    v_fmac_f32 v225, s20, v113
    v_fmac_f32 v226, s20, v114
    v_fmac_f32 v227, s20, v115
    v_readlane_b32 s20, v33, 63
    s_nop 1
    v_fmac_f32 v224, s20, v116
    v_fmac_f32 v225, s20, v117
    v_fmac_f32 v226, s20, v118
    v_fmac_f32 v227, s20, v119
    v_readlane_b32 s20, v34, 63
    s_nop 1
    v_fmac_f32 v224, s20, v120
    v_fmac_f32 v225, s20, v121
    v_fmac_f32 v226, s20, v122
    v_fmac_f32 v227, s20, v123
    v_readlane_b32 s20, v35, 63
    s_nop 1
    v_fmac_f32 v224, s20, v124
    v_fmac_f32 v225, s20, v125
    v_fmac_f32 v226, s20, v126
    v_fmac_f32 v227, s20, v127
    v_readlane_b32 s20, v40, 15
    s_nop 1
    v_fmac_f32 v224, s20, v128
    v_fmac_f32 v225, s20, v129
    v_fmac_f32 v226, s20, v130
    v_fmac_f32 v227, s20, v131
    v_readlane_b32 s20, v41, 15
    s_nop 1
    v_fmac_f32 v224, s20, v132
    v_fmac_f32 v225, s20, v133
    v_fmac_f32 v226, s20, v134
    v_fmac_f32 v227, s20, v135
    v_readlane_b32 s20, v42, 15
    s_nop 1
    v_fmac_f32 v224, s20, v136
    v_fmac_f32 v225, s20, v137
    v_fmac_f32 v226, s20, v138
    v_fmac_f32 v227, s20, v139
    v_readlane_b32 s20, v43, 15
    s_nop 1
    v_fmac_f32 v224, s20, v140
    v_fmac_f32 v225, s20, v141
    v_fmac_f32 v226, s20, v142
    v_fmac_f32 v227, s20, v143
    v_readlane_b32 s20, v40, 31
    s_nop 1
    v_fmac_f32 v224, s20, v144
    v_fmac_f32 v225, s20, v145
    v_fmac_f32 v226, s20, v146
    v_fmac_f32 v227, s20, v147
    v_readlane_b32 s20, v41, 31
    s_nop 1
    v_fmac_f32 v224, s20, v148
    v_fmac_f32 v225, s20, v149
    v_fmac_f32 v226, s20, v150
    v_fmac_f32 v227, s20, v151
    v_readlane_b32 s20, v42, 31
    s_nop 1
    v_fmac_f32 v224, s20, v152
    v_fmac_f32 v225, s20, v153
    v_fmac_f32 v226, s20, v154
    v_fmac_f32 v227, s20, v155
    v_readlane_b32 s20, v43, 31
    s_nop 1
    v_fmac_f32 v224, s20, v156
    v_fmac_f32 v225, s20, v157
    v_fmac_f32 v226, s20, v158
    v_fmac_f32 v227, s20, v159
    v_cvt_pk_bf16_f32 v6, v224, v225
    v_cvt_pk_bf16_f32 v7, v226, v227
    v_add_u32 v9, 122880, v3
    buffer_store_dwordx2 v[6:7], v9, s[8:11], 0 offen
    s_nop 1
    v_mov_b32 v224, 0
    v_mov_b32 v225, 0
    v_mov_b32 v226, 0
    v_mov_b32 v227, 0
    v_readlane_b32 s20, v36, 0
    s_nop 1
    v_fmac_f32 v224, s20, v64
    v_fmac_f32 v225, s20, v65
    v_fmac_f32 v226, s20, v66
    v_fmac_f32 v227, s20, v67
    v_readlane_b32 s20, v37, 0
    s_nop 1
    v_fmac_f32 v224, s20, v68
    v_fmac_f32 v225, s20, v69
    v_fmac_f32 v226, s20, v70
    v_fmac_f32 v227, s20, v71
    v_readlane_b32 s20, v38, 0
    s_nop 1
    v_fmac_f32 v224, s20, v72
    v_fmac_f32 v225, s20, v73
    v_fmac_f32 v226, s20, v74
    v_fmac_f32 v227, s20, v75
    v_readlane_b32 s20, v39, 0
    s_nop 1
    v_fmac_f32 v224, s20, v76
    v_fmac_f32 v225, s20, v77
    v_fmac_f32 v226, s20, v78
    v_fmac_f32 v227, s20, v79
    v_readlane_b32 s20, v36, 16
    s_nop 1
    v_fmac_f32 v224, s20, v80
    v_fmac_f32 v225, s20, v81
    v_fmac_f32 v226, s20, v82
    v_fmac_f32 v227, s20, v83
    v_readlane_b32 s20, v37, 16
    s_nop 1
    v_fmac_f32 v224, s20, v84
    v_fmac_f32 v225, s20, v85
    v_fmac_f32 v226, s20, v86
    v_fmac_f32 v227, s20, v87
    v_readlane_b32 s20, v38, 16
    s_nop 1
    v_fmac_f32 v224, s20, v88
    v_fmac_f32 v225, s20, v89
    v_fmac_f32 v226, s20, v90
    v_fmac_f32 v227, s20, v91
    v_readlane_b32 s20, v39, 16
    s_nop 1
    v_fmac_f32 v224, s20, v92
    v_fmac_f32 v225, s20, v93
    v_fmac_f32 v226, s20, v94
    v_fmac_f32 v227, s20, v95
    v_readlane_b32 s20, v36, 32
    s_nop 1
    v_fmac_f32 v224, s20, v96
    v_fmac_f32 v225, s20, v97
    v_fmac_f32 v226, s20, v98
    v_fmac_f32 v227, s20, v99
    v_readlane_b32 s20, v37, 32
    s_nop 1
    v_fmac_f32 v224, s20, v100
    v_fmac_f32 v225, s20, v101
    v_fmac_f32 v226, s20, v102
    v_fmac_f32 v227, s20, v103
    v_readlane_b32 s20, v38, 32
    s_nop 1
    v_fmac_f32 v224, s20, v104
    v_fmac_f32 v225, s20, v105
    v_fmac_f32 v226, s20, v106
    v_fmac_f32 v227, s20, v107
    v_readlane_b32 s20, v39, 32
    s_nop 1
    v_fmac_f32 v224, s20, v108
    v_fmac_f32 v225, s20, v109
    v_fmac_f32 v226, s20, v110
    v_fmac_f32 v227, s20, v111
    v_readlane_b32 s20, v36, 48
    s_nop 1
    v_fmac_f32 v224, s20, v112
    v_fmac_f32 v225, s20, v113
    v_fmac_f32 v226, s20, v114
    v_fmac_f32 v227, s20, v115
    v_readlane_b32 s20, v37, 48
    s_nop 1
    v_fmac_f32 v224, s20, v116
    v_fmac_f32 v225, s20, v117
    v_fmac_f32 v226, s20, v118
    v_fmac_f32 v227, s20, v119
    v_readlane_b32 s20, v38, 48
    s_nop 1
    v_fmac_f32 v224, s20, v120
    v_fmac_f32 v225, s20, v121
    v_fmac_f32 v226, s20, v122
    v_fmac_f32 v227, s20, v123
    v_readlane_b32 s20, v39, 48
    s_nop 1
    v_fmac_f32 v224, s20, v124
    v_fmac_f32 v225, s20, v125
    v_fmac_f32 v226, s20, v126
    v_fmac_f32 v227, s20, v127
    v_readlane_b32 s20, v44, 0
    s_nop 1
    v_fmac_f32 v224, s20, v128
    v_fmac_f32 v225, s20, v129
    v_fmac_f32 v226, s20, v130
    v_fmac_f32 v227, s20, v131
    v_readlane_b32 s20, v45, 0
    s_nop 1
    v_fmac_f32 v224, s20, v132
    v_fmac_f32 v225, s20, v133
    v_fmac_f32 v226, s20, v134
    v_fmac_f32 v227, s20, v135
    v_readlane_b32 s20, v46, 0
    s_nop 1
    v_fmac_f32 v224, s20, v136
    v_fmac_f32 v225, s20, v137
    v_fmac_f32 v226, s20, v138
    v_fmac_f32 v227, s20, v139
    v_readlane_b32 s20, v47, 0
    s_nop 1
    v_fmac_f32 v224, s20, v140
    v_fmac_f32 v225, s20, v141
    v_fmac_f32 v226, s20, v142
    v_fmac_f32 v227, s20, v143
    v_readlane_b32 s20, v44, 16
    s_nop 1
    v_fmac_f32 v224, s20, v144
    v_fmac_f32 v225, s20, v145
    v_fmac_f32 v226, s20, v146
    v_fmac_f32 v227, s20, v147
    v_readlane_b32 s20, v45, 16
    s_nop 1
    v_fmac_f32 v224, s20, v148
    v_fmac_f32 v225, s20, v149
    v_fmac_f32 v226, s20, v150
    v_fmac_f32 v227, s20, v151
    v_readlane_b32 s20, v46, 16
    s_nop 1
    v_fmac_f32 v224, s20, v152
    v_fmac_f32 v225, s20, v153
    v_fmac_f32 v226, s20, v154
    v_fmac_f32 v227, s20, v155
    v_readlane_b32 s20, v47, 16
    s_nop 1
    v_fmac_f32 v224, s20, v156
    v_fmac_f32 v225, s20, v157
    v_fmac_f32 v226, s20, v158
    v_fmac_f32 v227, s20, v159
    v_readlane_b32 s20, v44, 32
    s_nop 1
    v_fmac_f32 v224, s20, v160
    v_fmac_f32 v225, s20, v161
    v_fmac_f32 v226, s20, v162
    v_fmac_f32 v227, s20, v163
    v_cvt_pk_bf16_f32 v6, v224, v225
    v_cvt_pk_bf16_f32 v7, v226, v227
    v_add_u32 v9, 131072, v3
    buffer_store_dwordx2 v[6:7], v9, s[8:11], 0 offen
    s_nop 1
    v_mov_b32 v224, 0
    v_mov_b32 v225, 0
    v_mov_b32 v226, 0
    v_mov_b32 v227, 0
    v_readlane_b32 s20, v36, 1
    s_nop 1
    v_fmac_f32 v224, s20, v64
    v_fmac_f32 v225, s20, v65
    v_fmac_f32 v226, s20, v66
    v_fmac_f32 v227, s20, v67
    v_readlane_b32 s20, v37, 1
    s_nop 1
    v_fmac_f32 v224, s20, v68
    v_fmac_f32 v225, s20, v69
    v_fmac_f32 v226, s20, v70
    v_fmac_f32 v227, s20, v71
    v_readlane_b32 s20, v38, 1
    s_nop 1
    v_fmac_f32 v224, s20, v72
    v_fmac_f32 v225, s20, v73
    v_fmac_f32 v226, s20, v74
    v_fmac_f32 v227, s20, v75
    v_readlane_b32 s20, v39, 1
    s_nop 1
    v_fmac_f32 v224, s20, v76
    v_fmac_f32 v225, s20, v77
    v_fmac_f32 v226, s20, v78
    v_fmac_f32 v227, s20, v79
    v_readlane_b32 s20, v36, 17
    s_nop 1
    v_fmac_f32 v224, s20, v80
    v_fmac_f32 v225, s20, v81
    v_fmac_f32 v226, s20, v82
    v_fmac_f32 v227, s20, v83
    v_readlane_b32 s20, v37, 17
    s_nop 1
    v_fmac_f32 v224, s20, v84
    v_fmac_f32 v225, s20, v85
    v_fmac_f32 v226, s20, v86
    v_fmac_f32 v227, s20, v87
    v_readlane_b32 s20, v38, 17
    s_nop 1
    v_fmac_f32 v224, s20, v88
    v_fmac_f32 v225, s20, v89
    v_fmac_f32 v226, s20, v90
    v_fmac_f32 v227, s20, v91
    v_readlane_b32 s20, v39, 17
    s_nop 1
    v_fmac_f32 v224, s20, v92
    v_fmac_f32 v225, s20, v93
    v_fmac_f32 v226, s20, v94
    v_fmac_f32 v227, s20, v95
    v_readlane_b32 s20, v36, 33
    s_nop 1
    v_fmac_f32 v224, s20, v96
    v_fmac_f32 v225, s20, v97
    v_fmac_f32 v226, s20, v98
    v_fmac_f32 v227, s20, v99
    v_readlane_b32 s20, v37, 33
    s_nop 1
    v_fmac_f32 v224, s20, v100
    v_fmac_f32 v225, s20, v101
    v_fmac_f32 v226, s20, v102
    v_fmac_f32 v227, s20, v103
    v_readlane_b32 s20, v38, 33
    s_nop 1
    v_fmac_f32 v224, s20, v104
    v_fmac_f32 v225, s20, v105
    v_fmac_f32 v226, s20, v106
    v_fmac_f32 v227, s20, v107
    v_readlane_b32 s20, v39, 33
    s_nop 1
    v_fmac_f32 v224, s20, v108
    v_fmac_f32 v225, s20, v109
    v_fmac_f32 v226, s20, v110
    v_fmac_f32 v227, s20, v111
    v_readlane_b32 s20, v36, 49
    s_nop 1
    v_fmac_f32 v224, s20, v112
    v_fmac_f32 v225, s20, v113
    v_fmac_f32 v226, s20, v114
    v_fmac_f32 v227, s20, v115
    v_readlane_b32 s20, v37, 49
    s_nop 1
    v_fmac_f32 v224, s20, v116
    v_fmac_f32 v225, s20, v117
    v_fmac_f32 v226, s20, v118
    v_fmac_f32 v227, s20, v119
    v_readlane_b32 s20, v38, 49
    s_nop 1
    v_fmac_f32 v224, s20, v120
    v_fmac_f32 v225, s20, v121
    v_fmac_f32 v226, s20, v122
    v_fmac_f32 v227, s20, v123
    v_readlane_b32 s20, v39, 49
    s_nop 1
    v_fmac_f32 v224, s20, v124
    v_fmac_f32 v225, s20, v125
    v_fmac_f32 v226, s20, v126
    v_fmac_f32 v227, s20, v127
    v_readlane_b32 s20, v44, 1
    s_nop 1
    v_fmac_f32 v224, s20, v128
    v_fmac_f32 v225, s20, v129
    v_fmac_f32 v226, s20, v130
    v_fmac_f32 v227, s20, v131
    v_readlane_b32 s20, v45, 1
    s_nop 1
    v_fmac_f32 v224, s20, v132
    v_fmac_f32 v225, s20, v133
    v_fmac_f32 v226, s20, v134
    v_fmac_f32 v227, s20, v135
    v_readlane_b32 s20, v46, 1
    s_nop 1
    v_fmac_f32 v224, s20, v136
    v_fmac_f32 v225, s20, v137
    v_fmac_f32 v226, s20, v138
    v_fmac_f32 v227, s20, v139
    v_readlane_b32 s20, v47, 1
    s_nop 1
    v_fmac_f32 v224, s20, v140
    v_fmac_f32 v225, s20, v141
    v_fmac_f32 v226, s20, v142
    v_fmac_f32 v227, s20, v143
    v_readlane_b32 s20, v44, 17
    s_nop 1
    v_fmac_f32 v224, s20, v144
    v_fmac_f32 v225, s20, v145
    v_fmac_f32 v226, s20, v146
    v_fmac_f32 v227, s20, v147
    v_readlane_b32 s20, v45, 17
    s_nop 1
    v_fmac_f32 v224, s20, v148
    v_fmac_f32 v225, s20, v149
    v_fmac_f32 v226, s20, v150
    v_fmac_f32 v227, s20, v151
    v_readlane_b32 s20, v46, 17
    s_nop 1
    v_fmac_f32 v224, s20, v152
    v_fmac_f32 v225, s20, v153
    v_fmac_f32 v226, s20, v154
    v_fmac_f32 v227, s20, v155
    v_readlane_b32 s20, v47, 17
    s_nop 1
    v_fmac_f32 v224, s20, v156
    v_fmac_f32 v225, s20, v157
    v_fmac_f32 v226, s20, v158
    v_fmac_f32 v227, s20, v159
    v_readlane_b32 s20, v44, 33
    s_nop 1
    v_fmac_f32 v224, s20, v160
    v_fmac_f32 v225, s20, v161
    v_fmac_f32 v226, s20, v162
    v_fmac_f32 v227, s20, v163
    v_readlane_b32 s20, v45, 33
    s_nop 1
    v_fmac_f32 v224, s20, v164
    v_fmac_f32 v225, s20, v165
    v_fmac_f32 v226, s20, v166
    v_fmac_f32 v227, s20, v167
    v_cvt_pk_bf16_f32 v6, v224, v225
    v_cvt_pk_bf16_f32 v7, v226, v227
    v_add_u32 v9, 139264, v3
    buffer_store_dwordx2 v[6:7], v9, s[8:11], 0 offen
    s_nop 1
    v_mov_b32 v224, 0
    v_mov_b32 v225, 0
    v_mov_b32 v226, 0
    v_mov_b32 v227, 0
    v_readlane_b32 s20, v36, 2
    s_nop 1
    v_fmac_f32 v224, s20, v64
    v_fmac_f32 v225, s20, v65
    v_fmac_f32 v226, s20, v66
    v_fmac_f32 v227, s20, v67
    v_readlane_b32 s20, v37, 2
    s_nop 1
    v_fmac_f32 v224, s20, v68
    v_fmac_f32 v225, s20, v69
    v_fmac_f32 v226, s20, v70
    v_fmac_f32 v227, s20, v71
    v_readlane_b32 s20, v38, 2
    s_nop 1
    v_fmac_f32 v224, s20, v72
    v_fmac_f32 v225, s20, v73
    v_fmac_f32 v226, s20, v74
    v_fmac_f32 v227, s20, v75
    v_readlane_b32 s20, v39, 2
    s_nop 1
    v_fmac_f32 v224, s20, v76
    v_fmac_f32 v225, s20, v77
    v_fmac_f32 v226, s20, v78
    v_fmac_f32 v227, s20, v79
    v_readlane_b32 s20, v36, 18
    s_nop 1
    v_fmac_f32 v224, s20, v80
    v_fmac_f32 v225, s20, v81
    v_fmac_f32 v226, s20, v82
    v_fmac_f32 v227, s20, v83
    v_readlane_b32 s20, v37, 18
    s_nop 1
    v_fmac_f32 v224, s20, v84
    v_fmac_f32 v225, s20, v85
    v_fmac_f32 v226, s20, v86
    v_fmac_f32 v227, s20, v87
    v_readlane_b32 s20, v38, 18
    s_nop 1
    v_fmac_f32 v224, s20, v88
    v_fmac_f32 v225, s20, v89
    v_fmac_f32 v226, s20, v90
    v_fmac_f32 v227, s20, v91
    v_readlane_b32 s20, v39, 18
    s_nop 1
    v_fmac_f32 v224, s20, v92
    v_fmac_f32 v225, s20, v93
    v_fmac_f32 v226, s20, v94
    v_fmac_f32 v227, s20, v95
    v_readlane_b32 s20, v36, 34
    s_nop 1
    v_fmac_f32 v224, s20, v96
    v_fmac_f32 v225, s20, v97
    v_fmac_f32 v226, s20, v98
    v_fmac_f32 v227, s20, v99
    v_readlane_b32 s20, v37, 34
    s_nop 1
    v_fmac_f32 v224, s20, v100
    v_fmac_f32 v225, s20, v101
    v_fmac_f32 v226, s20, v102
    v_fmac_f32 v227, s20, v103
    v_readlane_b32 s20, v38, 34
    s_nop 1
    v_fmac_f32 v224, s20, v104
    v_fmac_f32 v225, s20, v105
    v_fmac_f32 v226, s20, v106
    v_fmac_f32 v227, s20, v107
    v_readlane_b32 s20, v39, 34
    s_nop 1
    v_fmac_f32 v224, s20, v108
    v_fmac_f32 v225, s20, v109
    v_fmac_f32 v226, s20, v110
    v_fmac_f32 v227, s20, v111
    v_readlane_b32 s20, v36, 50
    s_nop 1
    v_fmac_f32 v224, s20, v112
    v_fmac_f32 v225, s20, v113
    v_fmac_f32 v226, s20, v114
    v_fmac_f32 v227, s20, v115
    v_readlane_b32 s20, v37, 50
    s_nop 1
    v_fmac_f32 v224, s20, v116
    v_fmac_f32 v225, s20, v117
    v_fmac_f32 v226, s20, v118
    v_fmac_f32 v227, s20, v119
    v_readlane_b32 s20, v38, 50
    s_nop 1
    v_fmac_f32 v224, s20, v120
    v_fmac_f32 v225, s20, v121
    v_fmac_f32 v226, s20, v122
    v_fmac_f32 v227, s20, v123
    v_readlane_b32 s20, v39, 50
    s_nop 1
    v_fmac_f32 v224, s20, v124
    v_fmac_f32 v225, s20, v125
    v_fmac_f32 v226, s20, v126
    v_fmac_f32 v227, s20, v127
    v_readlane_b32 s20, v44, 2
    s_nop 1
    v_fmac_f32 v224, s20, v128
    v_fmac_f32 v225, s20, v129
    v_fmac_f32 v226, s20, v130
    v_fmac_f32 v227, s20, v131
    v_readlane_b32 s20, v45, 2
    s_nop 1
    v_fmac_f32 v224, s20, v132
    v_fmac_f32 v225, s20, v133
    v_fmac_f32 v226, s20, v134
    v_fmac_f32 v227, s20, v135
    v_readlane_b32 s20, v46, 2
    s_nop 1
    v_fmac_f32 v224, s20, v136
    v_fmac_f32 v225, s20, v137
    v_fmac_f32 v226, s20, v138
    v_fmac_f32 v227, s20, v139
    v_readlane_b32 s20, v47, 2
    s_nop 1
    v_fmac_f32 v224, s20, v140
    v_fmac_f32 v225, s20, v141
    v_fmac_f32 v226, s20, v142
    v_fmac_f32 v227, s20, v143
    v_readlane_b32 s20, v44, 18
    s_nop 1
    v_fmac_f32 v224, s20, v144
    v_fmac_f32 v225, s20, v145
    v_fmac_f32 v226, s20, v146
    v_fmac_f32 v227, s20, v147
    v_readlane_b32 s20, v45, 18
    s_nop 1
    v_fmac_f32 v224, s20, v148
    v_fmac_f32 v225, s20, v149
    v_fmac_f32 v226, s20, v150
    v_fmac_f32 v227, s20, v151
    v_readlane_b32 s20, v46, 18
    s_nop 1
    v_fmac_f32 v224, s20, v152
    v_fmac_f32 v225, s20, v153
    v_fmac_f32 v226, s20, v154
    v_fmac_f32 v227, s20, v155
    v_readlane_b32 s20, v47, 18
    s_nop 1
    v_fmac_f32 v224, s20, v156
    v_fmac_f32 v225, s20, v157
    v_fmac_f32 v226, s20, v158
    v_fmac_f32 v227, s20, v159
    v_readlane_b32 s20, v44, 34
    s_nop 1
    v_fmac_f32 v224, s20, v160
    v_fmac_f32 v225, s20, v161
    v_fmac_f32 v226, s20, v162
    v_fmac_f32 v227, s20, v163
    v_readlane_b32 s20, v45, 34
    s_nop 1
    v_fmac_f32 v224, s20, v164
    v_fmac_f32 v225, s20, v165
    v_fmac_f32 v226, s20, v166
    v_fmac_f32 v227, s20, v167
    v_readlane_b32 s20, v46, 34
    s_nop 1
    v_fmac_f32 v224, s20, v168
    v_fmac_f32 v225, s20, v169
    v_fmac_f32 v226, s20, v170
    v_fmac_f32 v227, s20, v171
    v_cvt_pk_bf16_f32 v6, v224, v225
    v_cvt_pk_bf16_f32 v7, v226, v227
    v_add_u32 v9, 147456, v3
    buffer_store_dwordx2 v[6:7], v9, s[8:11], 0 offen
    s_nop 1
    v_mov_b32 v224, 0
    v_mov_b32 v225, 0
    v_mov_b32 v226, 0
    v_mov_b32 v227, 0
    v_readlane_b32 s20, v36, 3
    s_nop 1
    v_fmac_f32 v224, s20, v64
    v_fmac_f32 v225, s20, v65
    v_fmac_f32 v226, s20, v66
    v_fmac_f32 v227, s20, v67
    v_readlane_b32 s20, v37, 3
    s_nop 1
    v_fmac_f32 v224, s20, v68
    v_fmac_f32 v225, s20, v69
    v_fmac_f32 v226, s20, v70
    v_fmac_f32 v227, s20, v71
    v_readlane_b32 s20, v38, 3
    s_nop 1
    v_fmac_f32 v224, s20, v72
    v_fmac_f32 v225, s20, v73
    v_fmac_f32 v226, s20, v74
    v_fmac_f32 v227, s20, v75
    v_readlane_b32 s20, v39, 3
    s_nop 1
    v_fmac_f32 v224, s20, v76
    v_fmac_f32 v225, s20, v77
    v_fmac_f32 v226, s20, v78
    v_fmac_f32 v227, s20, v79
    v_readlane_b32 s20, v36, 19
    s_nop 1
    v_fmac_f32 v224, s20, v80
    v_fmac_f32 v225, s20, v81
    v_fmac_f32 v226, s20, v82
    v_fmac_f32 v227, s20, v83
    v_readlane_b32 s20, v37, 19
    s_nop 1
    v_fmac_f32 v224, s20, v84
    v_fmac_f32 v225, s20, v85
    v_fmac_f32 v226, s20, v86
    v_fmac_f32 v227, s20, v87
    v_readlane_b32 s20, v38, 19
    s_nop 1
    v_fmac_f32 v224, s20, v88
    v_fmac_f32 v225, s20, v89
    v_fmac_f32 v226, s20, v90
    v_fmac_f32 v227, s20, v91
    v_readlane_b32 s20, v39, 19
    s_nop 1
    v_fmac_f32 v224, s20, v92
    v_fmac_f32 v225, s20, v93
    v_fmac_f32 v226, s20, v94
    v_fmac_f32 v227, s20, v95
    v_readlane_b32 s20, v36, 35
    s_nop 1
    v_fmac_f32 v224, s20, v96
    v_fmac_f32 v225, s20, v97
    v_fmac_f32 v226, s20, v98
    v_fmac_f32 v227, s20, v99
    v_readlane_b32 s20, v37, 35
    s_nop 1
    v_fmac_f32 v224, s20, v100
    v_fmac_f32 v225, s20, v101
    v_fmac_f32 v226, s20, v102
    v_fmac_f32 v227, s20, v103
    v_readlane_b32 s20, v38, 35
    s_nop 1
    v_fmac_f32 v224, s20, v104
    v_fmac_f32 v225, s20, v105
    v_fmac_f32 v226, s20, v106
    v_fmac_f32 v227, s20, v107
    v_readlane_b32 s20, v39, 35
    s_nop 1
    v_fmac_f32 v224, s20, v108
    v_fmac_f32 v225, s20, v109
    v_fmac_f32 v226, s20, v110
    v_fmac_f32 v227, s20, v111
    v_readlane_b32 s20, v36, 51
    s_nop 1
    v_fmac_f32 v224, s20, v112
    v_fmac_f32 v225, s20, v113
    v_fmac_f32 v226, s20, v114
    v_fmac_f32 v227, s20, v115
    v_readlane_b32 s20, v37, 51
    s_nop 1
    v_fmac_f32 v224, s20, v116
    v_fmac_f32 v225, s20, v117
    v_fmac_f32 v226, s20, v118
    v_fmac_f32 v227, s20, v119
    v_readlane_b32 s20, v38, 51
    s_nop 1
    v_fmac_f32 v224, s20, v120
    v_fmac_f32 v225, s20, v121
    v_fmac_f32 v226, s20, v122
    v_fmac_f32 v227, s20, v123
    v_readlane_b32 s20, v39, 51
    s_nop 1
    v_fmac_f32 v224, s20, v124
    v_fmac_f32 v225, s20, v125
    v_fmac_f32 v226, s20, v126
    v_fmac_f32 v227, s20, v127
    v_readlane_b32 s20, v44, 3
    s_nop 1
    v_fmac_f32 v224, s20, v128
    v_fmac_f32 v225, s20, v129
    v_fmac_f32 v226, s20, v130
    v_fmac_f32 v227, s20, v131
    v_readlane_b32 s20, v45, 3
    s_nop 1
    v_fmac_f32 v224, s20, v132
    v_fmac_f32 v225, s20, v133
    v_fmac_f32 v226, s20, v134
    v_fmac_f32 v227, s20, v135
    v_readlane_b32 s20, v46, 3
    s_nop 1
    v_fmac_f32 v224, s20, v136
    v_fmac_f32 v225, s20, v137
    v_fmac_f32 v226, s20, v138
    v_fmac_f32 v227, s20, v139
    v_readlane_b32 s20, v47, 3
    s_nop 1
    v_fmac_f32 v224, s20, v140
    v_fmac_f32 v225, s20, v141
    v_fmac_f32 v226, s20, v142
    v_fmac_f32 v227, s20, v143
    v_readlane_b32 s20, v44, 19
    s_nop 1
    v_fmac_f32 v224, s20, v144
    v_fmac_f32 v225, s20, v145
    v_fmac_f32 v226, s20, v146
    v_fmac_f32 v227, s20, v147
    v_readlane_b32 s20, v45, 19
    s_nop 1
    v_fmac_f32 v224, s20, v148
    v_fmac_f32 v225, s20, v149
    v_fmac_f32 v226, s20, v150
    v_fmac_f32 v227, s20, v151
    v_readlane_b32 s20, v46, 19
    s_nop 1
    v_fmac_f32 v224, s20, v152
    v_fmac_f32 v225, s20, v153
    v_fmac_f32 v226, s20, v154
    v_fmac_f32 v227, s20, v155
    v_readlane_b32 s20, v47, 19
    s_nop 1
    v_fmac_f32 v224, s20, v156
    v_fmac_f32 v225, s20, v157
    v_fmac_f32 v226, s20, v158
    v_fmac_f32 v227, s20, v159
    v_readlane_b32 s20, v44, 35
    s_nop 1
    v_fmac_f32 v224, s20, v160
    v_fmac_f32 v225, s20, v161
    v_fmac_f32 v226, s20, v162
    v_fmac_f32 v227, s20, v163
    v_readlane_b32 s20, v45, 35
    s_nop 1
    v_fmac_f32 v224, s20, v164
    v_fmac_f32 v225, s20, v165
    v_fmac_f32 v226, s20, v166
    v_fmac_f32 v227, s20, v167
    v_readlane_b32 s20, v46, 35
    s_nop 1
    v_fmac_f32 v224, s20, v168
    v_fmac_f32 v225, s20, v169
    v_fmac_f32 v226, s20, v170
    v_fmac_f32 v227, s20, v171
    v_readlane_b32 s20, v47, 35
    s_nop 1
    v_fmac_f32 v224, s20, v172
    v_fmac_f32 v225, s20, v173
    v_fmac_f32 v226, s20, v174
    v_fmac_f32 v227, s20, v175
    v_cvt_pk_bf16_f32 v6, v224, v225
    v_cvt_pk_bf16_f32 v7, v226, v227
    v_add_u32 v9, 155648, v3
    buffer_store_dwordx2 v[6:7], v9, s[8:11], 0 offen
    s_nop 1
    v_mov_b32 v224, 0
    v_mov_b32 v225, 0
    v_mov_b32 v226, 0
    v_mov_b32 v227, 0
    v_readlane_b32 s20, v36, 4
    s_nop 1
    v_fmac_f32 v224, s20, v64
    v_fmac_f32 v225, s20, v65
    v_fmac_f32 v226, s20, v66
    v_fmac_f32 v227, s20, v67
    v_readlane_b32 s20, v37, 4
    s_nop 1
    v_fmac_f32 v224, s20, v68
    v_fmac_f32 v225, s20, v69
    v_fmac_f32 v226, s20, v70
    v_fmac_f32 v227, s20, v71
    v_readlane_b32 s20, v38, 4
    s_nop 1
    v_fmac_f32 v224, s20, v72
    v_fmac_f32 v225, s20, v73
    v_fmac_f32 v226, s20, v74
    v_fmac_f32 v227, s20, v75
    v_readlane_b32 s20, v39, 4
    s_nop 1
    v_fmac_f32 v224, s20, v76
    v_fmac_f32 v225, s20, v77
    v_fmac_f32 v226, s20, v78
    v_fmac_f32 v227, s20, v79
    v_readlane_b32 s20, v36, 20
    s_nop 1
    v_fmac_f32 v224, s20, v80
    v_fmac_f32 v225, s20, v81
    v_fmac_f32 v226, s20, v82
    v_fmac_f32 v227, s20, v83
    v_readlane_b32 s20, v37, 20
    s_nop 1
    v_fmac_f32 v224, s20, v84
    v_fmac_f32 v225, s20, v85
    v_fmac_f32 v226, s20, v86
    v_fmac_f32 v227, s20, v87
    v_readlane_b32 s20, v38, 20
    s_nop 1
    v_fmac_f32 v224, s20, v88
    v_fmac_f32 v225, s20, v89
    v_fmac_f32 v226, s20, v90
    v_fmac_f32 v227, s20, v91
    v_readlane_b32 s20, v39, 20
    s_nop 1
    v_fmac_f32 v224, s20, v92
    v_fmac_f32 v225, s20, v93
    v_fmac_f32 v226, s20, v94
    v_fmac_f32 v227, s20, v95
    v_readlane_b32 s20, v36, 36
    s_nop 1
    v_fmac_f32 v224, s20, v96
    v_fmac_f32 v225, s20, v97
    v_fmac_f32 v226, s20, v98
    v_fmac_f32 v227, s20, v99
    v_readlane_b32 s20, v37, 36
    s_nop 1
    v_fmac_f32 v224, s20, v100
    v_fmac_f32 v225, s20, v101
    v_fmac_f32 v226, s20, v102
    v_fmac_f32 v227, s20, v103
    v_readlane_b32 s20, v38, 36
    s_nop 1
    v_fmac_f32 v224, s20, v104
    v_fmac_f32 v225, s20, v105
    v_fmac_f32 v226, s20, v106
    v_fmac_f32 v227, s20, v107
    v_readlane_b32 s20, v39, 36
    s_nop 1
    v_fmac_f32 v224, s20, v108
    v_fmac_f32 v225, s20, v109
    v_fmac_f32 v226, s20, v110
    v_fmac_f32 v227, s20, v111
    v_readlane_b32 s20, v36, 52
    s_nop 1
    v_fmac_f32 v224, s20, v112
    v_fmac_f32 v225, s20, v113
    v_fmac_f32 v226, s20, v114
    v_fmac_f32 v227, s20, v115
    v_readlane_b32 s20, v37, 52
    s_nop 1
    v_fmac_f32 v224, s20, v116
    v_fmac_f32 v225, s20, v117
    v_fmac_f32 v226, s20, v118
    v_fmac_f32 v227, s20, v119
    v_readlane_b32 s20, v38, 52
    s_nop 1
    v_fmac_f32 v224, s20, v120
    v_fmac_f32 v225, s20, v121
    v_fmac_f32 v226, s20, v122
    v_fmac_f32 v227, s20, v123
    v_readlane_b32 s20, v39, 52
    s_nop 1
    v_fmac_f32 v224, s20, v124
    v_fmac_f32 v225, s20, v125
    v_fmac_f32 v226, s20, v126
    v_fmac_f32 v227, s20, v127
    v_readlane_b32 s20, v44, 4
    s_nop 1
    v_fmac_f32 v224, s20, v128
    v_fmac_f32 v225, s20, v129
    v_fmac_f32 v226, s20, v130
    v_fmac_f32 v227, s20, v131
    v_readlane_b32 s20, v45, 4
    s_nop 1
    v_fmac_f32 v224, s20, v132
    v_fmac_f32 v225, s20, v133
    v_fmac_f32 v226, s20, v134
    v_fmac_f32 v227, s20, v135
    v_readlane_b32 s20, v46, 4
    s_nop 1
    v_fmac_f32 v224, s20, v136
    v_fmac_f32 v225, s20, v137
    v_fmac_f32 v226, s20, v138
    v_fmac_f32 v227, s20, v139
    v_readlane_b32 s20, v47, 4
    s_nop 1
    v_fmac_f32 v224, s20, v140
    v_fmac_f32 v225, s20, v141
    v_fmac_f32 v226, s20, v142
    v_fmac_f32 v227, s20, v143
    v_readlane_b32 s20, v44, 20
    s_nop 1
    v_fmac_f32 v224, s20, v144
    v_fmac_f32 v225, s20, v145
    v_fmac_f32 v226, s20, v146
    v_fmac_f32 v227, s20, v147
    v_readlane_b32 s20, v45, 20
    s_nop 1
    v_fmac_f32 v224, s20, v148
    v_fmac_f32 v225, s20, v149
    v_fmac_f32 v226, s20, v150
    v_fmac_f32 v227, s20, v151
    v_readlane_b32 s20, v46, 20
    s_nop 1
    v_fmac_f32 v224, s20, v152
    v_fmac_f32 v225, s20, v153
    v_fmac_f32 v226, s20, v154
    v_fmac_f32 v227, s20, v155
    v_readlane_b32 s20, v47, 20
    s_nop 1
    v_fmac_f32 v224, s20, v156
    v_fmac_f32 v225, s20, v157
    v_fmac_f32 v226, s20, v158
    v_fmac_f32 v227, s20, v159
    v_readlane_b32 s20, v44, 36
    s_nop 1
    v_fmac_f32 v224, s20, v160
    v_fmac_f32 v225, s20, v161
    v_fmac_f32 v226, s20, v162
    v_fmac_f32 v227, s20, v163
    v_readlane_b32 s20, v45, 36
    s_nop 1
    v_fmac_f32 v224, s20, v164
    v_fmac_f32 v225, s20, v165
    v_fmac_f32 v226, s20, v166
    v_fmac_f32 v227, s20, v167
    v_readlane_b32 s20, v46, 36
    s_nop 1
    v_fmac_f32 v224, s20, v168
    v_fmac_f32 v225, s20, v169
    v_fmac_f32 v226, s20, v170
    v_fmac_f32 v227, s20, v171
    v_readlane_b32 s20, v47, 36
    s_nop 1
    v_fmac_f32 v224, s20, v172
    v_fmac_f32 v225, s20, v173
    v_fmac_f32 v226, s20, v174
    v_fmac_f32 v227, s20, v175
    v_readlane_b32 s20, v44, 52
    s_nop 1
    v_fmac_f32 v224, s20, v176
    v_fmac_f32 v225, s20, v177
    v_fmac_f32 v226, s20, v178
    v_fmac_f32 v227, s20, v179
    v_cvt_pk_bf16_f32 v6, v224, v225
    v_cvt_pk_bf16_f32 v7, v226, v227
    v_add_u32 v9, 163840, v3
    buffer_store_dwordx2 v[6:7], v9, s[8:11], 0 offen
    s_nop 1
    v_mov_b32 v224, 0
    v_mov_b32 v225, 0
    v_mov_b32 v226, 0
    v_mov_b32 v227, 0
    v_readlane_b32 s20, v36, 5
    s_nop 1
    v_fmac_f32 v224, s20, v64
    v_fmac_f32 v225, s20, v65
    v_fmac_f32 v226, s20, v66
    v_fmac_f32 v227, s20, v67
    v_readlane_b32 s20, v37, 5
    s_nop 1
    v_fmac_f32 v224, s20, v68
    v_fmac_f32 v225, s20, v69
    v_fmac_f32 v226, s20, v70
    v_fmac_f32 v227, s20, v71
    v_readlane_b32 s20, v38, 5
    s_nop 1
    v_fmac_f32 v224, s20, v72
    v_fmac_f32 v225, s20, v73
    v_fmac_f32 v226, s20, v74
    v_fmac_f32 v227, s20, v75
    v_readlane_b32 s20, v39, 5
    s_nop 1
    v_fmac_f32 v224, s20, v76
    v_fmac_f32 v225, s20, v77
    v_fmac_f32 v226, s20, v78
    v_fmac_f32 v227, s20, v79
    v_readlane_b32 s20, v36, 21
    s_nop 1
    v_fmac_f32 v224, s20, v80
    v_fmac_f32 v225, s20, v81
    v_fmac_f32 v226, s20, v82
    v_fmac_f32 v227, s20, v83
    v_readlane_b32 s20, v37, 21
    s_nop 1
    v_fmac_f32 v224, s20, v84
    v_fmac_f32 v225, s20, v85
    v_fmac_f32 v226, s20, v86
    v_fmac_f32 v227, s20, v87
    v_readlane_b32 s20, v38, 21
    s_nop 1
    v_fmac_f32 v224, s20, v88
    v_fmac_f32 v225, s20, v89
    v_fmac_f32 v226, s20, v90
    v_fmac_f32 v227, s20, v91
    v_readlane_b32 s20, v39, 21
    s_nop 1
    v_fmac_f32 v224, s20, v92
    v_fmac_f32 v225, s20, v93
    v_fmac_f32 v226, s20, v94
    v_fmac_f32 v227, s20, v95
    v_readlane_b32 s20, v36, 37
    s_nop 1
    v_fmac_f32 v224, s20, v96
    v_fmac_f32 v225, s20, v97
    v_fmac_f32 v226, s20, v98
    v_fmac_f32 v227, s20, v99
    v_readlane_b32 s20, v37, 37
    s_nop 1
    v_fmac_f32 v224, s20, v100
    v_fmac_f32 v225, s20, v101
    v_fmac_f32 v226, s20, v102
    v_fmac_f32 v227, s20, v103
    v_readlane_b32 s20, v38, 37
    s_nop 1
    v_fmac_f32 v224, s20, v104
    v_fmac_f32 v225, s20, v105
    v_fmac_f32 v226, s20, v106
    v_fmac_f32 v227, s20, v107
    v_readlane_b32 s20, v39, 37
    s_nop 1
    v_fmac_f32 v224, s20, v108
    v_fmac_f32 v225, s20, v109
    v_fmac_f32 v226, s20, v110
    v_fmac_f32 v227, s20, v111
    v_readlane_b32 s20, v36, 53
    s_nop 1
    v_fmac_f32 v224, s20, v112
    v_fmac_f32 v225, s20, v113
    v_fmac_f32 v226, s20, v114
    v_fmac_f32 v227, s20, v115
    v_readlane_b32 s20, v37, 53
    s_nop 1
    v_fmac_f32 v224, s20, v116
    v_fmac_f32 v225, s20, v117
    v_fmac_f32 v226, s20, v118
    v_fmac_f32 v227, s20, v119
    v_readlane_b32 s20, v38, 53
    s_nop 1
    v_fmac_f32 v224, s20, v120
    v_fmac_f32 v225, s20, v121
    v_fmac_f32 v226, s20, v122
    v_fmac_f32 v227, s20, v123
    v_readlane_b32 s20, v39, 53
    s_nop 1
    v_fmac_f32 v224, s20, v124
    v_fmac_f32 v225, s20, v125
    v_fmac_f32 v226, s20, v126
    v_fmac_f32 v227, s20, v127
    v_readlane_b32 s20, v44, 5
    s_nop 1
    v_fmac_f32 v224, s20, v128
    v_fmac_f32 v225, s20, v129
    v_fmac_f32 v226, s20, v130
    v_fmac_f32 v227, s20, v131
    v_readlane_b32 s20, v45, 5
    s_nop 1
    v_fmac_f32 v224, s20, v132
    v_fmac_f32 v225, s20, v133
    v_fmac_f32 v226, s20, v134
    v_fmac_f32 v227, s20, v135
    v_readlane_b32 s20, v46, 5
    s_nop 1
    v_fmac_f32 v224, s20, v136
    v_fmac_f32 v225, s20, v137
    v_fmac_f32 v226, s20, v138
    v_fmac_f32 v227, s20, v139
    v_readlane_b32 s20, v47, 5
    s_nop 1
    v_fmac_f32 v224, s20, v140
    v_fmac_f32 v225, s20, v141
    v_fmac_f32 v226, s20, v142
    v_fmac_f32 v227, s20, v143
    v_readlane_b32 s20, v44, 21
    s_nop 1
    v_fmac_f32 v224, s20, v144
    v_fmac_f32 v225, s20, v145
    v_fmac_f32 v226, s20, v146
    v_fmac_f32 v227, s20, v147
    v_readlane_b32 s20, v45, 21
    s_nop 1
    v_fmac_f32 v224, s20, v148
    v_fmac_f32 v225, s20, v149
    v_fmac_f32 v226, s20, v150
    v_fmac_f32 v227, s20, v151
    v_readlane_b32 s20, v46, 21
    s_nop 1
    v_fmac_f32 v224, s20, v152
    v_fmac_f32 v225, s20, v153
    v_fmac_f32 v226, s20, v154
    v_fmac_f32 v227, s20, v155
    v_readlane_b32 s20, v47, 21
    s_nop 1
    v_fmac_f32 v224, s20, v156
    v_fmac_f32 v225, s20, v157
    v_fmac_f32 v226, s20, v158
    v_fmac_f32 v227, s20, v159
    v_readlane_b32 s20, v44, 37
    s_nop 1
    v_fmac_f32 v224, s20, v160
    v_fmac_f32 v225, s20, v161
    v_fmac_f32 v226, s20, v162
    v_fmac_f32 v227, s20, v163
    v_readlane_b32 s20, v45, 37
    s_nop 1
    v_fmac_f32 v224, s20, v164
    v_fmac_f32 v225, s20, v165
    v_fmac_f32 v226, s20, v166
    v_fmac_f32 v227, s20, v167
    v_readlane_b32 s20, v46, 37
    s_nop 1
    v_fmac_f32 v224, s20, v168
    v_fmac_f32 v225, s20, v169
    v_fmac_f32 v226, s20, v170
    v_fmac_f32 v227, s20, v171
    v_readlane_b32 s20, v47, 37
    s_nop 1
    v_fmac_f32 v224, s20, v172
    v_fmac_f32 v225, s20, v173
    v_fmac_f32 v226, s20, v174
    v_fmac_f32 v227, s20, v175
    v_readlane_b32 s20, v44, 53
    s_nop 1
    v_fmac_f32 v224, s20, v176
    v_fmac_f32 v225, s20, v177
    v_fmac_f32 v226, s20, v178
    v_fmac_f32 v227, s20, v179
    v_readlane_b32 s20, v45, 53
    s_nop 1
    v_fmac_f32 v224, s20, v180
    v_fmac_f32 v225, s20, v181
    v_fmac_f32 v226, s20, v182
    v_fmac_f32 v227, s20, v183
    v_cvt_pk_bf16_f32 v6, v224, v225
    v_cvt_pk_bf16_f32 v7, v226, v227
    v_add_u32 v9, 172032, v3
    buffer_store_dwordx2 v[6:7], v9, s[8:11], 0 offen
    s_nop 1
    v_mov_b32 v224, 0
    v_mov_b32 v225, 0
    v_mov_b32 v226, 0
    v_mov_b32 v227, 0
    v_readlane_b32 s20, v36, 6
    s_nop 1
    v_fmac_f32 v224, s20, v64
    v_fmac_f32 v225, s20, v65
    v_fmac_f32 v226, s20, v66
    v_fmac_f32 v227, s20, v67
    v_readlane_b32 s20, v37, 6
    s_nop 1
    v_fmac_f32 v224, s20, v68
    v_fmac_f32 v225, s20, v69
    v_fmac_f32 v226, s20, v70
    v_fmac_f32 v227, s20, v71
    v_readlane_b32 s20, v38, 6
    s_nop 1
    v_fmac_f32 v224, s20, v72
    v_fmac_f32 v225, s20, v73
    v_fmac_f32 v226, s20, v74
    v_fmac_f32 v227, s20, v75
    v_readlane_b32 s20, v39, 6
    s_nop 1
    v_fmac_f32 v224, s20, v76
    v_fmac_f32 v225, s20, v77
    v_fmac_f32 v226, s20, v78
    v_fmac_f32 v227, s20, v79
    v_readlane_b32 s20, v36, 22
    s_nop 1
    v_fmac_f32 v224, s20, v80
    v_fmac_f32 v225, s20, v81
    v_fmac_f32 v226, s20, v82
    v_fmac_f32 v227, s20, v83
    v_readlane_b32 s20, v37, 22
    s_nop 1
    v_fmac_f32 v224, s20, v84
    v_fmac_f32 v225, s20, v85
    v_fmac_f32 v226, s20, v86
    v_fmac_f32 v227, s20, v87
    v_readlane_b32 s20, v38, 22
    s_nop 1
    v_fmac_f32 v224, s20, v88
    v_fmac_f32 v225, s20, v89
    v_fmac_f32 v226, s20, v90
    v_fmac_f32 v227, s20, v91
    v_readlane_b32 s20, v39, 22
    s_nop 1
    v_fmac_f32 v224, s20, v92
    v_fmac_f32 v225, s20, v93
    v_fmac_f32 v226, s20, v94
    v_fmac_f32 v227, s20, v95
    v_readlane_b32 s20, v36, 38
    s_nop 1
    v_fmac_f32 v224, s20, v96
    v_fmac_f32 v225, s20, v97
    v_fmac_f32 v226, s20, v98
    v_fmac_f32 v227, s20, v99
    v_readlane_b32 s20, v37, 38
    s_nop 1
    v_fmac_f32 v224, s20, v100
    v_fmac_f32 v225, s20, v101
    v_fmac_f32 v226, s20, v102
    v_fmac_f32 v227, s20, v103
    v_readlane_b32 s20, v38, 38
    s_nop 1
    v_fmac_f32 v224, s20, v104
    v_fmac_f32 v225, s20, v105
    v_fmac_f32 v226, s20, v106
    v_fmac_f32 v227, s20, v107
    v_readlane_b32 s20, v39, 38
    s_nop 1
    v_fmac_f32 v224, s20, v108
    v_fmac_f32 v225, s20, v109
    v_fmac_f32 v226, s20, v110
    v_fmac_f32 v227, s20, v111
    v_readlane_b32 s20, v36, 54
    s_nop 1
    v_fmac_f32 v224, s20, v112
    v_fmac_f32 v225, s20, v113
    v_fmac_f32 v226, s20, v114
    v_fmac_f32 v227, s20, v115
    v_readlane_b32 s20, v37, 54
    s_nop 1
    v_fmac_f32 v224, s20, v116
    v_fmac_f32 v225, s20, v117
    v_fmac_f32 v226, s20, v118
    v_fmac_f32 v227, s20, v119
    v_readlane_b32 s20, v38, 54
    s_nop 1
    v_fmac_f32 v224, s20, v120
    v_fmac_f32 v225, s20, v121
    v_fmac_f32 v226, s20, v122
    v_fmac_f32 v227, s20, v123
    v_readlane_b32 s20, v39, 54
    s_nop 1
    v_fmac_f32 v224, s20, v124
    v_fmac_f32 v225, s20, v125
    v_fmac_f32 v226, s20, v126
    v_fmac_f32 v227, s20, v127
    v_readlane_b32 s20, v44, 6
    s_nop 1
    v_fmac_f32 v224, s20, v128
    v_fmac_f32 v225, s20, v129
    v_fmac_f32 v226, s20, v130
    v_fmac_f32 v227, s20, v131
    v_readlane_b32 s20, v45, 6
    s_nop 1
    v_fmac_f32 v224, s20, v132
    v_fmac_f32 v225, s20, v133
    v_fmac_f32 v226, s20, v134
    v_fmac_f32 v227, s20, v135
    v_readlane_b32 s20, v46, 6
    s_nop 1
    v_fmac_f32 v224, s20, v136
    v_fmac_f32 v225, s20, v137
    v_fmac_f32 v226, s20, v138
    v_fmac_f32 v227, s20, v139
    v_readlane_b32 s20, v47, 6
    s_nop 1
    v_fmac_f32 v224, s20, v140
    v_fmac_f32 v225, s20, v141
    v_fmac_f32 v226, s20, v142
    v_fmac_f32 v227, s20, v143
    v_readlane_b32 s20, v44, 22
    s_nop 1
    v_fmac_f32 v224, s20, v144
    v_fmac_f32 v225, s20, v145
    v_fmac_f32 v226, s20, v146
    v_fmac_f32 v227, s20, v147
    v_readlane_b32 s20, v45, 22
    s_nop 1
    v_fmac_f32 v224, s20, v148
    v_fmac_f32 v225, s20, v149
    v_fmac_f32 v226, s20, v150
    v_fmac_f32 v227, s20, v151
    v_readlane_b32 s20, v46, 22
    s_nop 1
    v_fmac_f32 v224, s20, v152
    v_fmac_f32 v225, s20, v153
    v_fmac_f32 v226, s20, v154
    v_fmac_f32 v227, s20, v155
    v_readlane_b32 s20, v47, 22
    s_nop 1
    v_fmac_f32 v224, s20, v156
    v_fmac_f32 v225, s20, v157
    v_fmac_f32 v226, s20, v158
    v_fmac_f32 v227, s20, v159
    v_readlane_b32 s20, v44, 38
    s_nop 1
    v_fmac_f32 v224, s20, v160
    v_fmac_f32 v225, s20, v161
    v_fmac_f32 v226, s20, v162
    v_fmac_f32 v227, s20, v163
    v_readlane_b32 s20, v45, 38
    s_nop 1
    v_fmac_f32 v224, s20, v164
    v_fmac_f32 v225, s20, v165
    v_fmac_f32 v226, s20, v166
    v_fmac_f32 v227, s20, v167
    v_readlane_b32 s20, v46, 38
    s_nop 1
    v_fmac_f32 v224, s20, v168
    v_fmac_f32 v225, s20, v169
    v_fmac_f32 v226, s20, v170
    v_fmac_f32 v227, s20, v171
    v_readlane_b32 s20, v47, 38
    s_nop 1
    v_fmac_f32 v224, s20, v172
    v_fmac_f32 v225, s20, v173
    v_fmac_f32 v226, s20, v174
    v_fmac_f32 v227, s20, v175
    v_readlane_b32 s20, v44, 54
    s_nop 1
    v_fmac_f32 v224, s20, v176
    v_fmac_f32 v225, s20, v177
    v_fmac_f32 v226, s20, v178
    v_fmac_f32 v227, s20, v179
    v_readlane_b32 s20, v45, 54
    s_nop 1
    v_fmac_f32 v224, s20, v180
    v_fmac_f32 v225, s20, v181
    v_fmac_f32 v226, s20, v182
    v_fmac_f32 v227, s20, v183
    v_readlane_b32 s20, v46, 54
    s_nop 1
    v_fmac_f32 v224, s20, v184
    v_fmac_f32 v225, s20, v185
    v_fmac_f32 v226, s20, v186
    v_fmac_f32 v227, s20, v187
    v_cvt_pk_bf16_f32 v6, v224, v225
    v_cvt_pk_bf16_f32 v7, v226, v227
    v_add_u32 v9, 180224, v3
    buffer_store_dwordx2 v[6:7], v9, s[8:11], 0 offen
    s_nop 1
    v_mov_b32 v224, 0
    v_mov_b32 v225, 0
    v_mov_b32 v226, 0
    v_mov_b32 v227, 0
    v_readlane_b32 s20, v36, 7
    s_nop 1
    v_fmac_f32 v224, s20, v64
    v_fmac_f32 v225, s20, v65
    v_fmac_f32 v226, s20, v66
    v_fmac_f32 v227, s20, v67
    v_readlane_b32 s20, v37, 7
    s_nop 1
    v_fmac_f32 v224, s20, v68
    v_fmac_f32 v225, s20, v69
    v_fmac_f32 v226, s20, v70
    v_fmac_f32 v227, s20, v71
    v_readlane_b32 s20, v38, 7
    s_nop 1
    v_fmac_f32 v224, s20, v72
    v_fmac_f32 v225, s20, v73
    v_fmac_f32 v226, s20, v74
    v_fmac_f32 v227, s20, v75
    v_readlane_b32 s20, v39, 7
    s_nop 1
    v_fmac_f32 v224, s20, v76
    v_fmac_f32 v225, s20, v77
    v_fmac_f32 v226, s20, v78
    v_fmac_f32 v227, s20, v79
    v_readlane_b32 s20, v36, 23
    s_nop 1
    v_fmac_f32 v224, s20, v80
    v_fmac_f32 v225, s20, v81
    v_fmac_f32 v226, s20, v82
    v_fmac_f32 v227, s20, v83
    v_readlane_b32 s20, v37, 23
    s_nop 1
    v_fmac_f32 v224, s20, v84
    v_fmac_f32 v225, s20, v85
    v_fmac_f32 v226, s20, v86
    v_fmac_f32 v227, s20, v87
    v_readlane_b32 s20, v38, 23
    s_nop 1
    v_fmac_f32 v224, s20, v88
    v_fmac_f32 v225, s20, v89
    v_fmac_f32 v226, s20, v90
    v_fmac_f32 v227, s20, v91
    v_readlane_b32 s20, v39, 23
    s_nop 1
    v_fmac_f32 v224, s20, v92
    v_fmac_f32 v225, s20, v93
    v_fmac_f32 v226, s20, v94
    v_fmac_f32 v227, s20, v95
    v_readlane_b32 s20, v36, 39
    s_nop 1
    v_fmac_f32 v224, s20, v96
    v_fmac_f32 v225, s20, v97
    v_fmac_f32 v226, s20, v98
    v_fmac_f32 v227, s20, v99
    v_readlane_b32 s20, v37, 39
    s_nop 1
    v_fmac_f32 v224, s20, v100
    v_fmac_f32 v225, s20, v101
    v_fmac_f32 v226, s20, v102
    v_fmac_f32 v227, s20, v103
    v_readlane_b32 s20, v38, 39
    s_nop 1
    v_fmac_f32 v224, s20, v104
    v_fmac_f32 v225, s20, v105
    v_fmac_f32 v226, s20, v106
    v_fmac_f32 v227, s20, v107
    v_readlane_b32 s20, v39, 39
    s_nop 1
    v_fmac_f32 v224, s20, v108
    v_fmac_f32 v225, s20, v109
    v_fmac_f32 v226, s20, v110
    v_fmac_f32 v227, s20, v111
    v_readlane_b32 s20, v36, 55
    s_nop 1
    v_fmac_f32 v224, s20, v112
    v_fmac_f32 v225, s20, v113
    v_fmac_f32 v226, s20, v114
    v_fmac_f32 v227, s20, v115
    v_readlane_b32 s20, v37, 55
    s_nop 1
    v_fmac_f32 v224, s20, v116
    v_fmac_f32 v225, s20, v117
    v_fmac_f32 v226, s20, v118
    v_fmac_f32 v227, s20, v119
    v_readlane_b32 s20, v38, 55
    s_nop 1
    v_fmac_f32 v224, s20, v120
    v_fmac_f32 v225, s20, v121
    v_fmac_f32 v226, s20, v122
    v_fmac_f32 v227, s20, v123
    v_readlane_b32 s20, v39, 55
    s_nop 1
    v_fmac_f32 v224, s20, v124
    v_fmac_f32 v225, s20, v125
    v_fmac_f32 v226, s20, v126
    v_fmac_f32 v227, s20, v127
    v_readlane_b32 s20, v44, 7
    s_nop 1
    v_fmac_f32 v224, s20, v128
    v_fmac_f32 v225, s20, v129
    v_fmac_f32 v226, s20, v130
    v_fmac_f32 v227, s20, v131
    v_readlane_b32 s20, v45, 7
    s_nop 1
    v_fmac_f32 v224, s20, v132
    v_fmac_f32 v225, s20, v133
    v_fmac_f32 v226, s20, v134
    v_fmac_f32 v227, s20, v135
    v_readlane_b32 s20, v46, 7
    s_nop 1
    v_fmac_f32 v224, s20, v136
    v_fmac_f32 v225, s20, v137
    v_fmac_f32 v226, s20, v138
    v_fmac_f32 v227, s20, v139
    v_readlane_b32 s20, v47, 7
    s_nop 1
    v_fmac_f32 v224, s20, v140
    v_fmac_f32 v225, s20, v141
    v_fmac_f32 v226, s20, v142
    v_fmac_f32 v227, s20, v143
    v_readlane_b32 s20, v44, 23
    s_nop 1
    v_fmac_f32 v224, s20, v144
    v_fmac_f32 v225, s20, v145
    v_fmac_f32 v226, s20, v146
    v_fmac_f32 v227, s20, v147
    v_readlane_b32 s20, v45, 23
    s_nop 1
    v_fmac_f32 v224, s20, v148
    v_fmac_f32 v225, s20, v149
    v_fmac_f32 v226, s20, v150
    v_fmac_f32 v227, s20, v151
    v_readlane_b32 s20, v46, 23
    s_nop 1
    v_fmac_f32 v224, s20, v152
    v_fmac_f32 v225, s20, v153
    v_fmac_f32 v226, s20, v154
    v_fmac_f32 v227, s20, v155
    v_readlane_b32 s20, v47, 23
    s_nop 1
    v_fmac_f32 v224, s20, v156
    v_fmac_f32 v225, s20, v157
    v_fmac_f32 v226, s20, v158
    v_fmac_f32 v227, s20, v159
    v_readlane_b32 s20, v44, 39
    s_nop 1
    v_fmac_f32 v224, s20, v160
    v_fmac_f32 v225, s20, v161
    v_fmac_f32 v226, s20, v162
    v_fmac_f32 v227, s20, v163
    v_readlane_b32 s20, v45, 39
    s_nop 1
    v_fmac_f32 v224, s20, v164
    v_fmac_f32 v225, s20, v165
    v_fmac_f32 v226, s20, v166
    v_fmac_f32 v227, s20, v167
    v_readlane_b32 s20, v46, 39
    s_nop 1
    v_fmac_f32 v224, s20, v168
    v_fmac_f32 v225, s20, v169
    v_fmac_f32 v226, s20, v170
    v_fmac_f32 v227, s20, v171
    v_readlane_b32 s20, v47, 39
    s_nop 1
    v_fmac_f32 v224, s20, v172
    v_fmac_f32 v225, s20, v173
    v_fmac_f32 v226, s20, v174
    v_fmac_f32 v227, s20, v175
    v_readlane_b32 s20, v44, 55
    s_nop 1
    v_fmac_f32 v224, s20, v176
    v_fmac_f32 v225, s20, v177
    v_fmac_f32 v226, s20, v178
    v_fmac_f32 v227, s20, v179
    v_readlane_b32 s20, v45, 55
    s_nop 1
    v_fmac_f32 v224, s20, v180
    v_fmac_f32 v225, s20, v181
    v_fmac_f32 v226, s20, v182
    v_fmac_f32 v227, s20, v183
    v_readlane_b32 s20, v46, 55
    s_nop 1
    v_fmac_f32 v224, s20, v184
    v_fmac_f32 v225, s20, v185
    v_fmac_f32 v226, s20, v186
    v_fmac_f32 v227, s20, v187
    v_readlane_b32 s20, v47, 55
    s_nop 1
    v_fmac_f32 v224, s20, v188
    v_fmac_f32 v225, s20, v189
    v_fmac_f32 v226, s20, v190
    v_fmac_f32 v227, s20, v191
    v_cvt_pk_bf16_f32 v6, v224, v225
    v_cvt_pk_bf16_f32 v7, v226, v227
    v_add_u32 v9, 188416, v3
    buffer_store_dwordx2 v[6:7], v9, s[8:11], 0 offen
    s_nop 1
    v_mov_b32 v224, 0
    v_mov_b32 v225, 0
    v_mov_b32 v226, 0
    v_mov_b32 v227, 0
    v_readlane_b32 s20, v36, 8
    s_nop 1
    v_fmac_f32 v224, s20, v64
    v_fmac_f32 v225, s20, v65
    v_fmac_f32 v226, s20, v66
    v_fmac_f32 v227, s20, v67
    v_readlane_b32 s20, v37, 8
    s_nop 1
    v_fmac_f32 v224, s20, v68
    v_fmac_f32 v225, s20, v69
    v_fmac_f32 v226, s20, v70
    v_fmac_f32 v227, s20, v71
    v_readlane_b32 s20, v38, 8
    s_nop 1
    v_fmac_f32 v224, s20, v72
    v_fmac_f32 v225, s20, v73
    v_fmac_f32 v226, s20, v74
    v_fmac_f32 v227, s20, v75
    v_readlane_b32 s20, v39, 8
    s_nop 1
    v_fmac_f32 v224, s20, v76
    v_fmac_f32 v225, s20, v77
    v_fmac_f32 v226, s20, v78
    v_fmac_f32 v227, s20, v79
    v_readlane_b32 s20, v36, 24
    s_nop 1
    v_fmac_f32 v224, s20, v80
    v_fmac_f32 v225, s20, v81
    v_fmac_f32 v226, s20, v82
    v_fmac_f32 v227, s20, v83
    v_readlane_b32 s20, v37, 24
    s_nop 1
    v_fmac_f32 v224, s20, v84
    v_fmac_f32 v225, s20, v85
    v_fmac_f32 v226, s20, v86
    v_fmac_f32 v227, s20, v87
    v_readlane_b32 s20, v38, 24
    s_nop 1
    v_fmac_f32 v224, s20, v88
    v_fmac_f32 v225, s20, v89
    v_fmac_f32 v226, s20, v90
    v_fmac_f32 v227, s20, v91
    v_readlane_b32 s20, v39, 24
    s_nop 1
    v_fmac_f32 v224, s20, v92
    v_fmac_f32 v225, s20, v93
    v_fmac_f32 v226, s20, v94
    v_fmac_f32 v227, s20, v95
    v_readlane_b32 s20, v36, 40
    s_nop 1
    v_fmac_f32 v224, s20, v96
    v_fmac_f32 v225, s20, v97
    v_fmac_f32 v226, s20, v98
    v_fmac_f32 v227, s20, v99
    v_readlane_b32 s20, v37, 40
    s_nop 1
    v_fmac_f32 v224, s20, v100
    v_fmac_f32 v225, s20, v101
    v_fmac_f32 v226, s20, v102
    v_fmac_f32 v227, s20, v103
    v_readlane_b32 s20, v38, 40
    s_nop 1
    v_fmac_f32 v224, s20, v104
    v_fmac_f32 v225, s20, v105
    v_fmac_f32 v226, s20, v106
    v_fmac_f32 v227, s20, v107
    v_readlane_b32 s20, v39, 40
    s_nop 1
    v_fmac_f32 v224, s20, v108
    v_fmac_f32 v225, s20, v109
    v_fmac_f32 v226, s20, v110
    v_fmac_f32 v227, s20, v111
    v_readlane_b32 s20, v36, 56
    s_nop 1
    v_fmac_f32 v224, s20, v112
    v_fmac_f32 v225, s20, v113
    v_fmac_f32 v226, s20, v114
    v_fmac_f32 v227, s20, v115
    v_readlane_b32 s20, v37, 56
    s_nop 1
    v_fmac_f32 v224, s20, v116
    v_fmac_f32 v225, s20, v117
    v_fmac_f32 v226, s20, v118
    v_fmac_f32 v227, s20, v119
    v_readlane_b32 s20, v38, 56
    s_nop 1
    v_fmac_f32 v224, s20, v120
    v_fmac_f32 v225, s20, v121
    v_fmac_f32 v226, s20, v122
    v_fmac_f32 v227, s20, v123
    v_readlane_b32 s20, v39, 56
    s_nop 1
    v_fmac_f32 v224, s20, v124
    v_fmac_f32 v225, s20, v125
    v_fmac_f32 v226, s20, v126
    v_fmac_f32 v227, s20, v127
    v_readlane_b32 s20, v44, 8
    s_nop 1
    v_fmac_f32 v224, s20, v128
    v_fmac_f32 v225, s20, v129
    v_fmac_f32 v226, s20, v130
    v_fmac_f32 v227, s20, v131
    v_readlane_b32 s20, v45, 8
    s_nop 1
    v_fmac_f32 v224, s20, v132
    v_fmac_f32 v225, s20, v133
    v_fmac_f32 v226, s20, v134
    v_fmac_f32 v227, s20, v135
    v_readlane_b32 s20, v46, 8
    s_nop 1
    v_fmac_f32 v224, s20, v136
    v_fmac_f32 v225, s20, v137
    v_fmac_f32 v226, s20, v138
    v_fmac_f32 v227, s20, v139
    v_readlane_b32 s20, v47, 8
    s_nop 1
    v_fmac_f32 v224, s20, v140
    v_fmac_f32 v225, s20, v141
    v_fmac_f32 v226, s20, v142
    v_fmac_f32 v227, s20, v143
    v_readlane_b32 s20, v44, 24
    s_nop 1
    v_fmac_f32 v224, s20, v144
    v_fmac_f32 v225, s20, v145
    v_fmac_f32 v226, s20, v146
    v_fmac_f32 v227, s20, v147
    v_readlane_b32 s20, v45, 24
    s_nop 1
    v_fmac_f32 v224, s20, v148
    v_fmac_f32 v225, s20, v149
    v_fmac_f32 v226, s20, v150
    v_fmac_f32 v227, s20, v151
    v_readlane_b32 s20, v46, 24
    s_nop 1
    v_fmac_f32 v224, s20, v152
    v_fmac_f32 v225, s20, v153
    v_fmac_f32 v226, s20, v154
    v_fmac_f32 v227, s20, v155
    v_readlane_b32 s20, v47, 24
    s_nop 1
    v_fmac_f32 v224, s20, v156
    v_fmac_f32 v225, s20, v157
    v_fmac_f32 v226, s20, v158
    v_fmac_f32 v227, s20, v159
    v_readlane_b32 s20, v44, 40
    s_nop 1
    v_fmac_f32 v224, s20, v160
    v_fmac_f32 v225, s20, v161
    v_fmac_f32 v226, s20, v162
    v_fmac_f32 v227, s20, v163
    v_readlane_b32 s20, v45, 40
    s_nop 1
    v_fmac_f32 v224, s20, v164
    v_fmac_f32 v225, s20, v165
    v_fmac_f32 v226, s20, v166
    v_fmac_f32 v227, s20, v167
    v_readlane_b32 s20, v46, 40
    s_nop 1
    v_fmac_f32 v224, s20, v168
    v_fmac_f32 v225, s20, v169
    v_fmac_f32 v226, s20, v170
    v_fmac_f32 v227, s20, v171
    v_readlane_b32 s20, v47, 40
    s_nop 1
    v_fmac_f32 v224, s20, v172
    v_fmac_f32 v225, s20, v173
    v_fmac_f32 v226, s20, v174
    v_fmac_f32 v227, s20, v175
    v_readlane_b32 s20, v44, 56
    s_nop 1
    v_fmac_f32 v224, s20, v176
    v_fmac_f32 v225, s20, v177
    v_fmac_f32 v226, s20, v178
    v_fmac_f32 v227, s20, v179
    v_readlane_b32 s20, v45, 56
    s_nop 1
    v_fmac_f32 v224, s20, v180
    v_fmac_f32 v225, s20, v181
    v_fmac_f32 v226, s20, v182
    v_fmac_f32 v227, s20, v183
    v_readlane_b32 s20, v46, 56
    s_nop 1
    v_fmac_f32 v224, s20, v184
    v_fmac_f32 v225, s20, v185
    v_fmac_f32 v226, s20, v186
    v_fmac_f32 v227, s20, v187
    v_readlane_b32 s20, v47, 56
    s_nop 1
    v_fmac_f32 v224, s20, v188
    v_fmac_f32 v225, s20, v189
    v_fmac_f32 v226, s20, v190
    v_fmac_f32 v227, s20, v191
    v_readlane_b32 s20, v52, 8
    s_nop 1
    v_fmac_f32 v224, s20, v192
    v_fmac_f32 v225, s20, v193
    v_fmac_f32 v226, s20, v194
    v_fmac_f32 v227, s20, v195
    v_cvt_pk_bf16_f32 v6, v224, v225
    v_cvt_pk_bf16_f32 v7, v226, v227
    v_add_u32 v9, 196608, v3
    buffer_store_dwordx2 v[6:7], v9, s[8:11], 0 offen
    s_nop 1
    v_mov_b32 v224, 0
    v_mov_b32 v225, 0
    v_mov_b32 v226, 0
    v_mov_b32 v227, 0
    v_readlane_b32 s20, v36, 9
    s_nop 1
    v_fmac_f32 v224, s20, v64
    v_fmac_f32 v225, s20, v65
    v_fmac_f32 v226, s20, v66
    v_fmac_f32 v227, s20, v67
    v_readlane_b32 s20, v37, 9
    s_nop 1
    v_fmac_f32 v224, s20, v68
    v_fmac_f32 v225, s20, v69
    v_fmac_f32 v226, s20, v70
    v_fmac_f32 v227, s20, v71
    v_readlane_b32 s20, v38, 9
    s_nop 1
    v_fmac_f32 v224, s20, v72
    v_fmac_f32 v225, s20, v73
    v_fmac_f32 v226, s20, v74
    v_fmac_f32 v227, s20, v75
    v_readlane_b32 s20, v39, 9
    s_nop 1
    v_fmac_f32 v224, s20, v76
    v_fmac_f32 v225, s20, v77
    v_fmac_f32 v226, s20, v78
    v_fmac_f32 v227, s20, v79
    v_readlane_b32 s20, v36, 25
    s_nop 1
    v_fmac_f32 v224, s20, v80
    v_fmac_f32 v225, s20, v81
    v_fmac_f32 v226, s20, v82
    v_fmac_f32 v227, s20, v83
    v_readlane_b32 s20, v37, 25
    s_nop 1
    v_fmac_f32 v224, s20, v84
    v_fmac_f32 v225, s20, v85
    v_fmac_f32 v226, s20, v86
    v_fmac_f32 v227, s20, v87
    v_readlane_b32 s20, v38, 25
    s_nop 1
    v_fmac_f32 v224, s20, v88
    v_fmac_f32 v225, s20, v89
    v_fmac_f32 v226, s20, v90
    v_fmac_f32 v227, s20, v91
    v_readlane_b32 s20, v39, 25
    s_nop 1
    v_fmac_f32 v224, s20, v92
    v_fmac_f32 v225, s20, v93
    v_fmac_f32 v226, s20, v94
    v_fmac_f32 v227, s20, v95
    v_readlane_b32 s20, v36, 41
    s_nop 1
    v_fmac_f32 v224, s20, v96
    v_fmac_f32 v225, s20, v97
    v_fmac_f32 v226, s20, v98
    v_fmac_f32 v227, s20, v99
    v_readlane_b32 s20, v37, 41
    s_nop 1
    v_fmac_f32 v224, s20, v100
    v_fmac_f32 v225, s20, v101
    v_fmac_f32 v226, s20, v102
    v_fmac_f32 v227, s20, v103
    v_readlane_b32 s20, v38, 41
    s_nop 1
    v_fmac_f32 v224, s20, v104
    v_fmac_f32 v225, s20, v105
    v_fmac_f32 v226, s20, v106
    v_fmac_f32 v227, s20, v107
    v_readlane_b32 s20, v39, 41
    s_nop 1
    v_fmac_f32 v224, s20, v108
    v_fmac_f32 v225, s20, v109
    v_fmac_f32 v226, s20, v110
    v_fmac_f32 v227, s20, v111
    v_readlane_b32 s20, v36, 57
    s_nop 1
    v_fmac_f32 v224, s20, v112
    v_fmac_f32 v225, s20, v113
    v_fmac_f32 v226, s20, v114
    v_fmac_f32 v227, s20, v115
    v_readlane_b32 s20, v37, 57
    s_nop 1
    v_fmac_f32 v224, s20, v116
    v_fmac_f32 v225, s20, v117
    v_fmac_f32 v226, s20, v118
    v_fmac_f32 v227, s20, v119
    v_readlane_b32 s20, v38, 57
    s_nop 1
    v_fmac_f32 v224, s20, v120
    v_fmac_f32 v225, s20, v121
    v_fmac_f32 v226, s20, v122
    v_fmac_f32 v227, s20, v123
    v_readlane_b32 s20, v39, 57
    s_nop 1
    v_fmac_f32 v224, s20, v124
    v_fmac_f32 v225, s20, v125
    v_fmac_f32 v226, s20, v126
    v_fmac_f32 v227, s20, v127
    v_readlane_b32 s20, v44, 9
    s_nop 1
    v_fmac_f32 v224, s20, v128
    v_fmac_f32 v225, s20, v129
    v_fmac_f32 v226, s20, v130
    v_fmac_f32 v227, s20, v131
    v_readlane_b32 s20, v45, 9
    s_nop 1
    v_fmac_f32 v224, s20, v132
    v_fmac_f32 v225, s20, v133
    v_fmac_f32 v226, s20, v134
    v_fmac_f32 v227, s20, v135
    v_readlane_b32 s20, v46, 9
    s_nop 1
    v_fmac_f32 v224, s20, v136
    v_fmac_f32 v225, s20, v137
    v_fmac_f32 v226, s20, v138
    v_fmac_f32 v227, s20, v139
    v_readlane_b32 s20, v47, 9
    s_nop 1
    v_fmac_f32 v224, s20, v140
    v_fmac_f32 v225, s20, v141
    v_fmac_f32 v226, s20, v142
    v_fmac_f32 v227, s20, v143
    v_readlane_b32 s20, v44, 25
    s_nop 1
    v_fmac_f32 v224, s20, v144
    v_fmac_f32 v225, s20, v145
    v_fmac_f32 v226, s20, v146
    v_fmac_f32 v227, s20, v147
    v_readlane_b32 s20, v45, 25
    s_nop 1
    v_fmac_f32 v224, s20, v148
    v_fmac_f32 v225, s20, v149
    v_fmac_f32 v226, s20, v150
    v_fmac_f32 v227, s20, v151
    v_readlane_b32 s20, v46, 25
    s_nop 1
    v_fmac_f32 v224, s20, v152
    v_fmac_f32 v225, s20, v153
    v_fmac_f32 v226, s20, v154
    v_fmac_f32 v227, s20, v155
    v_readlane_b32 s20, v47, 25
    s_nop 1
    v_fmac_f32 v224, s20, v156
    v_fmac_f32 v225, s20, v157
    v_fmac_f32 v226, s20, v158
    v_fmac_f32 v227, s20, v159
    v_readlane_b32 s20, v44, 41
    s_nop 1
    v_fmac_f32 v224, s20, v160
    v_fmac_f32 v225, s20, v161
    v_fmac_f32 v226, s20, v162
    v_fmac_f32 v227, s20, v163
    v_readlane_b32 s20, v45, 41
    s_nop 1
    v_fmac_f32 v224, s20, v164
    v_fmac_f32 v225, s20, v165
    v_fmac_f32 v226, s20, v166
    v_fmac_f32 v227, s20, v167
    v_readlane_b32 s20, v46, 41
    s_nop 1
    v_fmac_f32 v224, s20, v168
    v_fmac_f32 v225, s20, v169
    v_fmac_f32 v226, s20, v170
    v_fmac_f32 v227, s20, v171
    v_readlane_b32 s20, v47, 41
    s_nop 1
    v_fmac_f32 v224, s20, v172
    v_fmac_f32 v225, s20, v173
    v_fmac_f32 v226, s20, v174
    v_fmac_f32 v227, s20, v175
    v_readlane_b32 s20, v44, 57
    s_nop 1
    v_fmac_f32 v224, s20, v176
    v_fmac_f32 v225, s20, v177
    v_fmac_f32 v226, s20, v178
    v_fmac_f32 v227, s20, v179
    v_readlane_b32 s20, v45, 57
    s_nop 1
    v_fmac_f32 v224, s20, v180
    v_fmac_f32 v225, s20, v181
    v_fmac_f32 v226, s20, v182
    v_fmac_f32 v227, s20, v183
    v_readlane_b32 s20, v46, 57
    s_nop 1
    v_fmac_f32 v224, s20, v184
    v_fmac_f32 v225, s20, v185
    v_fmac_f32 v226, s20, v186
    v_fmac_f32 v227, s20, v187
    v_readlane_b32 s20, v47, 57
    s_nop 1
    v_fmac_f32 v224, s20, v188
    v_fmac_f32 v225, s20, v189
    v_fmac_f32 v226, s20, v190
    v_fmac_f32 v227, s20, v191
    v_readlane_b32 s20, v52, 9
    s_nop 1
    v_fmac_f32 v224, s20, v192
    v_fmac_f32 v225, s20, v193
    v_fmac_f32 v226, s20, v194
    v_fmac_f32 v227, s20, v195
    v_readlane_b32 s20, v53, 9
    s_nop 1
    v_fmac_f32 v224, s20, v196
    v_fmac_f32 v225, s20, v197
    v_fmac_f32 v226, s20, v198
    v_fmac_f32 v227, s20, v199
    v_cvt_pk_bf16_f32 v6, v224, v225
    v_cvt_pk_bf16_f32 v7, v226, v227
    v_add_u32 v9, 204800, v3
    buffer_store_dwordx2 v[6:7], v9, s[8:11], 0 offen
    s_nop 1
    v_mov_b32 v224, 0
    v_mov_b32 v225, 0
    v_mov_b32 v226, 0
    v_mov_b32 v227, 0
    v_readlane_b32 s20, v36, 10
    s_nop 1
    v_fmac_f32 v224, s20, v64
    v_fmac_f32 v225, s20, v65
    v_fmac_f32 v226, s20, v66
    v_fmac_f32 v227, s20, v67
    v_readlane_b32 s20, v37, 10
    s_nop 1
    v_fmac_f32 v224, s20, v68
    v_fmac_f32 v225, s20, v69
    v_fmac_f32 v226, s20, v70
    v_fmac_f32 v227, s20, v71
    v_readlane_b32 s20, v38, 10
    s_nop 1
    v_fmac_f32 v224, s20, v72
    v_fmac_f32 v225, s20, v73
    v_fmac_f32 v226, s20, v74
    v_fmac_f32 v227, s20, v75
    v_readlane_b32 s20, v39, 10
    s_nop 1
    v_fmac_f32 v224, s20, v76
    v_fmac_f32 v225, s20, v77
    v_fmac_f32 v226, s20, v78
    v_fmac_f32 v227, s20, v79
    v_readlane_b32 s20, v36, 26
    s_nop 1
    v_fmac_f32 v224, s20, v80
    v_fmac_f32 v225, s20, v81
    v_fmac_f32 v226, s20, v82
    v_fmac_f32 v227, s20, v83
    v_readlane_b32 s20, v37, 26
    s_nop 1
    v_fmac_f32 v224, s20, v84
    v_fmac_f32 v225, s20, v85
    v_fmac_f32 v226, s20, v86
    v_fmac_f32 v227, s20, v87
    v_readlane_b32 s20, v38, 26
    s_nop 1
    v_fmac_f32 v224, s20, v88
    v_fmac_f32 v225, s20, v89
    v_fmac_f32 v226, s20, v90
    v_fmac_f32 v227, s20, v91
    v_readlane_b32 s20, v39, 26
    s_nop 1
    v_fmac_f32 v224, s20, v92
    v_fmac_f32 v225, s20, v93
    v_fmac_f32 v226, s20, v94
    v_fmac_f32 v227, s20, v95
    v_readlane_b32 s20, v36, 42
    s_nop 1
    v_fmac_f32 v224, s20, v96
    v_fmac_f32 v225, s20, v97
    v_fmac_f32 v226, s20, v98
    v_fmac_f32 v227, s20, v99
    v_readlane_b32 s20, v37, 42
    s_nop 1
    v_fmac_f32 v224, s20, v100
    v_fmac_f32 v225, s20, v101
    v_fmac_f32 v226, s20, v102
    v_fmac_f32 v227, s20, v103
    v_readlane_b32 s20, v38, 42
    s_nop 1
    v_fmac_f32 v224, s20, v104
    v_fmac_f32 v225, s20, v105
    v_fmac_f32 v226, s20, v106
    v_fmac_f32 v227, s20, v107
    v_readlane_b32 s20, v39, 42
    s_nop 1
    v_fmac_f32 v224, s20, v108
    v_fmac_f32 v225, s20, v109
    v_fmac_f32 v226, s20, v110
    v_fmac_f32 v227, s20, v111
    v_readlane_b32 s20, v36, 58
    s_nop 1
    v_fmac_f32 v224, s20, v112
    v_fmac_f32 v225, s20, v113
    v_fmac_f32 v226, s20, v114
    v_fmac_f32 v227, s20, v115
    v_readlane_b32 s20, v37, 58
    s_nop 1
    v_fmac_f32 v224, s20, v116
    v_fmac_f32 v225, s20, v117
    v_fmac_f32 v226, s20, v118
    v_fmac_f32 v227, s20, v119
    v_readlane_b32 s20, v38, 58
    s_nop 1
    v_fmac_f32 v224, s20, v120
    v_fmac_f32 v225, s20, v121
    v_fmac_f32 v226, s20, v122
    v_fmac_f32 v227, s20, v123
    v_readlane_b32 s20, v39, 58
    s_nop 1
    v_fmac_f32 v224, s20, v124
    v_fmac_f32 v225, s20, v125
    v_fmac_f32 v226, s20, v126
    v_fmac_f32 v227, s20, v127
    v_readlane_b32 s20, v44, 10
    s_nop 1
    v_fmac_f32 v224, s20, v128
    v_fmac_f32 v225, s20, v129
    v_fmac_f32 v226, s20, v130
    v_fmac_f32 v227, s20, v131
    v_readlane_b32 s20, v45, 10
    s_nop 1
    v_fmac_f32 v224, s20, v132
    v_fmac_f32 v225, s20, v133
    v_fmac_f32 v226, s20, v134
    v_fmac_f32 v227, s20, v135
    v_readlane_b32 s20, v46, 10
    s_nop 1
    v_fmac_f32 v224, s20, v136
    v_fmac_f32 v225, s20, v137
    v_fmac_f32 v226, s20, v138
    v_fmac_f32 v227, s20, v139
    v_readlane_b32 s20, v47, 10
    s_nop 1
    v_fmac_f32 v224, s20, v140
    v_fmac_f32 v225, s20, v141
    v_fmac_f32 v226, s20, v142
    v_fmac_f32 v227, s20, v143
    v_readlane_b32 s20, v44, 26
    s_nop 1
    v_fmac_f32 v224, s20, v144
    v_fmac_f32 v225, s20, v145
    v_fmac_f32 v226, s20, v146
    v_fmac_f32 v227, s20, v147
    v_readlane_b32 s20, v45, 26
    s_nop 1
    v_fmac_f32 v224, s20, v148
    v_fmac_f32 v225, s20, v149
    v_fmac_f32 v226, s20, v150
    v_fmac_f32 v227, s20, v151
    v_readlane_b32 s20, v46, 26
    s_nop 1
    v_fmac_f32 v224, s20, v152
    v_fmac_f32 v225, s20, v153
    v_fmac_f32 v226, s20, v154
    v_fmac_f32 v227, s20, v155
    v_readlane_b32 s20, v47, 26
    s_nop 1
    v_fmac_f32 v224, s20, v156
    v_fmac_f32 v225, s20, v157
    v_fmac_f32 v226, s20, v158
    v_fmac_f32 v227, s20, v159
    v_readlane_b32 s20, v44, 42
    s_nop 1
    v_fmac_f32 v224, s20, v160
    v_fmac_f32 v225, s20, v161
    v_fmac_f32 v226, s20, v162
    v_fmac_f32 v227, s20, v163
    v_readlane_b32 s20, v45, 42
    s_nop 1
    v_fmac_f32 v224, s20, v164
    v_fmac_f32 v225, s20, v165
    v_fmac_f32 v226, s20, v166
    v_fmac_f32 v227, s20, v167
    v_readlane_b32 s20, v46, 42
    s_nop 1
    v_fmac_f32 v224, s20, v168
    v_fmac_f32 v225, s20, v169
    v_fmac_f32 v226, s20, v170
    v_fmac_f32 v227, s20, v171
    v_readlane_b32 s20, v47, 42
    s_nop 1
    v_fmac_f32 v224, s20, v172
    v_fmac_f32 v225, s20, v173
    v_fmac_f32 v226, s20, v174
    v_fmac_f32 v227, s20, v175
    v_readlane_b32 s20, v44, 58
    s_nop 1
    v_fmac_f32 v224, s20, v176
    v_fmac_f32 v225, s20, v177
    v_fmac_f32 v226, s20, v178
    v_fmac_f32 v227, s20, v179
    v_readlane_b32 s20, v45, 58
    s_nop 1
    v_fmac_f32 v224, s20, v180
    v_fmac_f32 v225, s20, v181
    v_fmac_f32 v226, s20, v182
    v_fmac_f32 v227, s20, v183
    v_readlane_b32 s20, v46, 58
    s_nop 1
    v_fmac_f32 v224, s20, v184
    v_fmac_f32 v225, s20, v185
    v_fmac_f32 v226, s20, v186
    v_fmac_f32 v227, s20, v187
    v_readlane_b32 s20, v47, 58
    s_nop 1
    v_fmac_f32 v224, s20, v188
    v_fmac_f32 v225, s20, v189
    v_fmac_f32 v226, s20, v190
    v_fmac_f32 v227, s20, v191
    v_readlane_b32 s20, v52, 10
    s_nop 1
    v_fmac_f32 v224, s20, v192
    v_fmac_f32 v225, s20, v193
    v_fmac_f32 v226, s20, v194
    v_fmac_f32 v227, s20, v195
    v_readlane_b32 s20, v53, 10
    s_nop 1
    v_fmac_f32 v224, s20, v196
    v_fmac_f32 v225, s20, v197
    v_fmac_f32 v226, s20, v198
    v_fmac_f32 v227, s20, v199
    v_readlane_b32 s20, v54, 10
    s_nop 1
    v_fmac_f32 v224, s20, v200
    v_fmac_f32 v225, s20, v201
    v_fmac_f32 v226, s20, v202
    v_fmac_f32 v227, s20, v203
    v_cvt_pk_bf16_f32 v6, v224, v225
    v_cvt_pk_bf16_f32 v7, v226, v227
    v_add_u32 v9, 212992, v3
    buffer_store_dwordx2 v[6:7], v9, s[8:11], 0 offen
    s_nop 1
    v_mov_b32 v224, 0
    v_mov_b32 v225, 0
    v_mov_b32 v226, 0
    v_mov_b32 v227, 0
    v_readlane_b32 s20, v36, 11
    s_nop 1
    v_fmac_f32 v224, s20, v64
    v_fmac_f32 v225, s20, v65
    v_fmac_f32 v226, s20, v66
    v_fmac_f32 v227, s20, v67
    v_readlane_b32 s20, v37, 11
    s_nop 1
    v_fmac_f32 v224, s20, v68
    v_fmac_f32 v225, s20, v69
    v_fmac_f32 v226, s20, v70
    v_fmac_f32 v227, s20, v71
    v_readlane_b32 s20, v38, 11
    s_nop 1
    v_fmac_f32 v224, s20, v72
    v_fmac_f32 v225, s20, v73
    v_fmac_f32 v226, s20, v74
    v_fmac_f32 v227, s20, v75
    v_readlane_b32 s20, v39, 11
    s_nop 1
    v_fmac_f32 v224, s20, v76
    v_fmac_f32 v225, s20, v77
    v_fmac_f32 v226, s20, v78
    v_fmac_f32 v227, s20, v79
    v_readlane_b32 s20, v36, 27
    s_nop 1
    v_fmac_f32 v224, s20, v80
    v_fmac_f32 v225, s20, v81
    v_fmac_f32 v226, s20, v82
    v_fmac_f32 v227, s20, v83
    v_readlane_b32 s20, v37, 27
    s_nop 1
    v_fmac_f32 v224, s20, v84
    v_fmac_f32 v225, s20, v85
    v_fmac_f32 v226, s20, v86
    v_fmac_f32 v227, s20, v87
    v_readlane_b32 s20, v38, 27
    s_nop 1
    v_fmac_f32 v224, s20, v88
    v_fmac_f32 v225, s20, v89
    v_fmac_f32 v226, s20, v90
    v_fmac_f32 v227, s20, v91
    v_readlane_b32 s20, v39, 27
    s_nop 1
    v_fmac_f32 v224, s20, v92
    v_fmac_f32 v225, s20, v93
    v_fmac_f32 v226, s20, v94
    v_fmac_f32 v227, s20, v95
    v_readlane_b32 s20, v36, 43
    s_nop 1
    v_fmac_f32 v224, s20, v96
    v_fmac_f32 v225, s20, v97
    v_fmac_f32 v226, s20, v98
    v_fmac_f32 v227, s20, v99
    v_readlane_b32 s20, v37, 43
    s_nop 1
    v_fmac_f32 v224, s20, v100
    v_fmac_f32 v225, s20, v101
    v_fmac_f32 v226, s20, v102
    v_fmac_f32 v227, s20, v103
    v_readlane_b32 s20, v38, 43
    s_nop 1
    v_fmac_f32 v224, s20, v104
    v_fmac_f32 v225, s20, v105
    v_fmac_f32 v226, s20, v106
    v_fmac_f32 v227, s20, v107
    v_readlane_b32 s20, v39, 43
    s_nop 1
    v_fmac_f32 v224, s20, v108
    v_fmac_f32 v225, s20, v109
    v_fmac_f32 v226, s20, v110
    v_fmac_f32 v227, s20, v111
    v_readlane_b32 s20, v36, 59
    s_nop 1
    v_fmac_f32 v224, s20, v112
    v_fmac_f32 v225, s20, v113
    v_fmac_f32 v226, s20, v114
    v_fmac_f32 v227, s20, v115
    v_readlane_b32 s20, v37, 59
    s_nop 1
    v_fmac_f32 v224, s20, v116
    v_fmac_f32 v225, s20, v117
    v_fmac_f32 v226, s20, v118
    v_fmac_f32 v227, s20, v119
    v_readlane_b32 s20, v38, 59
    s_nop 1
    v_fmac_f32 v224, s20, v120
    v_fmac_f32 v225, s20, v121
    v_fmac_f32 v226, s20, v122
    v_fmac_f32 v227, s20, v123
    v_readlane_b32 s20, v39, 59
    s_nop 1
    v_fmac_f32 v224, s20, v124
    v_fmac_f32 v225, s20, v125
    v_fmac_f32 v226, s20, v126
    v_fmac_f32 v227, s20, v127
    v_readlane_b32 s20, v44, 11
    s_nop 1
    v_fmac_f32 v224, s20, v128
    v_fmac_f32 v225, s20, v129
    v_fmac_f32 v226, s20, v130
    v_fmac_f32 v227, s20, v131
    v_readlane_b32 s20, v45, 11
    s_nop 1
    v_fmac_f32 v224, s20, v132
    v_fmac_f32 v225, s20, v133
    v_fmac_f32 v226, s20, v134
    v_fmac_f32 v227, s20, v135
    v_readlane_b32 s20, v46, 11
    s_nop 1
    v_fmac_f32 v224, s20, v136
    v_fmac_f32 v225, s20, v137
    v_fmac_f32 v226, s20, v138
    v_fmac_f32 v227, s20, v139
    v_readlane_b32 s20, v47, 11
    s_nop 1
    v_fmac_f32 v224, s20, v140
    v_fmac_f32 v225, s20, v141
    v_fmac_f32 v226, s20, v142
    v_fmac_f32 v227, s20, v143
    v_readlane_b32 s20, v44, 27
    s_nop 1
    v_fmac_f32 v224, s20, v144
    v_fmac_f32 v225, s20, v145
    v_fmac_f32 v226, s20, v146
    v_fmac_f32 v227, s20, v147
    v_readlane_b32 s20, v45, 27
    s_nop 1
    v_fmac_f32 v224, s20, v148
    v_fmac_f32 v225, s20, v149
    v_fmac_f32 v226, s20, v150
    v_fmac_f32 v227, s20, v151
    v_readlane_b32 s20, v46, 27
    s_nop 1
    v_fmac_f32 v224, s20, v152
    v_fmac_f32 v225, s20, v153
    v_fmac_f32 v226, s20, v154
    v_fmac_f32 v227, s20, v155
    v_readlane_b32 s20, v47, 27
    s_nop 1
    v_fmac_f32 v224, s20, v156
    v_fmac_f32 v225, s20, v157
    v_fmac_f32 v226, s20, v158
    v_fmac_f32 v227, s20, v159
    v_readlane_b32 s20, v44, 43
    s_nop 1
    v_fmac_f32 v224, s20, v160
    v_fmac_f32 v225, s20, v161
    v_fmac_f32 v226, s20, v162
    v_fmac_f32 v227, s20, v163
    v_readlane_b32 s20, v45, 43
    s_nop 1
    v_fmac_f32 v224, s20, v164
    v_fmac_f32 v225, s20, v165
    v_fmac_f32 v226, s20, v166
    v_fmac_f32 v227, s20, v167
    v_readlane_b32 s20, v46, 43
    s_nop 1
    v_fmac_f32 v224, s20, v168
    v_fmac_f32 v225, s20, v169
    v_fmac_f32 v226, s20, v170
    v_fmac_f32 v227, s20, v171
    v_readlane_b32 s20, v47, 43
    s_nop 1
    v_fmac_f32 v224, s20, v172
    v_fmac_f32 v225, s20, v173
    v_fmac_f32 v226, s20, v174
    v_fmac_f32 v227, s20, v175
    v_readlane_b32 s20, v44, 59
    s_nop 1
    v_fmac_f32 v224, s20, v176
    v_fmac_f32 v225, s20, v177
    v_fmac_f32 v226, s20, v178
    v_fmac_f32 v227, s20, v179
    v_readlane_b32 s20, v45, 59
    s_nop 1
    v_fmac_f32 v224, s20, v180
    v_fmac_f32 v225, s20, v181
    v_fmac_f32 v226, s20, v182
    v_fmac_f32 v227, s20, v183
    v_readlane_b32 s20, v46, 59
    s_nop 1
    v_fmac_f32 v224, s20, v184
    v_fmac_f32 v225, s20, v185
    v_fmac_f32 v226, s20, v186
    v_fmac_f32 v227, s20, v187
    v_readlane_b32 s20, v47, 59
    s_nop 1
    v_fmac_f32 v224, s20, v188
    v_fmac_f32 v225, s20, v189
    v_fmac_f32 v226, s20, v190
    v_fmac_f32 v227, s20, v191
    v_readlane_b32 s20, v52, 11
    s_nop 1
    v_fmac_f32 v224, s20, v192
    v_fmac_f32 v225, s20, v193
    v_fmac_f32 v226, s20, v194
    v_fmac_f32 v227, s20, v195
    v_readlane_b32 s20, v53, 11
    s_nop 1
    v_fmac_f32 v224, s20, v196
    v_fmac_f32 v225, s20, v197
    v_fmac_f32 v226, s20, v198
    v_fmac_f32 v227, s20, v199
    v_readlane_b32 s20, v54, 11
    s_nop 1
    v_fmac_f32 v224, s20, v200
    v_fmac_f32 v225, s20, v201
    v_fmac_f32 v226, s20, v202
    v_fmac_f32 v227, s20, v203
    v_readlane_b32 s20, v55, 11
    s_nop 1
    v_fmac_f32 v224, s20, v204
    v_fmac_f32 v225, s20, v205
    v_fmac_f32 v226, s20, v206
    v_fmac_f32 v227, s20, v207
    v_cvt_pk_bf16_f32 v6, v224, v225
    v_cvt_pk_bf16_f32 v7, v226, v227
    v_add_u32 v9, 221184, v3
    buffer_store_dwordx2 v[6:7], v9, s[8:11], 0 offen
    s_nop 1
    v_mov_b32 v224, 0
    v_mov_b32 v225, 0
    v_mov_b32 v226, 0
    v_mov_b32 v227, 0
    v_readlane_b32 s20, v36, 12
    s_nop 1
    v_fmac_f32 v224, s20, v64
    v_fmac_f32 v225, s20, v65
    v_fmac_f32 v226, s20, v66
    v_fmac_f32 v227, s20, v67
    v_readlane_b32 s20, v37, 12
    s_nop 1
    v_fmac_f32 v224, s20, v68
    v_fmac_f32 v225, s20, v69
    v_fmac_f32 v226, s20, v70
    v_fmac_f32 v227, s20, v71
    v_readlane_b32 s20, v38, 12
    s_nop 1
    v_fmac_f32 v224, s20, v72
    v_fmac_f32 v225, s20, v73
    v_fmac_f32 v226, s20, v74
    v_fmac_f32 v227, s20, v75
    v_readlane_b32 s20, v39, 12
    s_nop 1
    v_fmac_f32 v224, s20, v76
    v_fmac_f32 v225, s20, v77
    v_fmac_f32 v226, s20, v78
    v_fmac_f32 v227, s20, v79
    v_readlane_b32 s20, v36, 28
    s_nop 1
    v_fmac_f32 v224, s20, v80
    v_fmac_f32 v225, s20, v81
    v_fmac_f32 v226, s20, v82
    v_fmac_f32 v227, s20, v83
    v_readlane_b32 s20, v37, 28
    s_nop 1
    v_fmac_f32 v224, s20, v84
    v_fmac_f32 v225, s20, v85
    v_fmac_f32 v226, s20, v86
    v_fmac_f32 v227, s20, v87
    v_readlane_b32 s20, v38, 28
    s_nop 1
    v_fmac_f32 v224, s20, v88
    v_fmac_f32 v225, s20, v89
    v_fmac_f32 v226, s20, v90
    v_fmac_f32 v227, s20, v91
    v_readlane_b32 s20, v39, 28
    s_nop 1
    v_fmac_f32 v224, s20, v92
    v_fmac_f32 v225, s20, v93
    v_fmac_f32 v226, s20, v94
    v_fmac_f32 v227, s20, v95
    v_readlane_b32 s20, v36, 44
    s_nop 1
    v_fmac_f32 v224, s20, v96
    v_fmac_f32 v225, s20, v97
    v_fmac_f32 v226, s20, v98
    v_fmac_f32 v227, s20, v99
    v_readlane_b32 s20, v37, 44
    s_nop 1
    v_fmac_f32 v224, s20, v100
    v_fmac_f32 v225, s20, v101
    v_fmac_f32 v226, s20, v102
    v_fmac_f32 v227, s20, v103
    v_readlane_b32 s20, v38, 44
    s_nop 1
    v_fmac_f32 v224, s20, v104
    v_fmac_f32 v225, s20, v105
    v_fmac_f32 v226, s20, v106
    v_fmac_f32 v227, s20, v107
    v_readlane_b32 s20, v39, 44
    s_nop 1
    v_fmac_f32 v224, s20, v108
    v_fmac_f32 v225, s20, v109
    v_fmac_f32 v226, s20, v110
    v_fmac_f32 v227, s20, v111
    v_readlane_b32 s20, v36, 60
    s_nop 1
    v_fmac_f32 v224, s20, v112
    v_fmac_f32 v225, s20, v113
    v_fmac_f32 v226, s20, v114
    v_fmac_f32 v227, s20, v115
    v_readlane_b32 s20, v37, 60
    s_nop 1
    v_fmac_f32 v224, s20, v116
    v_fmac_f32 v225, s20, v117
    v_fmac_f32 v226, s20, v118
    v_fmac_f32 v227, s20, v119
    v_readlane_b32 s20, v38, 60
    s_nop 1
    v_fmac_f32 v224, s20, v120
    v_fmac_f32 v225, s20, v121
    v_fmac_f32 v226, s20, v122
    v_fmac_f32 v227, s20, v123
    v_readlane_b32 s20, v39, 60
    s_nop 1
    v_fmac_f32 v224, s20, v124
    v_fmac_f32 v225, s20, v125
    v_fmac_f32 v226, s20, v126
    v_fmac_f32 v227, s20, v127
    v_readlane_b32 s20, v44, 12
    s_nop 1
    v_fmac_f32 v224, s20, v128
    v_fmac_f32 v225, s20, v129
    v_fmac_f32 v226, s20, v130
    v_fmac_f32 v227, s20, v131
    v_readlane_b32 s20, v45, 12
    s_nop 1
    v_fmac_f32 v224, s20, v132
    v_fmac_f32 v225, s20, v133
    v_fmac_f32 v226, s20, v134
    v_fmac_f32 v227, s20, v135
    v_readlane_b32 s20, v46, 12
    s_nop 1
    v_fmac_f32 v224, s20, v136
    v_fmac_f32 v225, s20, v137
    v_fmac_f32 v226, s20, v138
    v_fmac_f32 v227, s20, v139
    v_readlane_b32 s20, v47, 12
    s_nop 1
    v_fmac_f32 v224, s20, v140
    v_fmac_f32 v225, s20, v141
    v_fmac_f32 v226, s20, v142
    v_fmac_f32 v227, s20, v143
    v_readlane_b32 s20, v44, 28
    s_nop 1
    v_fmac_f32 v224, s20, v144
    v_fmac_f32 v225, s20, v145
    v_fmac_f32 v226, s20, v146
    v_fmac_f32 v227, s20, v147
    v_readlane_b32 s20, v45, 28
    s_nop 1
    v_fmac_f32 v224, s20, v148
    v_fmac_f32 v225, s20, v149
    v_fmac_f32 v226, s20, v150
    v_fmac_f32 v227, s20, v151
    v_readlane_b32 s20, v46, 28
    s_nop 1
    v_fmac_f32 v224, s20, v152
    v_fmac_f32 v225, s20, v153
    v_fmac_f32 v226, s20, v154
    v_fmac_f32 v227, s20, v155
    v_readlane_b32 s20, v47, 28
    s_nop 1
    v_fmac_f32 v224, s20, v156
    v_fmac_f32 v225, s20, v157
    v_fmac_f32 v226, s20, v158
    v_fmac_f32 v227, s20, v159
    v_readlane_b32 s20, v44, 44
    s_nop 1
    v_fmac_f32 v224, s20, v160
    v_fmac_f32 v225, s20, v161
    v_fmac_f32 v226, s20, v162
    v_fmac_f32 v227, s20, v163
    v_readlane_b32 s20, v45, 44
    s_nop 1
    v_fmac_f32 v224, s20, v164
    v_fmac_f32 v225, s20, v165
    v_fmac_f32 v226, s20, v166
    v_fmac_f32 v227, s20, v167
    v_readlane_b32 s20, v46, 44
    s_nop 1
    v_fmac_f32 v224, s20, v168
    v_fmac_f32 v225, s20, v169
    v_fmac_f32 v226, s20, v170
    v_fmac_f32 v227, s20, v171
    v_readlane_b32 s20, v47, 44
    s_nop 1
    v_fmac_f32 v224, s20, v172
    v_fmac_f32 v225, s20, v173
    v_fmac_f32 v226, s20, v174
    v_fmac_f32 v227, s20, v175
    v_readlane_b32 s20, v44, 60
    s_nop 1
    v_fmac_f32 v224, s20, v176
    v_fmac_f32 v225, s20, v177
    v_fmac_f32 v226, s20, v178
    v_fmac_f32 v227, s20, v179
    v_readlane_b32 s20, v45, 60
    s_nop 1
    v_fmac_f32 v224, s20, v180
    v_fmac_f32 v225, s20, v181
    v_fmac_f32 v226, s20, v182
    v_fmac_f32 v227, s20, v183
    v_readlane_b32 s20, v46, 60
    s_nop 1
    v_fmac_f32 v224, s20, v184
    v_fmac_f32 v225, s20, v185
    v_fmac_f32 v226, s20, v186
    v_fmac_f32 v227, s20, v187
    v_readlane_b32 s20, v47, 60
    s_nop 1
    v_fmac_f32 v224, s20, v188
    v_fmac_f32 v225, s20, v189
    v_fmac_f32 v226, s20, v190
    v_fmac_f32 v227, s20, v191
    v_readlane_b32 s20, v52, 12
    s_nop 1
    v_fmac_f32 v224, s20, v192
    v_fmac_f32 v225, s20, v193
    v_fmac_f32 v226, s20, v194
    v_fmac_f32 v227, s20, v195
    v_readlane_b32 s20, v53, 12
    s_nop 1
    v_fmac_f32 v224, s20, v196
    v_fmac_f32 v225, s20, v197
    v_fmac_f32 v226, s20, v198
    v_fmac_f32 v227, s20, v199
    v_readlane_b32 s20, v54, 12
    s_nop 1
    v_fmac_f32 v224, s20, v200
    v_fmac_f32 v225, s20, v201
    v_fmac_f32 v226, s20, v202
    v_fmac_f32 v227, s20, v203
    v_readlane_b32 s20, v55, 12
    s_nop 1
    v_fmac_f32 v224, s20, v204
    v_fmac_f32 v225, s20, v205
    v_fmac_f32 v226, s20, v206
    v_fmac_f32 v227, s20, v207
    v_readlane_b32 s20, v52, 28
    s_nop 1
    v_fmac_f32 v224, s20, v208
    v_fmac_f32 v225, s20, v209
    v_fmac_f32 v226, s20, v210
    v_fmac_f32 v227, s20, v211
    v_cvt_pk_bf16_f32 v6, v224, v225
    v_cvt_pk_bf16_f32 v7, v226, v227
    v_add_u32 v9, 229376, v3
    buffer_store_dwordx2 v[6:7], v9, s[8:11], 0 offen
    s_nop 1
    v_mov_b32 v224, 0
    v_mov_b32 v225, 0
    v_mov_b32 v226, 0
    v_mov_b32 v227, 0
    v_readlane_b32 s20, v36, 13
    s_nop 1
    v_fmac_f32 v224, s20, v64
    v_fmac_f32 v225, s20, v65
    v_fmac_f32 v226, s20, v66
    v_fmac_f32 v227, s20, v67
    v_readlane_b32 s20, v37, 13
    s_nop 1
    v_fmac_f32 v224, s20, v68
    v_fmac_f32 v225, s20, v69
    v_fmac_f32 v226, s20, v70
    v_fmac_f32 v227, s20, v71
    v_readlane_b32 s20, v38, 13
    s_nop 1
    v_fmac_f32 v224, s20, v72
    v_fmac_f32 v225, s20, v73
    v_fmac_f32 v226, s20, v74
    v_fmac_f32 v227, s20, v75
    v_readlane_b32 s20, v39, 13
    s_nop 1
    v_fmac_f32 v224, s20, v76
    v_fmac_f32 v225, s20, v77
    v_fmac_f32 v226, s20, v78
    v_fmac_f32 v227, s20, v79
    v_readlane_b32 s20, v36, 29
    s_nop 1
    v_fmac_f32 v224, s20, v80
    v_fmac_f32 v225, s20, v81
    v_fmac_f32 v226, s20, v82
    v_fmac_f32 v227, s20, v83
    v_readlane_b32 s20, v37, 29
    s_nop 1
    v_fmac_f32 v224, s20, v84
    v_fmac_f32 v225, s20, v85
    v_fmac_f32 v226, s20, v86
    v_fmac_f32 v227, s20, v87
    v_readlane_b32 s20, v38, 29
    s_nop 1
    v_fmac_f32 v224, s20, v88
    v_fmac_f32 v225, s20, v89
    v_fmac_f32 v226, s20, v90
    v_fmac_f32 v227, s20, v91
    v_readlane_b32 s20, v39, 29
    s_nop 1
    v_fmac_f32 v224, s20, v92
    v_fmac_f32 v225, s20, v93
    v_fmac_f32 v226, s20, v94
    v_fmac_f32 v227, s20, v95
    v_readlane_b32 s20, v36, 45
    s_nop 1
    v_fmac_f32 v224, s20, v96
    v_fmac_f32 v225, s20, v97
    v_fmac_f32 v226, s20, v98
    v_fmac_f32 v227, s20, v99
    v_readlane_b32 s20, v37, 45
    s_nop 1
    v_fmac_f32 v224, s20, v100
    v_fmac_f32 v225, s20, v101
    v_fmac_f32 v226, s20, v102
    v_fmac_f32 v227, s20, v103
    v_readlane_b32 s20, v38, 45
    s_nop 1
    v_fmac_f32 v224, s20, v104
    v_fmac_f32 v225, s20, v105
    v_fmac_f32 v226, s20, v106
    v_fmac_f32 v227, s20, v107
    v_readlane_b32 s20, v39, 45
    s_nop 1
    v_fmac_f32 v224, s20, v108
    v_fmac_f32 v225, s20, v109
    v_fmac_f32 v226, s20, v110
    v_fmac_f32 v227, s20, v111
    v_readlane_b32 s20, v36, 61
    s_nop 1
    v_fmac_f32 v224, s20, v112
    v_fmac_f32 v225, s20, v113
    v_fmac_f32 v226, s20, v114
    v_fmac_f32 v227, s20, v115
    v_readlane_b32 s20, v37, 61
    s_nop 1
    v_fmac_f32 v224, s20, v116
    v_fmac_f32 v225, s20, v117
    v_fmac_f32 v226, s20, v118
    v_fmac_f32 v227, s20, v119
    v_readlane_b32 s20, v38, 61
    s_nop 1
    v_fmac_f32 v224, s20, v120
    v_fmac_f32 v225, s20, v121
    v_fmac_f32 v226, s20, v122
    v_fmac_f32 v227, s20, v123
    v_readlane_b32 s20, v39, 61
    s_nop 1
    v_fmac_f32 v224, s20, v124
    v_fmac_f32 v225, s20, v125
    v_fmac_f32 v226, s20, v126
    v_fmac_f32 v227, s20, v127
    v_readlane_b32 s20, v44, 13
    s_nop 1
    v_fmac_f32 v224, s20, v128
    v_fmac_f32 v225, s20, v129
    v_fmac_f32 v226, s20, v130
    v_fmac_f32 v227, s20, v131
    v_readlane_b32 s20, v45, 13
    s_nop 1
    v_fmac_f32 v224, s20, v132
    v_fmac_f32 v225, s20, v133
    v_fmac_f32 v226, s20, v134
    v_fmac_f32 v227, s20, v135
    v_readlane_b32 s20, v46, 13
    s_nop 1
    v_fmac_f32 v224, s20, v136
    v_fmac_f32 v225, s20, v137
    v_fmac_f32 v226, s20, v138
    v_fmac_f32 v227, s20, v139
    v_readlane_b32 s20, v47, 13
    s_nop 1
    v_fmac_f32 v224, s20, v140
    v_fmac_f32 v225, s20, v141
    v_fmac_f32 v226, s20, v142
    v_fmac_f32 v227, s20, v143
    v_readlane_b32 s20, v44, 29
    s_nop 1
    v_fmac_f32 v224, s20, v144
    v_fmac_f32 v225, s20, v145
    v_fmac_f32 v226, s20, v146
    v_fmac_f32 v227, s20, v147
    v_readlane_b32 s20, v45, 29
    s_nop 1
    v_fmac_f32 v224, s20, v148
    v_fmac_f32 v225, s20, v149
    v_fmac_f32 v226, s20, v150
    v_fmac_f32 v227, s20, v151
    v_readlane_b32 s20, v46, 29
    s_nop 1
    v_fmac_f32 v224, s20, v152
    v_fmac_f32 v225, s20, v153
    v_fmac_f32 v226, s20, v154
    v_fmac_f32 v227, s20, v155
    v_readlane_b32 s20, v47, 29
    s_nop 1
    v_fmac_f32 v224, s20, v156
    v_fmac_f32 v225, s20, v157
    v_fmac_f32 v226, s20, v158
    v_fmac_f32 v227, s20, v159
    v_readlane_b32 s20, v44, 45
    s_nop 1
    v_fmac_f32 v224, s20, v160
    v_fmac_f32 v225, s20, v161
    v_fmac_f32 v226, s20, v162
    v_fmac_f32 v227, s20, v163
    v_readlane_b32 s20, v45, 45
    s_nop 1
    v_fmac_f32 v224, s20, v164
    v_fmac_f32 v225, s20, v165
    v_fmac_f32 v226, s20, v166
    v_fmac_f32 v227, s20, v167
    v_readlane_b32 s20, v46, 45
    s_nop 1
    v_fmac_f32 v224, s20, v168
    v_fmac_f32 v225, s20, v169
    v_fmac_f32 v226, s20, v170
    v_fmac_f32 v227, s20, v171
    v_readlane_b32 s20, v47, 45
    s_nop 1
    v_fmac_f32 v224, s20, v172
    v_fmac_f32 v225, s20, v173
    v_fmac_f32 v226, s20, v174
    v_fmac_f32 v227, s20, v175
    v_readlane_b32 s20, v44, 61
    s_nop 1
    v_fmac_f32 v224, s20, v176
    v_fmac_f32 v225, s20, v177
    v_fmac_f32 v226, s20, v178
    v_fmac_f32 v227, s20, v179
    v_readlane_b32 s20, v45, 61
    s_nop 1
    v_fmac_f32 v224, s20, v180
    v_fmac_f32 v225, s20, v181
    v_fmac_f32 v226, s20, v182
    v_fmac_f32 v227, s20, v183
    v_readlane_b32 s20, v46, 61
    s_nop 1
    v_fmac_f32 v224, s20, v184
    v_fmac_f32 v225, s20, v185
    v_fmac_f32 v226, s20, v186
    v_fmac_f32 v227, s20, v187
    v_readlane_b32 s20, v47, 61
    s_nop 1
    v_fmac_f32 v224, s20, v188
    v_fmac_f32 v225, s20, v189
    v_fmac_f32 v226, s20, v190
    v_fmac_f32 v227, s20, v191
    v_readlane_b32 s20, v52, 13
    s_nop 1
    v_fmac_f32 v224, s20, v192
    v_fmac_f32 v225, s20, v193
    v_fmac_f32 v226, s20, v194
    v_fmac_f32 v227, s20, v195
    v_readlane_b32 s20, v53, 13
    s_nop 1
    v_fmac_f32 v224, s20, v196
    v_fmac_f32 v225, s20, v197
    v_fmac_f32 v226, s20, v198
    v_fmac_f32 v227, s20, v199
    v_readlane_b32 s20, v54, 13
    s_nop 1
    v_fmac_f32 v224, s20, v200
    v_fmac_f32 v225, s20, v201
    v_fmac_f32 v226, s20, v202
    v_fmac_f32 v227, s20, v203
    v_readlane_b32 s20, v55, 13
    s_nop 1
    v_fmac_f32 v224, s20, v204
    v_fmac_f32 v225, s20, v205
    v_fmac_f32 v226, s20, v206
    v_fmac_f32 v227, s20, v207
    v_readlane_b32 s20, v52, 29
    s_nop 1
    v_fmac_f32 v224, s20, v208
    v_fmac_f32 v225, s20, v209
    v_fmac_f32 v226, s20, v210
    v_fmac_f32 v227, s20, v211
    v_readlane_b32 s20, v53, 29
    s_nop 1
    v_fmac_f32 v224, s20, v212
    v_fmac_f32 v225, s20, v213
    v_fmac_f32 v226, s20, v214
    v_fmac_f32 v227, s20, v215
    v_cvt_pk_bf16_f32 v6, v224, v225
    v_cvt_pk_bf16_f32 v7, v226, v227
    v_add_u32 v9, 237568, v3
    buffer_store_dwordx2 v[6:7], v9, s[8:11], 0 offen
    s_nop 1
    v_mov_b32 v224, 0
    v_mov_b32 v225, 0
    v_mov_b32 v226, 0
    v_mov_b32 v227, 0
    v_readlane_b32 s20, v36, 14
    s_nop 1
    v_fmac_f32 v224, s20, v64
    v_fmac_f32 v225, s20, v65
    v_fmac_f32 v226, s20, v66
    v_fmac_f32 v227, s20, v67
    v_readlane_b32 s20, v37, 14
    s_nop 1
    v_fmac_f32 v224, s20, v68
    v_fmac_f32 v225, s20, v69
    v_fmac_f32 v226, s20, v70
    v_fmac_f32 v227, s20, v71
    v_readlane_b32 s20, v38, 14
    s_nop 1
    v_fmac_f32 v224, s20, v72
    v_fmac_f32 v225, s20, v73
    v_fmac_f32 v226, s20, v74
    v_fmac_f32 v227, s20, v75
    v_readlane_b32 s20, v39, 14
    s_nop 1
    v_fmac_f32 v224, s20, v76
    v_fmac_f32 v225, s20, v77
    v_fmac_f32 v226, s20, v78
    v_fmac_f32 v227, s20, v79
    v_readlane_b32 s20, v36, 30
    s_nop 1
    v_fmac_f32 v224, s20, v80
    v_fmac_f32 v225, s20, v81
    v_fmac_f32 v226, s20, v82
    v_fmac_f32 v227, s20, v83
    v_readlane_b32 s20, v37, 30
    s_nop 1
    v_fmac_f32 v224, s20, v84
    v_fmac_f32 v225, s20, v85
    v_fmac_f32 v226, s20, v86
    v_fmac_f32 v227, s20, v87
    v_readlane_b32 s20, v38, 30
    s_nop 1
    v_fmac_f32 v224, s20, v88
    v_fmac_f32 v225, s20, v89
    v_fmac_f32 v226, s20, v90
    v_fmac_f32 v227, s20, v91
    v_readlane_b32 s20, v39, 30
    s_nop 1
    v_fmac_f32 v224, s20, v92
    v_fmac_f32 v225, s20, v93
    v_fmac_f32 v226, s20, v94
    v_fmac_f32 v227, s20, v95
    v_readlane_b32 s20, v36, 46
    s_nop 1
    v_fmac_f32 v224, s20, v96
    v_fmac_f32 v225, s20, v97
    v_fmac_f32 v226, s20, v98
    v_fmac_f32 v227, s20, v99
    v_readlane_b32 s20, v37, 46
    s_nop 1
    v_fmac_f32 v224, s20, v100
    v_fmac_f32 v225, s20, v101
    v_fmac_f32 v226, s20, v102
    v_fmac_f32 v227, s20, v103
    v_readlane_b32 s20, v38, 46
    s_nop 1
    v_fmac_f32 v224, s20, v104
    v_fmac_f32 v225, s20, v105
    v_fmac_f32 v226, s20, v106
    v_fmac_f32 v227, s20, v107
    v_readlane_b32 s20, v39, 46
    s_nop 1
    v_fmac_f32 v224, s20, v108
    v_fmac_f32 v225, s20, v109
    v_fmac_f32 v226, s20, v110
    v_fmac_f32 v227, s20, v111
    v_readlane_b32 s20, v36, 62
    s_nop 1
    v_fmac_f32 v224, s20, v112
    v_fmac_f32 v225, s20, v113
    v_fmac_f32 v226, s20, v114
    v_fmac_f32 v227, s20, v115
    v_readlane_b32 s20, v37, 62
    s_nop 1
    v_fmac_f32 v224, s20, v116
    v_fmac_f32 v225, s20, v117
    v_fmac_f32 v226, s20, v118
    v_fmac_f32 v227, s20, v119
    v_readlane_b32 s20, v38, 62
    s_nop 1
    v_fmac_f32 v224, s20, v120
    v_fmac_f32 v225, s20, v121
    v_fmac_f32 v226, s20, v122
    v_fmac_f32 v227, s20, v123
    v_readlane_b32 s20, v39, 62
    s_nop 1
    v_fmac_f32 v224, s20, v124
    v_fmac_f32 v225, s20, v125
    v_fmac_f32 v226, s20, v126
    v_fmac_f32 v227, s20, v127
    v_readlane_b32 s20, v44, 14
    s_nop 1
    v_fmac_f32 v224, s20, v128
    v_fmac_f32 v225, s20, v129
    v_fmac_f32 v226, s20, v130
    v_fmac_f32 v227, s20, v131
    v_readlane_b32 s20, v45, 14
    s_nop 1
    v_fmac_f32 v224, s20, v132
    v_fmac_f32 v225, s20, v133
    v_fmac_f32 v226, s20, v134
    v_fmac_f32 v227, s20, v135
    v_readlane_b32 s20, v46, 14
    s_nop 1
    v_fmac_f32 v224, s20, v136
    v_fmac_f32 v225, s20, v137
    v_fmac_f32 v226, s20, v138
    v_fmac_f32 v227, s20, v139
    v_readlane_b32 s20, v47, 14
    s_nop 1
    v_fmac_f32 v224, s20, v140
    v_fmac_f32 v225, s20, v141
    v_fmac_f32 v226, s20, v142
    v_fmac_f32 v227, s20, v143
    v_readlane_b32 s20, v44, 30
    s_nop 1
    v_fmac_f32 v224, s20, v144
    v_fmac_f32 v225, s20, v145
    v_fmac_f32 v226, s20, v146
    v_fmac_f32 v227, s20, v147
    v_readlane_b32 s20, v45, 30
    s_nop 1
    v_fmac_f32 v224, s20, v148
    v_fmac_f32 v225, s20, v149
    v_fmac_f32 v226, s20, v150
    v_fmac_f32 v227, s20, v151
    v_readlane_b32 s20, v46, 30
    s_nop 1
    v_fmac_f32 v224, s20, v152
    v_fmac_f32 v225, s20, v153
    v_fmac_f32 v226, s20, v154
    v_fmac_f32 v227, s20, v155
    v_readlane_b32 s20, v47, 30
    s_nop 1
    v_fmac_f32 v224, s20, v156
    v_fmac_f32 v225, s20, v157
    v_fmac_f32 v226, s20, v158
    v_fmac_f32 v227, s20, v159
    v_readlane_b32 s20, v44, 46
    s_nop 1
    v_fmac_f32 v224, s20, v160
    v_fmac_f32 v225, s20, v161
    v_fmac_f32 v226, s20, v162
    v_fmac_f32 v227, s20, v163
    v_readlane_b32 s20, v45, 46
    s_nop 1
    v_fmac_f32 v224, s20, v164
    v_fmac_f32 v225, s20, v165
    v_fmac_f32 v226, s20, v166
    v_fmac_f32 v227, s20, v167
    v_readlane_b32 s20, v46, 46
    s_nop 1
    v_fmac_f32 v224, s20, v168
    v_fmac_f32 v225, s20, v169
    v_fmac_f32 v226, s20, v170
    v_fmac_f32 v227, s20, v171
    v_readlane_b32 s20, v47, 46
    s_nop 1
    v_fmac_f32 v224, s20, v172
    v_fmac_f32 v225, s20, v173
    v_fmac_f32 v226, s20, v174
    v_fmac_f32 v227, s20, v175
    v_readlane_b32 s20, v44, 62
    s_nop 1
    v_fmac_f32 v224, s20, v176
    v_fmac_f32 v225, s20, v177
    v_fmac_f32 v226, s20, v178
    v_fmac_f32 v227, s20, v179
    v_readlane_b32 s20, v45, 62
    s_nop 1
    v_fmac_f32 v224, s20, v180
    v_fmac_f32 v225, s20, v181
    v_fmac_f32 v226, s20, v182
    v_fmac_f32 v227, s20, v183
    v_readlane_b32 s20, v46, 62
    s_nop 1
    v_fmac_f32 v224, s20, v184
    v_fmac_f32 v225, s20, v185
    v_fmac_f32 v226, s20, v186
    v_fmac_f32 v227, s20, v187
    v_readlane_b32 s20, v47, 62
    s_nop 1
    v_fmac_f32 v224, s20, v188
    v_fmac_f32 v225, s20, v189
    v_fmac_f32 v226, s20, v190
    v_fmac_f32 v227, s20, v191
    v_readlane_b32 s20, v52, 14
    s_nop 1
    v_fmac_f32 v224, s20, v192
    v_fmac_f32 v225, s20, v193
    v_fmac_f32 v226, s20, v194
    v_fmac_f32 v227, s20, v195
    v_readlane_b32 s20, v53, 14
    s_nop 1
    v_fmac_f32 v224, s20, v196
    v_fmac_f32 v225, s20, v197
    v_fmac_f32 v226, s20, v198
    v_fmac_f32 v227, s20, v199
    v_readlane_b32 s20, v54, 14
    s_nop 1
    v_fmac_f32 v224, s20, v200
    v_fmac_f32 v225, s20, v201
    v_fmac_f32 v226, s20, v202
    v_fmac_f32 v227, s20, v203
    v_readlane_b32 s20, v55, 14
    s_nop 1
    v_fmac_f32 v224, s20, v204
    v_fmac_f32 v225, s20, v205
    v_fmac_f32 v226, s20, v206
    v_fmac_f32 v227, s20, v207
    v_readlane_b32 s20, v52, 30
    s_nop 1
    v_fmac_f32 v224, s20, v208
    v_fmac_f32 v225, s20, v209
    v_fmac_f32 v226, s20, v210
    v_fmac_f32 v227, s20, v211
    v_readlane_b32 s20, v53, 30
    s_nop 1
    v_fmac_f32 v224, s20, v212
    v_fmac_f32 v225, s20, v213
    v_fmac_f32 v226, s20, v214
    v_fmac_f32 v227, s20, v215
    v_readlane_b32 s20, v54, 30
    s_nop 1
    v_fmac_f32 v224, s20, v216
    v_fmac_f32 v225, s20, v217
    v_fmac_f32 v226, s20, v218
    v_fmac_f32 v227, s20, v219
    v_cvt_pk_bf16_f32 v6, v224, v225
    v_cvt_pk_bf16_f32 v7, v226, v227
    v_add_u32 v9, 245760, v3
    buffer_store_dwordx2 v[6:7], v9, s[8:11], 0 offen
    s_nop 1
    v_mov_b32 v224, 0
    v_mov_b32 v225, 0
    v_mov_b32 v226, 0
    v_mov_b32 v227, 0
    v_readlane_b32 s20, v36, 15
    s_nop 1
    v_fmac_f32 v224, s20, v64
    v_fmac_f32 v225, s20, v65
    v_fmac_f32 v226, s20, v66
    v_fmac_f32 v227, s20, v67
    v_readlane_b32 s20, v37, 15
    s_nop 1
    v_fmac_f32 v224, s20, v68
    v_fmac_f32 v225, s20, v69
    v_fmac_f32 v226, s20, v70
    v_fmac_f32 v227, s20, v71
    v_readlane_b32 s20, v38, 15
    s_nop 1
    v_fmac_f32 v224, s20, v72
    v_fmac_f32 v225, s20, v73
    v_fmac_f32 v226, s20, v74
    v_fmac_f32 v227, s20, v75
    v_readlane_b32 s20, v39, 15
    s_nop 1
    v_fmac_f32 v224, s20, v76
    v_fmac_f32 v225, s20, v77
    v_fmac_f32 v226, s20, v78
    v_fmac_f32 v227, s20, v79
    v_readlane_b32 s20, v36, 31
    s_nop 1
    v_fmac_f32 v224, s20, v80
    v_fmac_f32 v225, s20, v81
    v_fmac_f32 v226, s20, v82
    v_fmac_f32 v227, s20, v83
    v_readlane_b32 s20, v37, 31
    s_nop 1
    v_fmac_f32 v224, s20, v84
    v_fmac_f32 v225, s20, v85
    v_fmac_f32 v226, s20, v86
    v_fmac_f32 v227, s20, v87
    v_readlane_b32 s20, v38, 31
    s_nop 1
    v_fmac_f32 v224, s20, v88
    v_fmac_f32 v225, s20, v89
    v_fmac_f32 v226, s20, v90
    v_fmac_f32 v227, s20, v91
    v_readlane_b32 s20, v39, 31
    s_nop 1
    v_fmac_f32 v224, s20, v92
    v_fmac_f32 v225, s20, v93
    v_fmac_f32 v226, s20, v94
    v_fmac_f32 v227, s20, v95
    v_readlane_b32 s20, v36, 47
    s_nop 1
    v_fmac_f32 v224, s20, v96
    v_fmac_f32 v225, s20, v97
    v_fmac_f32 v226, s20, v98
    v_fmac_f32 v227, s20, v99
    v_readlane_b32 s20, v37, 47
    s_nop 1
    v_fmac_f32 v224, s20, v100
    v_fmac_f32 v225, s20, v101
    v_fmac_f32 v226, s20, v102
    v_fmac_f32 v227, s20, v103
    v_readlane_b32 s20, v38, 47
    s_nop 1
    v_fmac_f32 v224, s20, v104
    v_fmac_f32 v225, s20, v105
    v_fmac_f32 v226, s20, v106
    v_fmac_f32 v227, s20, v107
    v_readlane_b32 s20, v39, 47
    s_nop 1
    v_fmac_f32 v224, s20, v108
    v_fmac_f32 v225, s20, v109
    v_fmac_f32 v226, s20, v110
    v_fmac_f32 v227, s20, v111
    v_readlane_b32 s20, v36, 63
    s_nop 1
    v_fmac_f32 v224, s20, v112
    v_fmac_f32 v225, s20, v113
    v_fmac_f32 v226, s20, v114
    v_fmac_f32 v227, s20, v115
    v_readlane_b32 s20, v37, 63
    s_nop 1
    v_fmac_f32 v224, s20, v116
    v_fmac_f32 v225, s20, v117
    v_fmac_f32 v226, s20, v118
    v_fmac_f32 v227, s20, v119
    v_readlane_b32 s20, v38, 63
    s_nop 1
    v_fmac_f32 v224, s20, v120
    v_fmac_f32 v225, s20, v121
    v_fmac_f32 v226, s20, v122
    v_fmac_f32 v227, s20, v123
    v_readlane_b32 s20, v39, 63
    s_nop 1
    v_fmac_f32 v224, s20, v124
    v_fmac_f32 v225, s20, v125
    v_fmac_f32 v226, s20, v126
    v_fmac_f32 v227, s20, v127
    v_readlane_b32 s20, v44, 15
    s_nop 1
    v_fmac_f32 v224, s20, v128
    v_fmac_f32 v225, s20, v129
    v_fmac_f32 v226, s20, v130
    v_fmac_f32 v227, s20, v131
    v_readlane_b32 s20, v45, 15
    s_nop 1
    v_fmac_f32 v224, s20, v132
    v_fmac_f32 v225, s20, v133
    v_fmac_f32 v226, s20, v134
    v_fmac_f32 v227, s20, v135
    v_readlane_b32 s20, v46, 15
    s_nop 1
    v_fmac_f32 v224, s20, v136
    v_fmac_f32 v225, s20, v137
    v_fmac_f32 v226, s20, v138
    v_fmac_f32 v227, s20, v139
    v_readlane_b32 s20, v47, 15
    s_nop 1
    v_fmac_f32 v224, s20, v140
    v_fmac_f32 v225, s20, v141
    v_fmac_f32 v226, s20, v142
    v_fmac_f32 v227, s20, v143
    v_readlane_b32 s20, v44, 31
    s_nop 1
    v_fmac_f32 v224, s20, v144
    v_fmac_f32 v225, s20, v145
    v_fmac_f32 v226, s20, v146
    v_fmac_f32 v227, s20, v147
    v_readlane_b32 s20, v45, 31
    s_nop 1
    v_fmac_f32 v224, s20, v148
    v_fmac_f32 v225, s20, v149
    v_fmac_f32 v226, s20, v150
    v_fmac_f32 v227, s20, v151
    v_readlane_b32 s20, v46, 31
    s_nop 1
    v_fmac_f32 v224, s20, v152
    v_fmac_f32 v225, s20, v153
    v_fmac_f32 v226, s20, v154
    v_fmac_f32 v227, s20, v155
    v_readlane_b32 s20, v47, 31
    s_nop 1
    v_fmac_f32 v224, s20, v156
    v_fmac_f32 v225, s20, v157
    v_fmac_f32 v226, s20, v158
    v_fmac_f32 v227, s20, v159
    v_readlane_b32 s20, v44, 47
    s_nop 1
    v_fmac_f32 v224, s20, v160
    v_fmac_f32 v225, s20, v161
    v_fmac_f32 v226, s20, v162
    v_fmac_f32 v227, s20, v163
    v_readlane_b32 s20, v45, 47
    s_nop 1
    v_fmac_f32 v224, s20, v164
    v_fmac_f32 v225, s20, v165
    v_fmac_f32 v226, s20, v166
    v_fmac_f32 v227, s20, v167
    v_readlane_b32 s20, v46, 47
    s_nop 1
    v_fmac_f32 v224, s20, v168
    v_fmac_f32 v225, s20, v169
    v_fmac_f32 v226, s20, v170
    v_fmac_f32 v227, s20, v171
    v_readlane_b32 s20, v47, 47
    s_nop 1
    v_fmac_f32 v224, s20, v172
    v_fmac_f32 v225, s20, v173
    v_fmac_f32 v226, s20, v174
    v_fmac_f32 v227, s20, v175
    v_readlane_b32 s20, v44, 63
    s_nop 1
    v_fmac_f32 v224, s20, v176
    v_fmac_f32 v225, s20, v177
    v_fmac_f32 v226, s20, v178
    v_fmac_f32 v227, s20, v179
    v_readlane_b32 s20, v45, 63
    s_nop 1
    v_fmac_f32 v224, s20, v180
    v_fmac_f32 v225, s20, v181
    v_fmac_f32 v226, s20, v182
    v_fmac_f32 v227, s20, v183
    v_readlane_b32 s20, v46, 63
    s_nop 1
    v_fmac_f32 v224, s20, v184
    v_fmac_f32 v225, s20, v185
    v_fmac_f32 v226, s20, v186
    v_fmac_f32 v227, s20, v187
    v_readlane_b32 s20, v47, 63
    s_nop 1
    v_fmac_f32 v224, s20, v188
    v_fmac_f32 v225, s20, v189
    v_fmac_f32 v226, s20, v190
    v_fmac_f32 v227, s20, v191
    v_readlane_b32 s20, v52, 15
    s_nop 1
    v_fmac_f32 v224, s20, v192
    v_fmac_f32 v225, s20, v193
    v_fmac_f32 v226, s20, v194
    v_fmac_f32 v227, s20, v195
    v_readlane_b32 s20, v53, 15
    s_nop 1
    v_fmac_f32 v224, s20, v196
    v_fmac_f32 v225, s20, v197
    v_fmac_f32 v226, s20, v198
    v_fmac_f32 v227, s20, v199
    v_readlane_b32 s20, v54, 15
    s_nop 1
    v_fmac_f32 v224, s20, v200
    v_fmac_f32 v225, s20, v201
    v_fmac_f32 v226, s20, v202
    v_fmac_f32 v227, s20, v203
    v_readlane_b32 s20, v55, 15
    s_nop 1
    v_fmac_f32 v224, s20, v204
    v_fmac_f32 v225, s20, v205
    v_fmac_f32 v226, s20, v206
    v_fmac_f32 v227, s20, v207
    v_readlane_b32 s20, v52, 31
    s_nop 1
    v_fmac_f32 v224, s20, v208
    v_fmac_f32 v225, s20, v209
    v_fmac_f32 v226, s20, v210
    v_fmac_f32 v227, s20, v211
    v_readlane_b32 s20, v53, 31
    s_nop 1
    v_fmac_f32 v224, s20, v212
    v_fmac_f32 v225, s20, v213
    v_fmac_f32 v226, s20, v214
    v_fmac_f32 v227, s20, v215
    v_readlane_b32 s20, v54, 31
    s_nop 1
    v_fmac_f32 v224, s20, v216
    v_fmac_f32 v225, s20, v217
    v_fmac_f32 v226, s20, v218
    v_fmac_f32 v227, s20, v219
    v_readlane_b32 s20, v55, 31
    s_nop 1
    v_fmac_f32 v224, s20, v220
    v_fmac_f32 v225, s20, v221
    v_fmac_f32 v226, s20, v222
    v_fmac_f32 v227, s20, v223
    v_cvt_pk_bf16_f32 v6, v224, v225
    v_cvt_pk_bf16_f32 v7, v226, v227
    v_add_u32 v9, 253952, v3
    buffer_store_dwordx2 v[6:7], v9, s[8:11], 0 offen
    s_nop 1
att_kernel_end:
    s_endpgm
.section .rodata,"a"
.p2align 6
.amdhsa_kernel prep_kernel
  .amdhsa_next_free_vgpr 32
  .amdhsa_next_free_sgpr 102
  .amdhsa_accum_offset 32
  .amdhsa_group_segment_fixed_size 0
  .amdhsa_kernarg_size 128
  .amdhsa_user_sgpr_count 2
  .amdhsa_user_sgpr_kernarg_segment_ptr 1
  .amdhsa_system_sgpr_workgroup_id_x 1
.end_amdhsa_kernel
.p2align 6
.amdhsa_kernel kv_kernel
  .amdhsa_next_free_vgpr 48
  .amdhsa_next_free_sgpr 102
  .amdhsa_accum_offset 48
  .amdhsa_group_segment_fixed_size 0
  .amdhsa_kernarg_size 128
  .amdhsa_user_sgpr_count 2
  .amdhsa_user_sgpr_kernarg_segment_ptr 1
  .amdhsa_system_sgpr_workgroup_id_x 1
.end_amdhsa_kernel
.p2align 6
.amdhsa_kernel conv_kernel
  .amdhsa_next_free_vgpr 96
  .amdhsa_next_free_sgpr 102
  .amdhsa_accum_offset 96
  .amdhsa_group_segment_fixed_size 0
  .amdhsa_kernarg_size 128
  .amdhsa_user_sgpr_count 2
  .amdhsa_user_sgpr_kernarg_segment_ptr 1
  .amdhsa_system_sgpr_workgroup_id_x 1
.end_amdhsa_kernel
.p2align 6
.amdhsa_kernel rowa_kernel
  .amdhsa_next_free_vgpr 72
  .amdhsa_next_free_sgpr 102
  .amdhsa_accum_offset 72
  .amdhsa_group_segment_fixed_size 0
  .amdhsa_kernarg_size 128
  .amdhsa_user_sgpr_count 2
  .amdhsa_user_sgpr_kernarg_segment_ptr 1
  .amdhsa_system_sgpr_workgroup_id_x 1
.end_amdhsa_kernel
.p2align 6
.amdhsa_kernel rowb_kernel
  .amdhsa_next_free_vgpr 72
  .amdhsa_next_free_sgpr 102
  .amdhsa_accum_offset 72
  .amdhsa_group_segment_fixed_size 0
  .amdhsa_kernarg_size 128
  .amdhsa_user_sgpr_count 2
  .amdhsa_user_sgpr_kernarg_segment_ptr 1
  .amdhsa_system_sgpr_workgroup_id_x 1
.end_amdhsa_kernel
.p2align 6
.amdhsa_kernel qkv_kernel
  .amdhsa_next_free_vgpr 96
  .amdhsa_next_free_sgpr 102
  .amdhsa_accum_offset 96
  .amdhsa_group_segment_fixed_size 0
  .amdhsa_kernarg_size 128
  .amdhsa_user_sgpr_count 2
  .amdhsa_user_sgpr_kernarg_segment_ptr 1
  .amdhsa_system_sgpr_workgroup_id_x 1
.end_amdhsa_kernel
.p2align 6
.amdhsa_kernel woa_kernel
  .amdhsa_next_free_vgpr 72
  .amdhsa_next_free_sgpr 102
  .amdhsa_accum_offset 72
  .amdhsa_group_segment_fixed_size 0
  .amdhsa_kernarg_size 128
  .amdhsa_user_sgpr_count 2
  .amdhsa_user_sgpr_kernarg_segment_ptr 1
  .amdhsa_system_sgpr_workgroup_id_x 1
.end_amdhsa_kernel
.p2align 6
.amdhsa_kernel wob_kernel
  .amdhsa_next_free_vgpr 72
  .amdhsa_next_free_sgpr 102
  .amdhsa_accum_offset 72
  .amdhsa_group_segment_fixed_size 0
  .amdhsa_kernarg_size 128
  .amdhsa_user_sgpr_count 2
  .amdhsa_user_sgpr_kernarg_segment_ptr 1
  .amdhsa_system_sgpr_workgroup_id_x 1
.end_amdhsa_kernel
.p2align 6
.amdhsa_kernel cha_kernel
  .amdhsa_next_free_vgpr 352
  .amdhsa_next_free_sgpr 102
  .amdhsa_accum_offset 128
  .amdhsa_group_segment_fixed_size 0
  .amdhsa_kernarg_size 128
  .amdhsa_user_sgpr_count 2
  .amdhsa_user_sgpr_kernarg_segment_ptr 1
  .amdhsa_system_sgpr_workgroup_id_x 1
.end_amdhsa_kernel
.p2align 6
.amdhsa_kernel chb_kernel
  .amdhsa_next_free_vgpr 352
  .amdhsa_next_free_sgpr 102
  .amdhsa_accum_offset 128
  .amdhsa_group_segment_fixed_size 0
  .amdhsa_kernarg_size 128
  .amdhsa_user_sgpr_count 2
  .amdhsa_user_sgpr_kernarg_segment_ptr 1
  .amdhsa_system_sgpr_workgroup_id_x 1
.end_amdhsa_kernel
.p2align 6
.amdhsa_kernel att_kernel
  .amdhsa_next_free_vgpr 248
  .amdhsa_next_free_sgpr 102
  .amdhsa_accum_offset 248
  .amdhsa_group_segment_fixed_size 0
  .amdhsa_kernarg_size 128
  .amdhsa_user_sgpr_count 2
  .amdhsa_user_sgpr_kernarg_segment_ptr 1
  .amdhsa_system_sgpr_workgroup_id_x 1
.end_amdhsa_kernel
```
